```python
import torch

def _softmax(x, axis=-1):
    return torch.softmax(x, dim=axis)
def _gelu(x):
    return torch.nn.functional.gelu(x, approximate="tanh")
def _silu(x):
    return torch.nn.functional.silu(x)
def _sigmoid(x):
    return torch.sigmoid(x)
def _layernorm(x, axis=-1, eps=1e-5):
    m = x.mean(dim=axis, keepdim=True)
    v = x.var(dim=axis, keepdim=True, unbiased=False)
    return (x - m) / torch.sqrt(v + eps)
def _scatter_add(tgt, idx, src, axis=0):
    return tgt.clone().index_add_(axis, idx, src)
def _segment_sum(src, seg, n):
    out = torch.zeros((n,) + src.shape[1:], dtype=src.dtype)
    return out.index_add_(0, seg, src)
def _pad(x, pw):
    flat = tuple(v for pair in reversed(pw) for v in pair)
    return torch.nn.functional.pad(x, flat)

kernel_name = 'concat_heads__gqa_block_cached__mha_block_cached__near_ridge'

def setup_inputs():

    _w = (lambda a: (lambda t: t.to(torch.bfloat16) if t.is_floating_point() else t)(torch.as_tensor(a)))
    def _A_setup():
        B, Sq, D = 8, 144, 448
        Hq, Hkv, Sk, Dh = 16, 8, 1024, 256
        assert Hq % Hkv == 0, (Hq, Hkv)
        return {
            "x": _w((lambda *s: torch.randn(*s, dtype=torch.bfloat16) * 0.8)(B, Sq, D)),
            "k_cache": _w((lambda *s: torch.randn(*s, dtype=torch.bfloat16) * 0.8)(B, Hkv, Sk, Dh)),
            "v_cache": _w((lambda *s: torch.randn(*s, dtype=torch.bfloat16) * 0.05)(B, Hkv, Sk, Dh)),
            "wq": _w((lambda *s: torch.randn(*s, dtype=torch.bfloat16) * 0.8)(D, Hq * Dh) * (D ** -0.5)),
            "wo": _w((lambda *s: torch.randn(*s, dtype=torch.bfloat16) * 0.05)(Hq * Dh, D) * ((Hq * Dh) ** -0.5)),
        }
    _A_in = _A_setup()

    def _B_setup():
        B, Sq, D = 8, 144, 448
        H, Sk, Dh = 16, 1024, 256
        return {
            "x": _w((lambda *s: torch.randn(*s, dtype=torch.bfloat16) * 0.8)(B, Sq, D)),
            "k_cache": _w((lambda *s: torch.randn(*s, dtype=torch.bfloat16) * 0.8)(B, H, Sk, Dh)),
            "v_cache": _w((lambda *s: torch.randn(*s, dtype=torch.bfloat16) * 0.05)(B, H, Sk, Dh)),
            "wq": _w((lambda *s: torch.randn(*s, dtype=torch.bfloat16) * 0.8)(D, H * Dh) * (D ** -0.5)),
            "wo": _w((lambda *s: torch.randn(*s, dtype=torch.bfloat16) * 0.05)(H * Dh, D) * ((H * Dh) ** -0.5)),
        }
    _B_in = _B_setup()

    return {
        "A_x": _A_in["x"],
        "A_k_cache": _A_in["k_cache"],
        "A_v_cache": _A_in["v_cache"],
        "A_wq": _A_in["wq"],
        "A_wo": _A_in["wo"],
        "B_x": _B_in["x"],
        "B_k_cache": _B_in["k_cache"],
        "B_v_cache": _B_in["v_cache"],
        "B_wq": _B_in["wq"],
        "B_wo": _B_in["wo"],
    }

def reference(A_x, A_k_cache, A_v_cache, A_wq, A_wo, B_x, B_k_cache, B_v_cache, B_wq, B_wo):
    def _A_ref(x, k_cache, v_cache, wq, wo):
        B, Sq, D = x.shape
        Hq, Dh = 16, 256
        Hkv = k_cache.shape[1]
        rep = Hq // Hkv
        q = (lambda x, *d: x.permute(*d))((x @ wq).reshape(B, Sq, Hq, Dh), 0, 2, 1, 3)
        k = (lambda x, n, axis: torch.repeat_interleave(x, n, dim=axis))(k_cache, rep, axis=1)
        v = (lambda x, n, axis: torch.repeat_interleave(x, n, dim=axis))(v_cache, rep, axis=1)
        scores = torch.einsum("bhqd,bhkd->bhqk", q, k) * (Dh ** -0.5)
        p = _softmax(scores, axis=-1)
        o = torch.einsum("bhqk,bhkd->bhqd", p, v)
        return (lambda x, *d: x.permute(*d))(o, 0, 2, 1, 3).reshape(B, Sq, Hq * Dh) @ wo

    def _B_ref(x, k_cache, v_cache, wq, wo):
        B, Sq, D = x.shape
        H, Dh = 16, 256
        q = (lambda x, *d: x.permute(*d))((x @ wq).reshape(B, Sq, H, Dh), 0, 2, 1, 3)
        scores = torch.einsum("bhqd,bhkd->bhqk", q, k_cache) * (Dh ** -0.5)
        p = _softmax(scores, axis=-1)
        o = torch.einsum("bhqk,bhkd->bhqd", p, v_cache)
        return (lambda x, *d: x.permute(*d))(o, 0, 2, 1, 3).reshape(B, Sq, H * Dh) @ wo

    a = _A_ref(A_x, A_k_cache, A_v_cache, A_wq, A_wo)
    b = _B_ref(B_x, B_k_cache, B_v_cache, B_wq, B_wo)
    return torch.concatenate([a, b], axis=-1)
```

```asm
; @launch grid=(256,1,1) block=(256,1,1) lds=163840
.amdgcn_target "amdgcn-amd-amdhsa--gfx950"
.text
.globl concat_heads__gqa_block_cached__mha_block_cached__near_ridge_kernel
.p2align 8
.type concat_heads__gqa_block_cached__mha_block_cached__near_ridge_kernel,@function
concat_heads__gqa_block_cached__mha_block_cached__near_ridge_kernel:
    s_cmp_ge_u32 s2, 256
    s_cbranch_scc1 L_end
    s_mov_b32 s39, 0
    s_memrealtime s[48:49]
    v_lshrrev_b32 v1, 6, v0
    s_nop 0
    v_readfirstlane_b32 s28, v1
L_start:
    s_and_b32 s42, s2, 7
    s_lshr_b32 s43, s2, 3
    s_lshr_b32 s96, s43, 4
    s_lshr_b32 s97, s43, 1
    s_and_b32 s97, s97, 7
    s_and_b32 s98, s43, 1
    s_lshl_b32 s99, s42, 1
    s_add_u32 s98, s98, s99
    s_mul_i32 s99, s96, 40
    s_add_u32 s50, s0, s99
    s_addc_u32 s51, s1, 0
    s_load_dwordx2 s[4:5], s[50:51], 0
    s_load_dwordx2 s[8:9], s[50:51], 24
    s_load_dwordx2 s[12:13], s[50:51], 8
    s_load_dwordx2 s[16:17], s[50:51], 16
    s_load_dwordx2 s[20:21], s[50:51], 32
    s_load_dwordx2 s[24:25], s[0:1], 96
    s_getpc_b64 s[52:53]
L_pc:
    s_lshr_b32 s99, s2, 3
    v_and_b32 v2, 63, v0
    v_lshlrev_b32 v2, 5, v2
    v_add_u32 v2, s99, v2
    v_lshlrev_b32 v2, 7, v2
    s_cmp_lg_u32 s28, 3
    s_cbranch_scc1 L_nocpf
    s_mov_b32 s46, L_codeend-L_pc-4
    v_cmp_gt_u32 vcc, s46, v2
    s_nop 1
    s_and_saveexec_b64 s[100:101], vcc
    s_cbranch_execz L_cpf2
    global_load_dword a201, v2, s[52:53]
L_cpf2:
    s_mov_b64 exec, -1
L_nocpf:
    v_mbcnt_lo_u32_b32 v200, -1, 0
    v_mbcnt_hi_u32_b32 v200, -1, v200
    v_mov_b32 v201, s28
    v_and_b32 v202, 15, v200
    v_lshrrev_b32 v203, 4, v200
    s_lshl_b32 s29, s28, 12
    s_lshr_b32 s30, s28, 1
    s_and_b32 s31, s28, 1
    v_lshrrev_b32 v220, 3, v200
    v_lshl_add_u32 v221, v201, 3, v220
    v_mul_u32_u24 v221, 896, v221
    v_and_b32 v222, 7, v200
    v_xor_b32 v223, v222, v203
    s_lshl_b32 s99, s31, 2
    v_xor_b32 v223, s99, v223
    v_lshl_add_u32 v204, v223, 4, v221
    v_lshrrev_b32 v220, 5, v200
    v_and_b32 v221, 31, v200
    v_lshl_add_u32 v223, v201, 1, v220
    v_lshlrev_b32 v223, 1, v223
    v_xor_b32 v223, v223, v221
    v_lshlrev_b32 v223, 4, v223
    s_lshl_b32 s99, s30, 3
    s_lshl_b32 s100, s31, 1
    s_add_u32 s99, s99, s100
    v_add_u32 v221, s99, v220
    v_lshl_add_u32 v205, v221, 13, v223
    v_lshl_add_u32 v221, v201, 3, v220
    v_lshl_add_u32 v0, v221, 9, v223
    s_mul_i32 s100, s97, 129024
    s_lshl_b32 s101, s98, 9
    s_lshl_b32 s46, s28, 10
    s_add_u32 s46, s46, 98304
    s_and_b32 s99, s98, 1
    s_mul_i32 s99, s99, 0
    s_and_b32 s54, s97, 3
    s_mul_i32 s54, s54, 2
    s_add_u32 s99, s99, s54
    s_cmp_ge_u32 s99, 7
    s_cselect_b32 s54, 7, 0
    s_sub_u32 s99, s99, s54
    s_lshl_b32 s54, s99, 19
    s_lshl_b32 s55, s99, 7
    s_waitcnt lgkmcnt(0)
    s_add_u32 s4, s4, s100
    s_addc_u32 s5, s5, 0
    s_mov_b32 s6, 129024
    s_mov_b32 s7, 0x20000
    s_add_u32 s8, s8, s101
    s_addc_u32 s9, s9, 0
    s_sub_u32 s10, 3670016, s101
    s_mov_b32 s11, 0x20000
    s_add_u32 m0, s46, 0
    s_add_u32 s34, s55, 0
    buffer_load_dwordx4 v204, s[4:7], s34 offen  lds
    s_add_u32 m0, s46, 4096
    s_add_u32 s34, s55, 28672
    buffer_load_dwordx4 v204, s[4:7], s34 offen  lds
    s_add_u32 m0, s46, 8192
    s_add_u32 s34, s55, 57344
    buffer_load_dwordx4 v204, s[4:7], s34 offen  lds
    s_add_u32 m0, s46, 12288
    s_add_u32 s34, s55, 86016
    buffer_load_dwordx4 v204, s[4:7], s34 offen  lds
    s_add_u32 m0, s46, 16384
    s_add_u32 s34, s55, 114688
    buffer_load_dwordx4 v204, s[4:7], s34 offen  lds
    s_add_u32 s55, s55, 128
    s_cmp_eq_u32 s55, 896
    s_cselect_b32 s55, 0, s55
    s_add_u32 m0, s29, 49152
    s_nop 0
    buffer_load_dwordx4 v205, s[8:11], s54 offen  lds
    s_add_u32 s34, s54, 130048
    buffer_load_dwordx4 v205, s[8:11], s34 offen offset:1024  lds
    s_add_u32 s34, s54, 30720
    buffer_load_dwordx4 v205, s[8:11], s34 offen offset:2048  lds
    s_add_u32 s34, s54, 160768
    buffer_load_dwordx4 v205, s[8:11], s34 offen offset:3072  lds
    s_add_u32 s54, s54, 0x40000
    s_cmp_eq_u32 s54, 3670016
    s_cselect_b32 s54, 0, s54
    s_add_u32 m0, s29, 81920
    s_nop 0
    buffer_load_dwordx4 v205, s[8:11], s54 offen  lds
    s_add_u32 s34, s54, 130048
    buffer_load_dwordx4 v205, s[8:11], s34 offen offset:1024  lds
    s_add_u32 s34, s54, 30720
    buffer_load_dwordx4 v205, s[8:11], s34 offen offset:2048  lds
    s_add_u32 s34, s54, 160768
    buffer_load_dwordx4 v205, s[8:11], s34 offen offset:3072  lds
    s_add_u32 s54, s54, 0x40000
    s_cmp_eq_u32 s54, 3670016
    s_cselect_b32 s54, 0, s54
    s_lshl_b32 s99, s97, 4
    s_add_u32 s99, s99, s98
    s_xor_b32 s100, s96, 1
    s_lshr_b32 s99, s99, s100
    s_lshl_b32 s99, s99, 19
    s_add_u32 s12, s12, s99
    s_addc_u32 s13, s13, 0
    s_mov_b32 s14, 0x80000
    s_mov_b32 s15, 0x20000
    s_add_u32 s16, s16, s99
    s_addc_u32 s17, s17, 0
    s_mov_b32 s18, 0x80000
    s_mov_b32 s19, 0x20000
    s_mul_i32 s99, s98, 229376
    s_add_u32 s20, s20, s99
    s_addc_u32 s21, s21, 0
    s_mov_b32 s22, 229376
    s_mov_b32 s23, 0x20000
    s_lshl_b32 s99, s96, 3
    s_add_u32 s99, s99, s97
    s_lshl_b32 s99, s99, 4
    s_add_u32 s3, s99, s98
    s_lshl_b32 s99, s3, 17
    s_add_u32 s24, s24, s99
    s_addc_u32 s25, s25, 0
    s_mov_b32 s26, 131072
    s_mov_b32 s27, 0x20000
    s_mov_b32 s32, 0
    s_mov_b32 s33, 0
    v_lshrrev_b32 v220, 1, v202
    v_xor_b32 v220, v220, v203
    v_lshlrev_b32 v221, 7, v202
    v_add_u32 v221, 98304, v221
    s_lshl_b32 s99, s30, 13
    v_xor_b32 v222, 0, v220
    v_lshl_add_u32 v222, v222, 4, v221
    v_add_u32 v206, s99, v222
    v_add_u32 v208, 16384, v222
    v_xor_b32 v222, 4, v220
    v_lshl_add_u32 v222, v222, 4, v221
    v_add_u32 v207, s99, v222
    v_add_u32 v209, 16384, v222
    v_lshrrev_b32 v225, 2, v200
    v_lshrrev_b32 v224, 1, v225
    v_and_b32 v224, 3, v224
    v_lshlrev_b32 v224, 3, v224
    v_lshrrev_b32 v220, 3, v225
    v_lshl_add_u32 v224, v220, 1, v224
    v_and_b32 v220, 1, v225
    v_add_u32 v224, v224, v220
    v_lshlrev_b32 v224, 9, v224
    v_and_b32 v225, 7, v225
    v_and_b32 v223, 3, v200
    v_lshlrev_b32 v220, 1, v225
    v_xor_b32 v220, v220, v223
    s_lshl_b32 s99, s30, 3
    v_xor_b32 v220, s99, v220
    s_lshl_b32 s99, s31, 8
    v_add_u32 v221, s99, v224
    v_xor_b32 v222, 0, v220
    v_lshl_add_u32 v210, v222, 4, v221
    v_add_u32 v214, 0x10000, v210
    v_xor_b32 v222, 4, v220
    v_lshl_add_u32 v211, v222, 4, v221
    v_add_u32 v215, 0x10000, v211
    v_xor_b32 v222, 8, v220
    v_lshl_add_u32 v212, v222, 4, v221
    v_add_u32 v216, 0x10000, v212
    v_xor_b32 v222, 12, v220
    v_lshl_add_u32 v213, v222, 4, v221
    v_add_u32 v217, 0x10000, v213
    s_add_u32 m0, s46, 20480
    s_add_u32 s34, s55, 0
    buffer_load_dwordx4 v204, s[4:7], s34 offen  lds
    s_add_u32 m0, s46, 24576
    s_add_u32 s34, s55, 28672
    buffer_load_dwordx4 v204, s[4:7], s34 offen  lds
    s_add_u32 m0, s46, 28672
    s_add_u32 s34, s55, 57344
    buffer_load_dwordx4 v204, s[4:7], s34 offen  lds
    s_add_u32 m0, s46, 32768
    s_add_u32 s34, s55, 86016
    buffer_load_dwordx4 v204, s[4:7], s34 offen  lds
    s_add_u32 m0, s46, 36864
    s_add_u32 s34, s55, 114688
    buffer_load_dwordx4 v204, s[4:7], s34 offen  lds
    s_add_u32 s55, s55, 128
    s_cmp_eq_u32 s55, 896
    s_cselect_b32 s55, 0, s55
    s_add_u32 m0, s29, 0
    s_nop 0
    buffer_load_dwordx4 v205, s[8:11], s54 offen  lds
    s_add_u32 s34, s54, 130048
    buffer_load_dwordx4 v205, s[8:11], s34 offen offset:1024  lds
    s_add_u32 s34, s54, 30720
    buffer_load_dwordx4 v205, s[8:11], s34 offen offset:2048  lds
    s_add_u32 s34, s54, 160768
    buffer_load_dwordx4 v205, s[8:11], s34 offen offset:3072  lds
    s_add_u32 s54, s54, 0x40000
    s_cmp_eq_u32 s54, 3670016
    s_cselect_b32 s54, 0, s54
    s_lshl_b32 s99, s30, 2
    v_xor_b32 v220, s99, v225
    s_mul_i32 s99, s31, 2304
    s_add_u32 s99, s99, 65536
    v_add_u32 v221, s99, v224
    v_lshl_add_u32 v221, v223, 3, v221
    v_xor_b32 v222, 0, v220
    v_lshl_add_u32 v8, v222, 5, v221
    v_xor_b32 v16, 0x800, v8
    v_xor_b32 v222, 1, v220
    v_lshl_add_u32 v9, v222, 5, v221
    v_xor_b32 v17, 0x800, v9
    v_xor_b32 v222, 2, v220
    v_lshl_add_u32 v10, v222, 5, v221
    v_xor_b32 v18, 0x800, v10
    v_xor_b32 v222, 3, v220
    v_lshl_add_u32 v11, v222, 5, v221
    v_xor_b32 v19, 0x800, v11
    v_xor_b32 v222, 4, v220
    v_lshl_add_u32 v12, v222, 5, v221
    v_xor_b32 v20, 0x800, v12
    v_xor_b32 v222, 5, v220
    v_lshl_add_u32 v13, v222, 5, v221
    v_xor_b32 v21, 0x800, v13
    v_xor_b32 v222, 6, v220
    v_lshl_add_u32 v14, v222, 5, v221
    v_xor_b32 v22, 0x800, v14
    v_xor_b32 v222, 7, v220
    v_lshl_add_u32 v15, v222, 5, v221
    v_xor_b32 v23, 0x800, v15
    v_lshrrev_b32 v224, 1, v202
    v_and_b32 v224, 3, v224
    v_lshlrev_b32 v224, 3, v224
    v_lshrrev_b32 v220, 3, v202
    v_lshl_add_u32 v224, v220, 1, v224
    v_and_b32 v220, 1, v202
    v_add_u32 v224, v224, v220
    v_and_b32 v220, 7, v202
    v_lshlrev_b32 v220, 1, v220
    v_xor_b32 v220, v220, v203
    s_lshl_b32 s99, s31, 11
    v_lshlrev_b32 v221, 9, v224
    v_add_u32 v221, s99, v221
    v_xor_b32 v222, 0, v220
    v_lshl_add_u32 v4, v222, 4, v221
    v_xor_b32 v222, 4, v220
    v_lshl_add_u32 v5, v222, 4, v221
    v_xor_b32 v222, 8, v220
    v_lshl_add_u32 v6, v222, 4, v221
    v_xor_b32 v222, 12, v220
    v_lshl_add_u32 v7, v222, 4, v221
    s_mul_i32 s99, s28, 5120
    s_add_u32 s99, s99, 131072
    v_lshlrev_b32 v220, 3, v200
    v_add_u32 v1, s99, v220
    s_xor_b32 s99, s28, 1
    s_mul_i32 s99, s99, 5120
    s_add_u32 s99, s99, 131072
    v_add_u32 v2, s99, v220
    v_lshlrev_b32 v3, 2, v200
    v_add_u32 v3, 151552, v3
    s_add_u32 m0, s29, 16384
    s_nop 0
    buffer_load_dwordx4 v205, s[8:11], s54 offen  lds
    s_add_u32 s34, s54, 130048
    buffer_load_dwordx4 v205, s[8:11], s34 offen offset:1024  lds
    s_add_u32 s34, s54, 30720
    buffer_load_dwordx4 v205, s[8:11], s34 offen offset:2048  lds
    s_add_u32 s34, s54, 160768
    buffer_load_dwordx4 v205, s[8:11], s34 offen offset:3072  lds
    s_add_u32 s54, s54, 0x40000
    s_cmp_eq_u32 s54, 3670016
    s_cselect_b32 s54, 0, s54
    s_waitcnt vmcnt(13)
    s_barrier
    ds_read_b128 a[0:3], v206 offset:0
    ds_read_b128 a[4:7], v206 offset:2048
    ds_read_b128 a[8:11], v206 offset:4096
    ds_read_b128 a[12:15], v206 offset:6144
    ds_read_b128 a[16:19], v208 offset:0
    ds_read_b128 a[20:23], v207 offset:0
    ds_read_b128 a[24:27], v207 offset:2048
    ds_read_b128 a[28:31], v207 offset:4096
    ds_read_b128 a[32:35], v207 offset:6144
    ds_read_b128 a[36:39], v209 offset:0
    ds_read_b64_tr_b16 a[224:225], v210 offset:49152
    ds_read_b64_tr_b16 a[226:227], v210 offset:51200
    ds_read_b64_tr_b16 a[228:229], v210 offset:49160
    ds_read_b64_tr_b16 a[230:231], v210 offset:51208
    ds_read_b64_tr_b16 a[232:233], v211 offset:49152
    s_waitcnt lgkmcnt(14)
    ds_read_b64_tr_b16 a[234:235], v211 offset:51200
    s_waitcnt lgkmcnt(4)
    v_mfma_f32_16x16x32_bf16 v[28:31], a[224:227], a[0:3], 0
    s_add_u32 m0, s29, 65536
    s_nop 0
    buffer_load_dwordx4 v205, s[8:11], s54 offen  lds
    v_mfma_f32_16x16x32_bf16 v[60:63], a[224:227], a[4:7], 0
    ds_read_b64_tr_b16 a[236:237], v211 offset:49160
    ds_read_b64_tr_b16 a[238:239], v211 offset:51208
    v_mfma_f32_16x16x32_bf16 v[92:95], a[224:227], a[8:11], 0
    v_mfma_f32_16x16x32_bf16 v[124:127], a[224:227], a[12:15], 0
    s_waitcnt lgkmcnt(4)
    s_add_u32 s34, s54, 130048
    buffer_load_dwordx4 v205, s[8:11], s34 offen offset:1024  lds
    v_mfma_f32_16x16x32_bf16 v[32:35], a[228:231], a[0:3], 0
    ds_read_b64_tr_b16 a[240:241], v212 offset:49152
    ds_read_b64_tr_b16 a[242:243], v212 offset:51200
    v_mfma_f32_16x16x32_bf16 v[64:67], a[228:231], a[4:7], 0
    v_mfma_f32_16x16x32_bf16 v[96:99], a[228:231], a[8:11], 0
    v_mfma_f32_16x16x32_bf16 v[128:131], a[228:231], a[12:15], 0
    s_waitcnt lgkmcnt(4)
    s_add_u32 s34, s54, 30720
    buffer_load_dwordx4 v205, s[8:11], s34 offen offset:2048  lds
    v_mfma_f32_16x16x32_bf16 v[36:39], a[232:235], a[0:3], 0
    ds_read_b64_tr_b16 a[244:245], v212 offset:49160
    ds_read_b64_tr_b16 a[246:247], v212 offset:51208
    v_mfma_f32_16x16x32_bf16 v[68:71], a[232:235], a[4:7], 0
    v_mfma_f32_16x16x32_bf16 v[100:103], a[232:235], a[8:11], 0
    v_mfma_f32_16x16x32_bf16 v[132:135], a[232:235], a[12:15], 0
    s_waitcnt lgkmcnt(4)
    s_add_u32 s34, s54, 160768
    buffer_load_dwordx4 v205, s[8:11], s34 offen offset:3072  lds
    v_mfma_f32_16x16x32_bf16 v[40:43], a[236:239], a[0:3], 0
    ds_read_b64_tr_b16 a[248:249], v213 offset:49152
    ds_read_b64_tr_b16 a[250:251], v213 offset:51200
    v_mfma_f32_16x16x32_bf16 v[72:75], a[236:239], a[4:7], 0
    v_mfma_f32_16x16x32_bf16 v[104:107], a[236:239], a[8:11], 0
    v_mfma_f32_16x16x32_bf16 v[136:139], a[236:239], a[12:15], 0
    s_waitcnt lgkmcnt(4)
    v_mfma_f32_16x16x32_bf16 v[44:47], a[240:243], a[0:3], 0
    s_add_u32 s54, s54, 0x40000
    s_cmp_eq_u32 s54, 3670016
    s_cselect_b32 s54, 0, s54
    v_mfma_f32_16x16x32_bf16 v[76:79], a[240:243], a[4:7], 0
    s_add_u32 m0, s46, 40960
    s_add_u32 s34, s55, 0
    buffer_load_dwordx4 v204, s[4:7], s34 offen  lds
    v_mfma_f32_16x16x32_bf16 v[108:111], a[240:243], a[8:11], 0
    s_add_u32 m0, s46, 45056
    s_add_u32 s34, s55, 28672
    buffer_load_dwordx4 v204, s[4:7], s34 offen  lds
    v_mfma_f32_16x16x32_bf16 v[140:143], a[240:243], a[12:15], 0
    ds_read_b64_tr_b16 a[252:253], v213 offset:49160
    ds_read_b64_tr_b16 a[254:255], v213 offset:51208
    v_mfma_f32_16x16x32_bf16 v[156:159], a[240:243], a[16:19], 0
    s_waitcnt lgkmcnt(4)
    v_mfma_f32_16x16x32_bf16 v[48:51], a[244:247], a[0:3], 0
    ds_read_b64_tr_b16 a[224:225], v214 offset:16384
    ds_read_b64_tr_b16 a[226:227], v214 offset:18432
    v_mfma_f32_16x16x32_bf16 v[80:83], a[244:247], a[4:7], 0
    s_add_u32 m0, s46, 49152
    s_add_u32 s34, s55, 57344
    buffer_load_dwordx4 v204, s[4:7], s34 offen  lds
    v_mfma_f32_16x16x32_bf16 v[112:115], a[244:247], a[8:11], 0
    v_mfma_f32_16x16x32_bf16 v[144:147], a[244:247], a[12:15], 0
    v_mfma_f32_16x16x32_bf16 v[160:163], a[244:247], a[16:19], 0
    s_waitcnt lgkmcnt(4)
    v_mfma_f32_16x16x32_bf16 v[52:55], a[248:251], a[0:3], 0
    s_add_u32 m0, s46, 53248
    s_add_u32 s34, s55, 86016
    buffer_load_dwordx4 v204, s[4:7], s34 offen  lds
    v_mfma_f32_16x16x32_bf16 v[84:87], a[248:251], a[4:7], 0
    ds_read_b64_tr_b16 a[228:229], v214 offset:16392
    ds_read_b64_tr_b16 a[230:231], v214 offset:18440
    v_mfma_f32_16x16x32_bf16 v[116:119], a[248:251], a[8:11], 0
    v_mfma_f32_16x16x32_bf16 v[148:151], a[248:251], a[12:15], 0
    v_mfma_f32_16x16x32_bf16 v[164:167], a[248:251], a[16:19], 0
    s_waitcnt lgkmcnt(4)
    v_mfma_f32_16x16x32_bf16 v[56:59], a[252:255], a[0:3], 0
    s_add_u32 m0, s46, 57344
    s_add_u32 s34, s55, 114688
    buffer_load_dwordx4 v204, s[4:7], s34 offen  lds
    v_mfma_f32_16x16x32_bf16 v[88:91], a[252:255], a[4:7], 0
    ds_read_b64_tr_b16 a[232:233], v215 offset:16384
    ds_read_b64_tr_b16 a[234:235], v215 offset:18432
    v_mfma_f32_16x16x32_bf16 v[120:123], a[252:255], a[8:11], 0
    v_mfma_f32_16x16x32_bf16 v[152:155], a[252:255], a[12:15], 0
    s_add_u32 s55, s55, 128
    s_cmp_eq_u32 s55, 896
    s_cselect_b32 s55, 0, s55
    v_mfma_f32_16x16x32_bf16 v[168:171], a[252:255], a[16:19], 0
    s_waitcnt vmcnt(13)
    s_barrier
    s_waitcnt lgkmcnt(4)
    v_mfma_f32_16x16x32_bf16 v[28:31], a[224:227], a[20:23], v[28:31]
    s_add_u32 m0, s29, 32768
    s_nop 0
    buffer_load_dwordx4 v205, s[8:11], s54 offen  lds
    ds_read_b128 a[40:43], v206 offset:20480
    v_mfma_f32_16x16x32_bf16 v[60:63], a[224:227], a[24:27], v[60:63]
    ds_read_b64_tr_b16 a[236:237], v215 offset:16392
    ds_read_b64_tr_b16 a[238:239], v215 offset:18440
    v_mfma_f32_16x16x32_bf16 v[92:95], a[224:227], a[28:31], v[92:95]
    ds_read_b128 a[44:47], v206 offset:22528
    ds_read_b128 a[48:51], v206 offset:24576
    v_mfma_f32_16x16x32_bf16 v[124:127], a[224:227], a[32:35], v[124:127]
    s_waitcnt lgkmcnt(7)
    ds_read_b128 a[52:55], v206 offset:26624
    ds_read_b128 a[56:59], v208 offset:20480
    v_mfma_f32_16x16x32_bf16 v[32:35], a[228:231], a[20:23], v[32:35]
    s_add_u32 s34, s54, 130048
    buffer_load_dwordx4 v205, s[8:11], s34 offen offset:1024  lds
    ds_read_b128 a[60:63], v207 offset:20480
    v_mfma_f32_16x16x32_bf16 v[64:67], a[228:231], a[24:27], v[64:67]
    ds_read_b64_tr_b16 a[240:241], v216 offset:16384
    ds_read_b64_tr_b16 a[242:243], v216 offset:18432
    v_mfma_f32_16x16x32_bf16 v[96:99], a[228:231], a[28:31], v[96:99]
    ds_read_b128 a[64:67], v207 offset:22528
    ds_read_b128 a[68:71], v207 offset:24576
    v_mfma_f32_16x16x32_bf16 v[128:131], a[228:231], a[32:35], v[128:131]
    s_waitcnt lgkmcnt(12)
    ds_read_b128 a[72:75], v207 offset:26624
    ds_read_b128 a[76:79], v209 offset:20480
    v_mfma_f32_16x16x32_bf16 v[36:39], a[232:235], a[20:23], v[36:39]
    s_add_u32 s34, s54, 30720
    buffer_load_dwordx4 v205, s[8:11], s34 offen offset:2048  lds
    v_mov_b32 v172, 0
    v_mfma_f32_16x16x32_bf16 v[68:71], a[232:235], a[24:27], v[68:71]
    ds_read_b64_tr_b16 a[244:245], v216 offset:16392
    s_waitcnt lgkmcnt(14)
    ds_read_b64_tr_b16 a[246:247], v216 offset:18440
    v_mfma_f32_16x16x32_bf16 v[100:103], a[232:235], a[28:31], v[100:103]
    v_mov_b32 v173, 0
    v_mov_b32 v174, 0
    v_mfma_f32_16x16x32_bf16 v[132:135], a[232:235], a[32:35], v[132:135]
    s_waitcnt lgkmcnt(13)
    v_mov_b32 v175, 0
    v_mov_b32 v176, 0
    v_mfma_f32_16x16x32_bf16 v[40:43], a[236:239], a[20:23], v[40:43]
    s_add_u32 s34, s54, 160768
    buffer_load_dwordx4 v205, s[8:11], s34 offen offset:3072  lds
    v_mov_b32 v177, 0
    v_mfma_f32_16x16x32_bf16 v[72:75], a[236:239], a[24:27], v[72:75]
    ds_read_b64_tr_b16 a[248:249], v217 offset:16384
    ds_read_b64_tr_b16 a[250:251], v217 offset:18432
    v_mfma_f32_16x16x32_bf16 v[104:107], a[236:239], a[28:31], v[104:107]
    v_mov_b32 v178, 0
    v_mov_b32 v179, 0
    v_mfma_f32_16x16x32_bf16 v[136:139], a[236:239], a[32:35], v[136:139]
    s_waitcnt lgkmcnt(8)
    v_mov_b32 v180, 0
    v_mfma_f32_16x16x32_bf16 v[44:47], a[240:243], a[20:23], v[44:47]
    s_add_u32 s54, s54, 0x40000
    s_cmp_eq_u32 s54, 3670016
    s_cselect_b32 s54, 0, s54
    v_mfma_f32_16x16x32_bf16 v[76:79], a[240:243], a[24:27], v[76:79]
    ds_read_b64_tr_b16 a[252:253], v217 offset:16392
    ds_read_b64_tr_b16 a[254:255], v217 offset:18440
    v_mfma_f32_16x16x32_bf16 v[108:111], a[240:243], a[28:31], v[108:111]
    v_mfma_f32_16x16x32_bf16 v[140:143], a[240:243], a[32:35], v[140:143]
    v_mfma_f32_16x16x32_bf16 v[156:159], a[240:243], a[36:39], v[156:159]
    s_waitcnt lgkmcnt(4)
    v_mfma_f32_16x16x32_bf16 v[48:51], a[244:247], a[20:23], v[48:51]
    ds_read_b64_tr_b16 a[224:225], v210 offset:0
    ds_read_b64_tr_b16 a[226:227], v210 offset:2048
    v_mfma_f32_16x16x32_bf16 v[80:83], a[244:247], a[24:27], v[80:83]
    v_mfma_f32_16x16x32_bf16 v[112:115], a[244:247], a[28:31], v[112:115]
    v_mfma_f32_16x16x32_bf16 v[144:147], a[244:247], a[32:35], v[144:147]
    v_mfma_f32_16x16x32_bf16 v[160:163], a[244:247], a[36:39], v[160:163]
    s_waitcnt lgkmcnt(4)
    v_mfma_f32_16x16x32_bf16 v[52:55], a[248:251], a[20:23], v[52:55]
    ds_read_b64_tr_b16 a[228:229], v210 offset:8
    ds_read_b64_tr_b16 a[230:231], v210 offset:2056
    v_mfma_f32_16x16x32_bf16 v[84:87], a[248:251], a[24:27], v[84:87]
    v_mfma_f32_16x16x32_bf16 v[116:119], a[248:251], a[28:31], v[116:119]
    v_mfma_f32_16x16x32_bf16 v[148:151], a[248:251], a[32:35], v[148:151]
    v_mfma_f32_16x16x32_bf16 v[164:167], a[248:251], a[36:39], v[164:167]
    s_waitcnt lgkmcnt(4)
    v_mfma_f32_16x16x32_bf16 v[56:59], a[252:255], a[20:23], v[56:59]
    ds_read_b64_tr_b16 a[232:233], v211 offset:0
    ds_read_b64_tr_b16 a[234:235], v211 offset:2048
    v_mfma_f32_16x16x32_bf16 v[88:91], a[252:255], a[24:27], v[88:91]
    v_mfma_f32_16x16x32_bf16 v[120:123], a[252:255], a[28:31], v[120:123]
    v_mfma_f32_16x16x32_bf16 v[152:155], a[252:255], a[32:35], v[152:155]
    v_mfma_f32_16x16x32_bf16 v[168:171], a[252:255], a[36:39], v[168:171]
    s_waitcnt vmcnt(13)
    s_barrier
    s_waitcnt lgkmcnt(4)
    v_mfma_f32_16x16x32_bf16 v[28:31], a[224:227], a[40:43], v[28:31]
    s_add_u32 m0, s29, 49152
    s_nop 0
    buffer_load_dwordx4 v205, s[8:11], s54 offen  lds
    v_mov_b32 v181, 0
    v_mfma_f32_16x16x32_bf16 v[60:63], a[224:227], a[44:47], v[60:63]
    ds_read_b64_tr_b16 a[236:237], v211 offset:8
    ds_read_b64_tr_b16 a[238:239], v211 offset:2056
    v_mfma_f32_16x16x32_bf16 v[92:95], a[224:227], a[48:51], v[92:95]
    s_add_u32 s34, s54, 130048
    buffer_load_dwordx4 v205, s[8:11], s34 offen offset:1024  lds
    v_mov_b32 v182, 0
    v_mfma_f32_16x16x32_bf16 v[124:127], a[224:227], a[52:55], v[124:127]
    s_waitcnt lgkmcnt(4)
    v_mov_b32 v183, 0
    v_mov_b32 v184, 0
    v_mfma_f32_16x16x32_bf16 v[32:35], a[228:231], a[40:43], v[32:35]
    ds_read_b64_tr_b16 a[240:241], v212 offset:0
    ds_read_b64_tr_b16 a[242:243], v212 offset:2048
    v_mfma_f32_16x16x32_bf16 v[64:67], a[228:231], a[44:47], v[64:67]
    s_add_u32 s34, s54, 30720
    buffer_load_dwordx4 v205, s[8:11], s34 offen offset:2048  lds
    v_mov_b32 v185, 0
    v_mfma_f32_16x16x32_bf16 v[96:99], a[228:231], a[48:51], v[96:99]
    v_mov_b32 v186, 0
    v_mov_b32 v187, 0
    v_mfma_f32_16x16x32_bf16 v[128:131], a[228:231], a[52:55], v[128:131]
    s_waitcnt lgkmcnt(4)
    s_add_u32 s34, s54, 160768
    buffer_load_dwordx4 v205, s[8:11], s34 offen offset:3072  lds
    v_mfma_f32_16x16x32_bf16 v[36:39], a[232:235], a[40:43], v[36:39]
    ds_read_b64_tr_b16 a[244:245], v212 offset:8
    ds_read_b64_tr_b16 a[246:247], v212 offset:2056
    v_mfma_f32_16x16x32_bf16 v[68:71], a[232:235], a[44:47], v[68:71]
    v_mov_b32 v188, 0
    v_mov_b32 v189, 0
    v_mfma_f32_16x16x32_bf16 v[100:103], a[232:235], a[48:51], v[100:103]
    s_add_u32 s54, s54, 0x40000
    s_cmp_eq_u32 s54, 3670016
    s_cselect_b32 s54, 0, s54
    v_mfma_f32_16x16x32_bf16 v[132:135], a[232:235], a[52:55], v[132:135]
    s_waitcnt lgkmcnt(4)
    s_add_u32 m0, s29, 81920
    s_nop 0
    buffer_load_dwordx4 v205, s[8:11], s54 offen  lds
    v_mfma_f32_16x16x32_bf16 v[40:43], a[236:239], a[40:43], v[40:43]
    ds_read_b64_tr_b16 a[248:249], v213 offset:0
    ds_read_b64_tr_b16 a[250:251], v213 offset:2048
    v_mfma_f32_16x16x32_bf16 v[72:75], a[236:239], a[44:47], v[72:75]
    s_add_u32 s34, s54, 130048
    buffer_load_dwordx4 v205, s[8:11], s34 offen offset:1024  lds
    v_mfma_f32_16x16x32_bf16 v[104:107], a[236:239], a[48:51], v[104:107]
    v_mfma_f32_16x16x32_bf16 v[136:139], a[236:239], a[52:55], v[136:139]
    s_waitcnt lgkmcnt(4)
    s_add_u32 s34, s54, 30720
    buffer_load_dwordx4 v205, s[8:11], s34 offen offset:2048  lds
    v_mfma_f32_16x16x32_bf16 v[44:47], a[240:243], a[40:43], v[44:47]
    ds_read_b64_tr_b16 a[252:253], v213 offset:8
    ds_read_b64_tr_b16 a[254:255], v213 offset:2056
    v_mfma_f32_16x16x32_bf16 v[76:79], a[240:243], a[44:47], v[76:79]
    v_mfma_f32_16x16x32_bf16 v[108:111], a[240:243], a[48:51], v[108:111]
    s_add_u32 s34, s54, 160768
    buffer_load_dwordx4 v205, s[8:11], s34 offen offset:3072  lds
    v_mfma_f32_16x16x32_bf16 v[140:143], a[240:243], a[52:55], v[140:143]
    v_mfma_f32_16x16x32_bf16 v[156:159], a[240:243], a[56:59], v[156:159]
    s_waitcnt lgkmcnt(4)
    v_mfma_f32_16x16x32_bf16 v[48:51], a[244:247], a[40:43], v[48:51]
    s_add_u32 s54, s54, 0x40000
    s_cmp_eq_u32 s54, 3670016
    s_cselect_b32 s54, 0, s54
    v_mfma_f32_16x16x32_bf16 v[80:83], a[244:247], a[44:47], v[80:83]
    s_add_u32 m0, s46, 0
    s_add_u32 s34, s55, 0
    buffer_load_dwordx4 v204, s[4:7], s34 offen  lds
    v_mfma_f32_16x16x32_bf16 v[112:115], a[244:247], a[48:51], v[112:115]
    s_add_u32 m0, s46, 4096
    s_add_u32 s34, s55, 28672
    buffer_load_dwordx4 v204, s[4:7], s34 offen  lds
    v_mfma_f32_16x16x32_bf16 v[144:147], a[244:247], a[52:55], v[144:147]
    ds_read_b64_tr_b16 a[224:225], v210 offset:16384
    ds_read_b64_tr_b16 a[226:227], v210 offset:18432
    v_mfma_f32_16x16x32_bf16 v[160:163], a[244:247], a[56:59], v[160:163]
    s_waitcnt lgkmcnt(4)
    v_mfma_f32_16x16x32_bf16 v[52:55], a[248:251], a[40:43], v[52:55]
    s_add_u32 m0, s46, 8192
    s_add_u32 s34, s55, 57344
    buffer_load_dwordx4 v204, s[4:7], s34 offen  lds
    v_mfma_f32_16x16x32_bf16 v[84:87], a[248:251], a[44:47], v[84:87]
    ds_read_b64_tr_b16 a[228:229], v210 offset:16392
    ds_read_b64_tr_b16 a[230:231], v210 offset:18440
    v_mfma_f32_16x16x32_bf16 v[116:119], a[248:251], a[48:51], v[116:119]
    s_add_u32 m0, s46, 12288
    s_add_u32 s34, s55, 86016
    buffer_load_dwordx4 v204, s[4:7], s34 offen  lds
    v_mfma_f32_16x16x32_bf16 v[148:151], a[248:251], a[52:55], v[148:151]
    v_mfma_f32_16x16x32_bf16 v[164:167], a[248:251], a[56:59], v[164:167]
    s_waitcnt lgkmcnt(4)
    v_mfma_f32_16x16x32_bf16 v[56:59], a[252:255], a[40:43], v[56:59]
    s_add_u32 m0, s46, 16384
    s_add_u32 s34, s55, 114688
    buffer_load_dwordx4 v204, s[4:7], s34 offen  lds
    v_mfma_f32_16x16x32_bf16 v[88:91], a[252:255], a[44:47], v[88:91]
    ds_read_b64_tr_b16 a[232:233], v211 offset:16384
    ds_read_b64_tr_b16 a[234:235], v211 offset:18432
    v_mfma_f32_16x16x32_bf16 v[120:123], a[252:255], a[48:51], v[120:123]
    v_mfma_f32_16x16x32_bf16 v[152:155], a[252:255], a[52:55], v[152:155]
    s_add_u32 s55, s55, 128
    s_cmp_eq_u32 s55, 896
    s_cselect_b32 s55, 0, s55
    v_mfma_f32_16x16x32_bf16 v[168:171], a[252:255], a[56:59], v[168:171]
    s_waitcnt vmcnt(17)
    s_barrier
    s_waitcnt lgkmcnt(4)
    v_mfma_f32_16x16x32_bf16 v[28:31], a[224:227], a[60:63], v[28:31]
    s_add_u32 m0, s29, 0
    s_nop 0
    buffer_load_dwordx4 v205, s[8:11], s54 offen  lds
    ds_read_b128 a[0:3], v206 offset:40960
    v_mfma_f32_16x16x32_bf16 v[60:63], a[224:227], a[64:67], v[60:63]
    ds_read_b64_tr_b16 a[236:237], v211 offset:16392
    ds_read_b64_tr_b16 a[238:239], v211 offset:18440
    v_mfma_f32_16x16x32_bf16 v[92:95], a[224:227], a[68:71], v[92:95]
    ds_read_b128 a[4:7], v206 offset:43008
    ds_read_b128 a[8:11], v206 offset:45056
    v_mfma_f32_16x16x32_bf16 v[124:127], a[224:227], a[72:75], v[124:127]
    s_waitcnt lgkmcnt(7)
    ds_read_b128 a[12:15], v206 offset:47104
    ds_read_b128 a[16:19], v208 offset:40960
    v_mfma_f32_16x16x32_bf16 v[32:35], a[228:231], a[60:63], v[32:35]
    s_add_u32 s34, s54, 130048
    buffer_load_dwordx4 v205, s[8:11], s34 offen offset:1024  lds
    ds_read_b128 a[20:23], v207 offset:40960
    v_mfma_f32_16x16x32_bf16 v[64:67], a[228:231], a[64:67], v[64:67]
    ds_read_b64_tr_b16 a[240:241], v212 offset:16384
    ds_read_b64_tr_b16 a[242:243], v212 offset:18432
    v_mfma_f32_16x16x32_bf16 v[96:99], a[228:231], a[68:71], v[96:99]
    ds_read_b128 a[24:27], v207 offset:43008
    ds_read_b128 a[28:31], v207 offset:45056
    v_mfma_f32_16x16x32_bf16 v[128:131], a[228:231], a[72:75], v[128:131]
    s_waitcnt lgkmcnt(12)
    ds_read_b128 a[32:35], v207 offset:47104
    ds_read_b128 a[36:39], v209 offset:40960
    v_mfma_f32_16x16x32_bf16 v[36:39], a[232:235], a[60:63], v[36:39]
    s_add_u32 s34, s54, 30720
    buffer_load_dwordx4 v205, s[8:11], s34 offen offset:2048  lds
    v_mov_b32 v190, 0
    v_mfma_f32_16x16x32_bf16 v[68:71], a[232:235], a[64:67], v[68:71]
    ds_read_b64_tr_b16 a[244:245], v212 offset:16392
    s_waitcnt lgkmcnt(14)
    ds_read_b64_tr_b16 a[246:247], v212 offset:18440
    v_mfma_f32_16x16x32_bf16 v[100:103], a[232:235], a[68:71], v[100:103]
    v_mov_b32 v191, 0
    v_mov_b32 v192, 0
    v_mfma_f32_16x16x32_bf16 v[132:135], a[232:235], a[72:75], v[132:135]
    s_waitcnt lgkmcnt(13)
    v_mov_b32 v193, 0
    v_mov_b32 v194, 0
    v_mfma_f32_16x16x32_bf16 v[40:43], a[236:239], a[60:63], v[40:43]
    s_add_u32 s34, s54, 160768
    buffer_load_dwordx4 v205, s[8:11], s34 offen offset:3072  lds
    v_mov_b32 v195, 0
    v_mfma_f32_16x16x32_bf16 v[72:75], a[236:239], a[64:67], v[72:75]
    ds_read_b64_tr_b16 a[248:249], v213 offset:16384
    ds_read_b64_tr_b16 a[250:251], v213 offset:18432
    v_mfma_f32_16x16x32_bf16 v[104:107], a[236:239], a[68:71], v[104:107]
    v_mov_b32 v196, 0
    v_mov_b32 v197, 0
    v_mfma_f32_16x16x32_bf16 v[136:139], a[236:239], a[72:75], v[136:139]
    s_waitcnt lgkmcnt(8)
    v_mov_b32 v198, 0
    v_mfma_f32_16x16x32_bf16 v[44:47], a[240:243], a[60:63], v[44:47]
    s_add_u32 s54, s54, 0x40000
    s_cmp_eq_u32 s54, 3670016
    s_cselect_b32 s54, 0, s54
    v_mfma_f32_16x16x32_bf16 v[76:79], a[240:243], a[64:67], v[76:79]
    ds_read_b64_tr_b16 a[252:253], v213 offset:16392
    ds_read_b64_tr_b16 a[254:255], v213 offset:18440
    v_mfma_f32_16x16x32_bf16 v[108:111], a[240:243], a[68:71], v[108:111]
    v_mfma_f32_16x16x32_bf16 v[140:143], a[240:243], a[72:75], v[140:143]
    v_mfma_f32_16x16x32_bf16 v[156:159], a[240:243], a[76:79], v[156:159]
    s_waitcnt lgkmcnt(4)
    v_mfma_f32_16x16x32_bf16 v[48:51], a[244:247], a[60:63], v[48:51]
    ds_read_b64_tr_b16 a[224:225], v214 offset:0
    ds_read_b64_tr_b16 a[226:227], v214 offset:2048
    v_mfma_f32_16x16x32_bf16 v[80:83], a[244:247], a[64:67], v[80:83]
    v_mfma_f32_16x16x32_bf16 v[112:115], a[244:247], a[68:71], v[112:115]
    v_mfma_f32_16x16x32_bf16 v[144:147], a[244:247], a[72:75], v[144:147]
    v_mfma_f32_16x16x32_bf16 v[160:163], a[244:247], a[76:79], v[160:163]
    s_waitcnt lgkmcnt(4)
    v_mfma_f32_16x16x32_bf16 v[52:55], a[248:251], a[60:63], v[52:55]
    ds_read_b64_tr_b16 a[228:229], v214 offset:8
    ds_read_b64_tr_b16 a[230:231], v214 offset:2056
    v_mfma_f32_16x16x32_bf16 v[84:87], a[248:251], a[64:67], v[84:87]
    v_mfma_f32_16x16x32_bf16 v[116:119], a[248:251], a[68:71], v[116:119]
    v_mfma_f32_16x16x32_bf16 v[148:151], a[248:251], a[72:75], v[148:151]
    v_mfma_f32_16x16x32_bf16 v[164:167], a[248:251], a[76:79], v[164:167]
    s_waitcnt lgkmcnt(4)
    v_mfma_f32_16x16x32_bf16 v[56:59], a[252:255], a[60:63], v[56:59]
    ds_read_b64_tr_b16 a[232:233], v215 offset:0
    ds_read_b64_tr_b16 a[234:235], v215 offset:2048
    v_mfma_f32_16x16x32_bf16 v[88:91], a[252:255], a[64:67], v[88:91]
    v_mfma_f32_16x16x32_bf16 v[120:123], a[252:255], a[68:71], v[120:123]
    v_mfma_f32_16x16x32_bf16 v[152:155], a[252:255], a[72:75], v[152:155]
    v_mfma_f32_16x16x32_bf16 v[168:171], a[252:255], a[76:79], v[168:171]
    s_waitcnt vmcnt(17)
    s_barrier
    s_waitcnt lgkmcnt(4)
    v_mfma_f32_16x16x32_bf16 v[28:31], a[224:227], a[0:3], v[28:31]
    s_add_u32 m0, s29, 16384
    s_nop 0
    buffer_load_dwordx4 v205, s[8:11], s54 offen  lds
    v_mov_b32 v199, 0
    v_mfma_f32_16x16x32_bf16 v[60:63], a[224:227], a[4:7], v[60:63]
    ds_read_b64_tr_b16 a[236:237], v215 offset:8
    ds_read_b64_tr_b16 a[238:239], v215 offset:2056
    v_mfma_f32_16x16x32_bf16 v[92:95], a[224:227], a[8:11], v[92:95]
    v_mov_b32 v226, 0
    v_mov_b32 v227, 0
    v_mfma_f32_16x16x32_bf16 v[124:127], a[224:227], a[12:15], v[124:127]
    s_waitcnt lgkmcnt(4)
    s_add_u32 s34, s54, 130048
    buffer_load_dwordx4 v205, s[8:11], s34 offen offset:1024  lds
    v_mfma_f32_16x16x32_bf16 v[32:35], a[228:231], a[0:3], v[32:35]
    ds_read_b64_tr_b16 a[240:241], v216 offset:0
    ds_read_b64_tr_b16 a[242:243], v216 offset:2048
    v_mfma_f32_16x16x32_bf16 v[64:67], a[228:231], a[4:7], v[64:67]
    v_mov_b32 v228, 0
    v_mov_b32 v229, 0
    v_mfma_f32_16x16x32_bf16 v[96:99], a[228:231], a[8:11], v[96:99]
    v_mov_b32 v230, 0
    v_mov_b32 v231, 0
    v_mfma_f32_16x16x32_bf16 v[128:131], a[228:231], a[12:15], v[128:131]
    s_waitcnt lgkmcnt(4)
    s_add_u32 s34, s54, 30720
    buffer_load_dwordx4 v205, s[8:11], s34 offen offset:2048  lds
    v_mfma_f32_16x16x32_bf16 v[36:39], a[232:235], a[0:3], v[36:39]
    ds_read_b64_tr_b16 a[244:245], v216 offset:8
    ds_read_b64_tr_b16 a[246:247], v216 offset:2056
    v_mfma_f32_16x16x32_bf16 v[68:71], a[232:235], a[4:7], v[68:71]
    v_mov_b32 v232, 0
    v_mov_b32 v233, 0
    v_mfma_f32_16x16x32_bf16 v[100:103], a[232:235], a[8:11], v[100:103]
    v_mfma_f32_16x16x32_bf16 v[132:135], a[232:235], a[12:15], v[132:135]
    s_waitcnt lgkmcnt(4)
    s_add_u32 s34, s54, 160768
    buffer_load_dwordx4 v205, s[8:11], s34 offen offset:3072  lds
    v_mfma_f32_16x16x32_bf16 v[40:43], a[236:239], a[0:3], v[40:43]
    ds_read_b64_tr_b16 a[248:249], v217 offset:0
    ds_read_b64_tr_b16 a[250:251], v217 offset:2048
    v_mfma_f32_16x16x32_bf16 v[72:75], a[236:239], a[4:7], v[72:75]
    v_mfma_f32_16x16x32_bf16 v[104:107], a[236:239], a[8:11], v[104:107]
    v_mfma_f32_16x16x32_bf16 v[136:139], a[236:239], a[12:15], v[136:139]
    s_waitcnt lgkmcnt(4)
    v_mfma_f32_16x16x32_bf16 v[44:47], a[240:243], a[0:3], v[44:47]
    s_add_u32 s54, s54, 0x40000
    s_cmp_eq_u32 s54, 3670016
    s_cselect_b32 s54, 0, s54
    v_mfma_f32_16x16x32_bf16 v[76:79], a[240:243], a[4:7], v[76:79]
    s_add_u32 m0, s46, 20480
    s_add_u32 s34, s55, 0
    buffer_load_dwordx4 v204, s[4:7], s34 offen  lds
    v_mfma_f32_16x16x32_bf16 v[108:111], a[240:243], a[8:11], v[108:111]
    s_add_u32 m0, s46, 24576
    s_add_u32 s34, s55, 28672
    buffer_load_dwordx4 v204, s[4:7], s34 offen  lds
    v_mfma_f32_16x16x32_bf16 v[140:143], a[240:243], a[12:15], v[140:143]
    ds_read_b64_tr_b16 a[252:253], v217 offset:8
    ds_read_b64_tr_b16 a[254:255], v217 offset:2056
    v_mfma_f32_16x16x32_bf16 v[156:159], a[240:243], a[16:19], v[156:159]
    s_waitcnt lgkmcnt(4)
    v_mfma_f32_16x16x32_bf16 v[48:51], a[244:247], a[0:3], v[48:51]
    ds_read_b64_tr_b16 a[224:225], v210 offset:32768
    ds_read_b64_tr_b16 a[226:227], v210 offset:34816
    v_mfma_f32_16x16x32_bf16 v[80:83], a[244:247], a[4:7], v[80:83]
    s_add_u32 m0, s46, 28672
    s_add_u32 s34, s55, 57344
    buffer_load_dwordx4 v204, s[4:7], s34 offen  lds
    v_mfma_f32_16x16x32_bf16 v[112:115], a[244:247], a[8:11], v[112:115]
    v_mfma_f32_16x16x32_bf16 v[144:147], a[244:247], a[12:15], v[144:147]
    v_mfma_f32_16x16x32_bf16 v[160:163], a[244:247], a[16:19], v[160:163]
    s_waitcnt lgkmcnt(4)
    v_mfma_f32_16x16x32_bf16 v[52:55], a[248:251], a[0:3], v[52:55]
    s_add_u32 m0, s46, 32768
    s_add_u32 s34, s55, 86016
    buffer_load_dwordx4 v204, s[4:7], s34 offen  lds
    v_mfma_f32_16x16x32_bf16 v[84:87], a[248:251], a[4:7], v[84:87]
    ds_read_b64_tr_b16 a[228:229], v210 offset:32776
    ds_read_b64_tr_b16 a[230:231], v210 offset:34824
    v_mfma_f32_16x16x32_bf16 v[116:119], a[248:251], a[8:11], v[116:119]
    v_mfma_f32_16x16x32_bf16 v[148:151], a[248:251], a[12:15], v[148:151]
    v_mfma_f32_16x16x32_bf16 v[164:167], a[248:251], a[16:19], v[164:167]
    s_waitcnt lgkmcnt(4)
    v_mfma_f32_16x16x32_bf16 v[56:59], a[252:255], a[0:3], v[56:59]
    s_add_u32 m0, s46, 36864
    s_add_u32 s34, s55, 114688
    buffer_load_dwordx4 v204, s[4:7], s34 offen  lds
    v_mfma_f32_16x16x32_bf16 v[88:91], a[252:255], a[4:7], v[88:91]
    ds_read_b64_tr_b16 a[232:233], v211 offset:32768
    ds_read_b64_tr_b16 a[234:235], v211 offset:34816
    v_mfma_f32_16x16x32_bf16 v[120:123], a[252:255], a[8:11], v[120:123]
    v_mfma_f32_16x16x32_bf16 v[152:155], a[252:255], a[12:15], v[152:155]
    s_add_u32 s55, s55, 128
    s_cmp_eq_u32 s55, 896
    s_cselect_b32 s55, 0, s55
    v_mfma_f32_16x16x32_bf16 v[168:171], a[252:255], a[16:19], v[168:171]
    s_waitcnt vmcnt(13)
    s_barrier
    s_waitcnt lgkmcnt(4)
    v_mfma_f32_16x16x32_bf16 v[28:31], a[224:227], a[20:23], v[28:31]
    s_add_u32 m0, s29, 65536
    s_nop 0
    buffer_load_dwordx4 v205, s[8:11], s54 offen  lds
    ds_read_b128 a[40:43], v206 offset:0
    v_mfma_f32_16x16x32_bf16 v[60:63], a[224:227], a[24:27], v[60:63]
    ds_read_b64_tr_b16 a[236:237], v211 offset:32776
    ds_read_b64_tr_b16 a[238:239], v211 offset:34824
    v_mfma_f32_16x16x32_bf16 v[92:95], a[224:227], a[28:31], v[92:95]
    ds_read_b128 a[44:47], v206 offset:2048
    ds_read_b128 a[48:51], v206 offset:4096
    v_mfma_f32_16x16x32_bf16 v[124:127], a[224:227], a[32:35], v[124:127]
    s_waitcnt lgkmcnt(7)
    ds_read_b128 a[52:55], v206 offset:6144
    ds_read_b128 a[56:59], v208 offset:0
    v_mfma_f32_16x16x32_bf16 v[32:35], a[228:231], a[20:23], v[32:35]
    s_add_u32 s34, s54, 130048
    buffer_load_dwordx4 v205, s[8:11], s34 offen offset:1024  lds
    ds_read_b128 a[60:63], v207 offset:0
    v_mfma_f32_16x16x32_bf16 v[64:67], a[228:231], a[24:27], v[64:67]
    ds_read_b64_tr_b16 a[240:241], v212 offset:32768
    ds_read_b64_tr_b16 a[242:243], v212 offset:34816
    v_mfma_f32_16x16x32_bf16 v[96:99], a[228:231], a[28:31], v[96:99]
    ds_read_b128 a[64:67], v207 offset:2048
    ds_read_b128 a[68:71], v207 offset:4096
    v_mfma_f32_16x16x32_bf16 v[128:131], a[228:231], a[32:35], v[128:131]
    s_waitcnt lgkmcnt(12)
    ds_read_b128 a[72:75], v207 offset:6144
    ds_read_b128 a[76:79], v209 offset:0
    v_mfma_f32_16x16x32_bf16 v[36:39], a[232:235], a[20:23], v[36:39]
    s_add_u32 s34, s54, 30720
    buffer_load_dwordx4 v205, s[8:11], s34 offen offset:2048  lds
    v_mov_b32 v234, 0
    v_mfma_f32_16x16x32_bf16 v[68:71], a[232:235], a[24:27], v[68:71]
    ds_read_b64_tr_b16 a[244:245], v212 offset:32776
    s_waitcnt lgkmcnt(14)
    ds_read_b64_tr_b16 a[246:247], v212 offset:34824
    v_mfma_f32_16x16x32_bf16 v[100:103], a[232:235], a[28:31], v[100:103]
    v_mov_b32 v235, 0
    v_mov_b32 v236, 0
    v_mfma_f32_16x16x32_bf16 v[132:135], a[232:235], a[32:35], v[132:135]
    s_waitcnt lgkmcnt(13)
    v_mov_b32 v237, 0
    v_mov_b32 v238, 0
    v_mfma_f32_16x16x32_bf16 v[40:43], a[236:239], a[20:23], v[40:43]
    s_add_u32 s34, s54, 160768
    buffer_load_dwordx4 v205, s[8:11], s34 offen offset:3072  lds
    v_mov_b32 v239, 0
    v_mfma_f32_16x16x32_bf16 v[72:75], a[236:239], a[24:27], v[72:75]
    ds_read_b64_tr_b16 a[248:249], v213 offset:32768
    ds_read_b64_tr_b16 a[250:251], v213 offset:34816
    v_mfma_f32_16x16x32_bf16 v[104:107], a[236:239], a[28:31], v[104:107]
    v_mov_b32 v240, 0
    v_mov_b32 v241, 0
    v_mfma_f32_16x16x32_bf16 v[136:139], a[236:239], a[32:35], v[136:139]
    s_waitcnt lgkmcnt(8)
    v_mov_b32 v242, 0
    v_mfma_f32_16x16x32_bf16 v[44:47], a[240:243], a[20:23], v[44:47]
    s_add_u32 s54, s54, 0x40000
    s_cmp_eq_u32 s54, 3670016
    s_cselect_b32 s54, 0, s54
    v_mfma_f32_16x16x32_bf16 v[76:79], a[240:243], a[24:27], v[76:79]
    ds_read_b64_tr_b16 a[252:253], v213 offset:32776
    ds_read_b64_tr_b16 a[254:255], v213 offset:34824
    v_mfma_f32_16x16x32_bf16 v[108:111], a[240:243], a[28:31], v[108:111]
    v_mfma_f32_16x16x32_bf16 v[140:143], a[240:243], a[32:35], v[140:143]
    v_mfma_f32_16x16x32_bf16 v[156:159], a[240:243], a[36:39], v[156:159]
    s_waitcnt lgkmcnt(4)
    v_mfma_f32_16x16x32_bf16 v[48:51], a[244:247], a[20:23], v[48:51]
    ds_read_b64_tr_b16 a[224:225], v210 offset:49152
    ds_read_b64_tr_b16 a[226:227], v210 offset:51200
    v_mfma_f32_16x16x32_bf16 v[80:83], a[244:247], a[24:27], v[80:83]
    v_mfma_f32_16x16x32_bf16 v[112:115], a[244:247], a[28:31], v[112:115]
    v_mfma_f32_16x16x32_bf16 v[144:147], a[244:247], a[32:35], v[144:147]
    v_mfma_f32_16x16x32_bf16 v[160:163], a[244:247], a[36:39], v[160:163]
    s_waitcnt lgkmcnt(4)
    v_mfma_f32_16x16x32_bf16 v[52:55], a[248:251], a[20:23], v[52:55]
    ds_read_b64_tr_b16 a[228:229], v210 offset:49160
    ds_read_b64_tr_b16 a[230:231], v210 offset:51208
    v_mfma_f32_16x16x32_bf16 v[84:87], a[248:251], a[24:27], v[84:87]
    v_mfma_f32_16x16x32_bf16 v[116:119], a[248:251], a[28:31], v[116:119]
    v_mfma_f32_16x16x32_bf16 v[148:151], a[248:251], a[32:35], v[148:151]
    v_mfma_f32_16x16x32_bf16 v[164:167], a[248:251], a[36:39], v[164:167]
    s_waitcnt lgkmcnt(4)
    v_mfma_f32_16x16x32_bf16 v[56:59], a[252:255], a[20:23], v[56:59]
    ds_read_b64_tr_b16 a[232:233], v211 offset:49152
    ds_read_b64_tr_b16 a[234:235], v211 offset:51200
    v_mfma_f32_16x16x32_bf16 v[88:91], a[252:255], a[24:27], v[88:91]
    v_mfma_f32_16x16x32_bf16 v[120:123], a[252:255], a[28:31], v[120:123]
    v_mfma_f32_16x16x32_bf16 v[152:155], a[252:255], a[32:35], v[152:155]
    v_mfma_f32_16x16x32_bf16 v[168:171], a[252:255], a[36:39], v[168:171]
    s_barrier
    s_waitcnt lgkmcnt(4)
    v_mfma_f32_16x16x32_bf16 v[28:31], a[224:227], a[40:43], v[28:31]
    s_add_u32 m0, s29, 32768
    s_nop 0
    buffer_load_dwordx4 v205, s[8:11], s54 offen  lds
    v_mov_b32 v243, 0
    v_mfma_f32_16x16x32_bf16 v[60:63], a[224:227], a[44:47], v[60:63]
    ds_read_b64_tr_b16 a[236:237], v211 offset:49160
    ds_read_b64_tr_b16 a[238:239], v211 offset:51208
    v_mfma_f32_16x16x32_bf16 v[92:95], a[224:227], a[48:51], v[92:95]
    v_mov_b32 v244, 0
    v_mov_b32 v245, 0
    v_mfma_f32_16x16x32_bf16 v[124:127], a[224:227], a[52:55], v[124:127]
    s_waitcnt lgkmcnt(4)
    s_add_u32 s34, s54, 130048
    buffer_load_dwordx4 v205, s[8:11], s34 offen offset:1024  lds
    v_mfma_f32_16x16x32_bf16 v[32:35], a[228:231], a[40:43], v[32:35]
    ds_read_b64_tr_b16 a[240:241], v212 offset:49152
    ds_read_b64_tr_b16 a[242:243], v212 offset:51200
    v_mfma_f32_16x16x32_bf16 v[64:67], a[228:231], a[44:47], v[64:67]
    v_mov_b32 v246, 0
    v_mov_b32 v247, 0
    v_mfma_f32_16x16x32_bf16 v[96:99], a[228:231], a[48:51], v[96:99]
    v_mov_b32 v248, 0
    v_mov_b32 v249, 0
    v_mfma_f32_16x16x32_bf16 v[128:131], a[228:231], a[52:55], v[128:131]
    s_waitcnt lgkmcnt(4)
    s_add_u32 s34, s54, 30720
    buffer_load_dwordx4 v205, s[8:11], s34 offen offset:2048  lds
    v_mfma_f32_16x16x32_bf16 v[36:39], a[232:235], a[40:43], v[36:39]
    ds_read_b64_tr_b16 a[244:245], v212 offset:49160
    ds_read_b64_tr_b16 a[246:247], v212 offset:51208
    v_mfma_f32_16x16x32_bf16 v[68:71], a[232:235], a[44:47], v[68:71]
    v_mov_b32 v250, 0
    v_mov_b32 v251, 0
    v_mfma_f32_16x16x32_bf16 v[100:103], a[232:235], a[48:51], v[100:103]
    v_mfma_f32_16x16x32_bf16 v[132:135], a[232:235], a[52:55], v[132:135]
    s_waitcnt lgkmcnt(4)
    s_add_u32 s34, s54, 160768
    buffer_load_dwordx4 v205, s[8:11], s34 offen offset:3072  lds
    v_mfma_f32_16x16x32_bf16 v[40:43], a[236:239], a[40:43], v[40:43]
    ds_read_b64_tr_b16 a[248:249], v213 offset:49152
    ds_read_b64_tr_b16 a[250:251], v213 offset:51200
    v_mfma_f32_16x16x32_bf16 v[72:75], a[236:239], a[44:47], v[72:75]
    v_mfma_f32_16x16x32_bf16 v[104:107], a[236:239], a[48:51], v[104:107]
    v_mfma_f32_16x16x32_bf16 v[136:139], a[236:239], a[52:55], v[136:139]
    s_waitcnt lgkmcnt(4)
    v_mfma_f32_16x16x32_bf16 v[44:47], a[240:243], a[40:43], v[44:47]
    s_add_u32 s54, s54, 0x40000
    s_cmp_eq_u32 s54, 3670016
    s_cselect_b32 s54, 0, s54
    v_mfma_f32_16x16x32_bf16 v[76:79], a[240:243], a[44:47], v[76:79]
    s_add_u32 m0, s46, 40960
    s_add_u32 s34, s55, 0
    buffer_load_dwordx4 v204, s[4:7], s34 offen  lds
    v_mfma_f32_16x16x32_bf16 v[108:111], a[240:243], a[48:51], v[108:111]
    s_add_u32 m0, s46, 45056
    s_add_u32 s34, s55, 28672
    buffer_load_dwordx4 v204, s[4:7], s34 offen  lds
    v_mfma_f32_16x16x32_bf16 v[140:143], a[240:243], a[52:55], v[140:143]
    ds_read_b64_tr_b16 a[252:253], v213 offset:49160
    ds_read_b64_tr_b16 a[254:255], v213 offset:51208
    v_mfma_f32_16x16x32_bf16 v[156:159], a[240:243], a[56:59], v[156:159]
    s_waitcnt lgkmcnt(4)
    v_mfma_f32_16x16x32_bf16 v[48:51], a[244:247], a[40:43], v[48:51]
    ds_read_b64_tr_b16 a[224:225], v214 offset:16384
    ds_read_b64_tr_b16 a[226:227], v214 offset:18432
    v_mfma_f32_16x16x32_bf16 v[80:83], a[244:247], a[44:47], v[80:83]
    s_add_u32 m0, s46, 49152
    s_add_u32 s34, s55, 57344
    buffer_load_dwordx4 v204, s[4:7], s34 offen  lds
    v_mfma_f32_16x16x32_bf16 v[112:115], a[244:247], a[48:51], v[112:115]
    v_mfma_f32_16x16x32_bf16 v[144:147], a[244:247], a[52:55], v[144:147]
    v_mfma_f32_16x16x32_bf16 v[160:163], a[244:247], a[56:59], v[160:163]
    s_waitcnt lgkmcnt(4)
    v_mfma_f32_16x16x32_bf16 v[52:55], a[248:251], a[40:43], v[52:55]
    s_add_u32 m0, s46, 53248
    s_add_u32 s34, s55, 86016
    buffer_load_dwordx4 v204, s[4:7], s34 offen  lds
    v_mfma_f32_16x16x32_bf16 v[84:87], a[248:251], a[44:47], v[84:87]
    ds_read_b64_tr_b16 a[228:229], v214 offset:16392
    ds_read_b64_tr_b16 a[230:231], v214 offset:18440
    v_mfma_f32_16x16x32_bf16 v[116:119], a[248:251], a[48:51], v[116:119]
    v_mfma_f32_16x16x32_bf16 v[148:151], a[248:251], a[52:55], v[148:151]
    v_mfma_f32_16x16x32_bf16 v[164:167], a[248:251], a[56:59], v[164:167]
    s_waitcnt lgkmcnt(4)
    v_mfma_f32_16x16x32_bf16 v[56:59], a[252:255], a[40:43], v[56:59]
    s_add_u32 m0, s46, 57344
    s_add_u32 s34, s55, 114688
    buffer_load_dwordx4 v204, s[4:7], s34 offen  lds
    v_mfma_f32_16x16x32_bf16 v[88:91], a[252:255], a[44:47], v[88:91]
    ds_read_b64_tr_b16 a[232:233], v215 offset:16384
    ds_read_b64_tr_b16 a[234:235], v215 offset:18432
    v_mfma_f32_16x16x32_bf16 v[120:123], a[252:255], a[48:51], v[120:123]
    v_mfma_f32_16x16x32_bf16 v[152:155], a[252:255], a[52:55], v[152:155]
    s_add_u32 s55, s55, 128
    s_cmp_eq_u32 s55, 896
    s_cselect_b32 s55, 0, s55
    v_mfma_f32_16x16x32_bf16 v[168:171], a[252:255], a[56:59], v[168:171]
    s_waitcnt vmcnt(13)
    s_barrier
    s_waitcnt lgkmcnt(4)
    v_mfma_f32_16x16x32_bf16 v[28:31], a[224:227], a[60:63], v[28:31]
    s_add_u32 m0, s29, 49152
    s_nop 0
    buffer_load_dwordx4 v205, s[8:11], s54 offen  lds
    ds_read_b128 a[0:3], v206 offset:20480
    v_mfma_f32_16x16x32_bf16 v[60:63], a[224:227], a[64:67], v[60:63]
    ds_read_b64_tr_b16 a[236:237], v215 offset:16392
    ds_read_b64_tr_b16 a[238:239], v215 offset:18440
    v_mfma_f32_16x16x32_bf16 v[92:95], a[224:227], a[68:71], v[92:95]
    ds_read_b128 a[4:7], v206 offset:22528
    ds_read_b128 a[8:11], v206 offset:24576
    v_mfma_f32_16x16x32_bf16 v[124:127], a[224:227], a[72:75], v[124:127]
    s_waitcnt lgkmcnt(7)
    ds_read_b128 a[12:15], v206 offset:26624
    ds_read_b128 a[16:19], v208 offset:20480
    v_mfma_f32_16x16x32_bf16 v[32:35], a[228:231], a[60:63], v[32:35]
    s_add_u32 s34, s54, 130048
    buffer_load_dwordx4 v205, s[8:11], s34 offen offset:1024  lds
    ds_read_b128 a[20:23], v207 offset:20480
    v_mfma_f32_16x16x32_bf16 v[64:67], a[228:231], a[64:67], v[64:67]
    ds_read_b64_tr_b16 a[240:241], v216 offset:16384
    ds_read_b64_tr_b16 a[242:243], v216 offset:18432
    v_mfma_f32_16x16x32_bf16 v[96:99], a[228:231], a[68:71], v[96:99]
    ds_read_b128 a[24:27], v207 offset:22528
    ds_read_b128 a[28:31], v207 offset:24576
    v_mfma_f32_16x16x32_bf16 v[128:131], a[228:231], a[72:75], v[128:131]
    s_waitcnt lgkmcnt(12)
    ds_read_b128 a[32:35], v207 offset:26624
    ds_read_b128 a[36:39], v209 offset:20480
    v_mfma_f32_16x16x32_bf16 v[36:39], a[232:235], a[60:63], v[36:39]
    s_add_u32 s34, s54, 30720
    buffer_load_dwordx4 v205, s[8:11], s34 offen offset:2048  lds
    v_mov_b32 v252, 0
    v_mfma_f32_16x16x32_bf16 v[68:71], a[232:235], a[64:67], v[68:71]
    ds_read_b64_tr_b16 a[244:245], v216 offset:16392
    s_waitcnt lgkmcnt(14)
    ds_read_b64_tr_b16 a[246:247], v216 offset:18440
    v_mfma_f32_16x16x32_bf16 v[100:103], a[232:235], a[68:71], v[100:103]
    v_mov_b32 v253, 0
    v_mov_b32 v254, 0
    v_mfma_f32_16x16x32_bf16 v[132:135], a[232:235], a[72:75], v[132:135]
    s_waitcnt lgkmcnt(13)
    v_mov_b32 v255, 0
    v_accvgpr_write_b32 a160, 0
    v_mfma_f32_16x16x32_bf16 v[40:43], a[236:239], a[60:63], v[40:43]
    s_add_u32 s34, s54, 160768
    buffer_load_dwordx4 v205, s[8:11], s34 offen offset:3072  lds
    v_accvgpr_write_b32 a161, 0
    v_mfma_f32_16x16x32_bf16 v[72:75], a[236:239], a[64:67], v[72:75]
    ds_read_b64_tr_b16 a[248:249], v217 offset:16384
    ds_read_b64_tr_b16 a[250:251], v217 offset:18432
    v_mfma_f32_16x16x32_bf16 v[104:107], a[236:239], a[68:71], v[104:107]
    v_accvgpr_write_b32 a162, 0
    v_accvgpr_write_b32 a163, 0
    v_mfma_f32_16x16x32_bf16 v[136:139], a[236:239], a[72:75], v[136:139]
    s_waitcnt lgkmcnt(8)
    v_accvgpr_write_b32 a164, 0
    v_mfma_f32_16x16x32_bf16 v[44:47], a[240:243], a[60:63], v[44:47]
    s_add_u32 s54, s54, 0x40000
    s_cmp_eq_u32 s54, 3670016
    s_cselect_b32 s54, 0, s54
    v_mfma_f32_16x16x32_bf16 v[76:79], a[240:243], a[64:67], v[76:79]
    ds_read_b64_tr_b16 a[252:253], v217 offset:16392
    ds_read_b64_tr_b16 a[254:255], v217 offset:18440
    v_mfma_f32_16x16x32_bf16 v[108:111], a[240:243], a[68:71], v[108:111]
    v_mfma_f32_16x16x32_bf16 v[140:143], a[240:243], a[72:75], v[140:143]
    v_mfma_f32_16x16x32_bf16 v[156:159], a[240:243], a[76:79], v[156:159]
    s_waitcnt lgkmcnt(4)
    v_mfma_f32_16x16x32_bf16 v[48:51], a[244:247], a[60:63], v[48:51]
    ds_read_b64_tr_b16 a[224:225], v210 offset:0
    ds_read_b64_tr_b16 a[226:227], v210 offset:2048
    v_mfma_f32_16x16x32_bf16 v[80:83], a[244:247], a[64:67], v[80:83]
    v_mfma_f32_16x16x32_bf16 v[112:115], a[244:247], a[68:71], v[112:115]
    v_mfma_f32_16x16x32_bf16 v[144:147], a[244:247], a[72:75], v[144:147]
    v_mfma_f32_16x16x32_bf16 v[160:163], a[244:247], a[76:79], v[160:163]
    s_waitcnt lgkmcnt(4)
    v_mfma_f32_16x16x32_bf16 v[52:55], a[248:251], a[60:63], v[52:55]
    ds_read_b64_tr_b16 a[228:229], v210 offset:8
    ds_read_b64_tr_b16 a[230:231], v210 offset:2056
    v_mfma_f32_16x16x32_bf16 v[84:87], a[248:251], a[64:67], v[84:87]
    v_mfma_f32_16x16x32_bf16 v[116:119], a[248:251], a[68:71], v[116:119]
    v_mfma_f32_16x16x32_bf16 v[148:151], a[248:251], a[72:75], v[148:151]
    v_mfma_f32_16x16x32_bf16 v[164:167], a[248:251], a[76:79], v[164:167]
    s_waitcnt lgkmcnt(4)
    v_mfma_f32_16x16x32_bf16 v[56:59], a[252:255], a[60:63], v[56:59]
    ds_read_b64_tr_b16 a[232:233], v211 offset:0
    ds_read_b64_tr_b16 a[234:235], v211 offset:2048
    v_mfma_f32_16x16x32_bf16 v[88:91], a[252:255], a[64:67], v[88:91]
    v_mfma_f32_16x16x32_bf16 v[120:123], a[252:255], a[68:71], v[120:123]
    v_mfma_f32_16x16x32_bf16 v[152:155], a[252:255], a[72:75], v[152:155]
    v_mfma_f32_16x16x32_bf16 v[168:171], a[252:255], a[76:79], v[168:171]
    s_barrier
    s_waitcnt lgkmcnt(4)
    v_mfma_f32_16x16x32_bf16 v[28:31], a[224:227], a[0:3], v[28:31]
    s_add_u32 m0, s29, 81920
    s_nop 0
    buffer_load_dwordx4 v205, s[8:11], s54 offen  lds
    v_accvgpr_write_b32 a165, 0
    v_mfma_f32_16x16x32_bf16 v[60:63], a[224:227], a[4:7], v[60:63]
    ds_read_b64_tr_b16 a[236:237], v211 offset:8
    ds_read_b64_tr_b16 a[238:239], v211 offset:2056
    v_mfma_f32_16x16x32_bf16 v[92:95], a[224:227], a[8:11], v[92:95]
    v_accvgpr_write_b32 a166, 0
    v_accvgpr_write_b32 a167, 0
    v_mfma_f32_16x16x32_bf16 v[124:127], a[224:227], a[12:15], v[124:127]
    s_waitcnt lgkmcnt(4)
    s_add_u32 s34, s54, 130048
    buffer_load_dwordx4 v205, s[8:11], s34 offen offset:1024  lds
    v_mfma_f32_16x16x32_bf16 v[32:35], a[228:231], a[0:3], v[32:35]
    ds_read_b64_tr_b16 a[240:241], v212 offset:0
    ds_read_b64_tr_b16 a[242:243], v212 offset:2048
    v_mfma_f32_16x16x32_bf16 v[64:67], a[228:231], a[4:7], v[64:67]
    v_accvgpr_write_b32 a168, 0
    v_accvgpr_write_b32 a169, 0
    v_mfma_f32_16x16x32_bf16 v[96:99], a[228:231], a[8:11], v[96:99]
    v_accvgpr_write_b32 a170, 0
    v_accvgpr_write_b32 a171, 0
    v_mfma_f32_16x16x32_bf16 v[128:131], a[228:231], a[12:15], v[128:131]
    s_waitcnt lgkmcnt(4)
    s_add_u32 s34, s54, 30720
    buffer_load_dwordx4 v205, s[8:11], s34 offen offset:2048  lds
    v_mfma_f32_16x16x32_bf16 v[36:39], a[232:235], a[0:3], v[36:39]
    ds_read_b64_tr_b16 a[244:245], v212 offset:8
    ds_read_b64_tr_b16 a[246:247], v212 offset:2056
    v_mfma_f32_16x16x32_bf16 v[68:71], a[232:235], a[4:7], v[68:71]
    v_accvgpr_write_b32 a172, 0
    v_accvgpr_write_b32 a173, 0
    v_mfma_f32_16x16x32_bf16 v[100:103], a[232:235], a[8:11], v[100:103]
    v_mfma_f32_16x16x32_bf16 v[132:135], a[232:235], a[12:15], v[132:135]
    s_waitcnt lgkmcnt(4)
    s_add_u32 s34, s54, 160768
    buffer_load_dwordx4 v205, s[8:11], s34 offen offset:3072  lds
    v_mfma_f32_16x16x32_bf16 v[40:43], a[236:239], a[0:3], v[40:43]
    ds_read_b64_tr_b16 a[248:249], v213 offset:0
    ds_read_b64_tr_b16 a[250:251], v213 offset:2048
    v_mfma_f32_16x16x32_bf16 v[72:75], a[236:239], a[4:7], v[72:75]
    v_mfma_f32_16x16x32_bf16 v[104:107], a[236:239], a[8:11], v[104:107]
    v_mfma_f32_16x16x32_bf16 v[136:139], a[236:239], a[12:15], v[136:139]
    s_waitcnt lgkmcnt(4)
    v_mfma_f32_16x16x32_bf16 v[44:47], a[240:243], a[0:3], v[44:47]
    s_add_u32 s54, s54, 0x40000
    s_cmp_eq_u32 s54, 3670016
    s_cselect_b32 s54, 0, s54
    v_mfma_f32_16x16x32_bf16 v[76:79], a[240:243], a[4:7], v[76:79]
    s_add_u32 m0, s46, 0
    s_add_u32 s34, s55, 0
    buffer_load_dwordx4 v204, s[4:7], s34 offen  lds
    v_mfma_f32_16x16x32_bf16 v[108:111], a[240:243], a[8:11], v[108:111]
    s_add_u32 m0, s46, 4096
    s_add_u32 s34, s55, 28672
    buffer_load_dwordx4 v204, s[4:7], s34 offen  lds
    v_mfma_f32_16x16x32_bf16 v[140:143], a[240:243], a[12:15], v[140:143]
    ds_read_b64_tr_b16 a[252:253], v213 offset:8
    ds_read_b64_tr_b16 a[254:255], v213 offset:2056
    v_mfma_f32_16x16x32_bf16 v[156:159], a[240:243], a[16:19], v[156:159]
    s_waitcnt lgkmcnt(4)
    v_mfma_f32_16x16x32_bf16 v[48:51], a[244:247], a[0:3], v[48:51]
    ds_read_b64_tr_b16 a[224:225], v210 offset:16384
    ds_read_b64_tr_b16 a[226:227], v210 offset:18432
    v_mfma_f32_16x16x32_bf16 v[80:83], a[244:247], a[4:7], v[80:83]
    s_add_u32 m0, s46, 8192
    s_add_u32 s34, s55, 57344
    buffer_load_dwordx4 v204, s[4:7], s34 offen  lds
    v_mfma_f32_16x16x32_bf16 v[112:115], a[244:247], a[8:11], v[112:115]
    v_mfma_f32_16x16x32_bf16 v[144:147], a[244:247], a[12:15], v[144:147]
    v_mfma_f32_16x16x32_bf16 v[160:163], a[244:247], a[16:19], v[160:163]
    s_waitcnt lgkmcnt(4)
    v_mfma_f32_16x16x32_bf16 v[52:55], a[248:251], a[0:3], v[52:55]
    s_add_u32 m0, s46, 12288
    s_add_u32 s34, s55, 86016
    buffer_load_dwordx4 v204, s[4:7], s34 offen  lds
    v_mfma_f32_16x16x32_bf16 v[84:87], a[248:251], a[4:7], v[84:87]
    ds_read_b64_tr_b16 a[228:229], v210 offset:16392
    ds_read_b64_tr_b16 a[230:231], v210 offset:18440
    v_mfma_f32_16x16x32_bf16 v[116:119], a[248:251], a[8:11], v[116:119]
    v_mfma_f32_16x16x32_bf16 v[148:151], a[248:251], a[12:15], v[148:151]
    v_mfma_f32_16x16x32_bf16 v[164:167], a[248:251], a[16:19], v[164:167]
    s_waitcnt lgkmcnt(4)
    v_mfma_f32_16x16x32_bf16 v[56:59], a[252:255], a[0:3], v[56:59]
    s_add_u32 m0, s46, 16384
    s_add_u32 s34, s55, 114688
    buffer_load_dwordx4 v204, s[4:7], s34 offen  lds
    v_mfma_f32_16x16x32_bf16 v[88:91], a[252:255], a[4:7], v[88:91]
    ds_read_b64_tr_b16 a[232:233], v211 offset:16384
    ds_read_b64_tr_b16 a[234:235], v211 offset:18432
    v_mfma_f32_16x16x32_bf16 v[120:123], a[252:255], a[8:11], v[120:123]
    v_mfma_f32_16x16x32_bf16 v[152:155], a[252:255], a[12:15], v[152:155]
    s_add_u32 s55, s55, 128
    s_cmp_eq_u32 s55, 896
    s_cselect_b32 s55, 0, s55
    v_mfma_f32_16x16x32_bf16 v[168:171], a[252:255], a[16:19], v[168:171]
    s_waitcnt vmcnt(13)
    s_barrier
    s_waitcnt lgkmcnt(4)
    v_mfma_f32_16x16x32_bf16 v[28:31], a[224:227], a[20:23], v[28:31]
    s_add_u32 m0, s29, 0
    s_nop 0
    buffer_load_dwordx4 v0, s[12:15], s32 offen offset:0 nt lds
    ds_read_b128 a[40:43], v206 offset:40960
    v_mfma_f32_16x16x32_bf16 v[60:63], a[224:227], a[24:27], v[60:63]
    ds_read_b64_tr_b16 a[236:237], v211 offset:16392
    ds_read_b64_tr_b16 a[238:239], v211 offset:18440
    v_mfma_f32_16x16x32_bf16 v[92:95], a[224:227], a[28:31], v[92:95]
    ds_read_b128 a[44:47], v206 offset:43008
    ds_read_b128 a[48:51], v206 offset:45056
    v_mfma_f32_16x16x32_bf16 v[124:127], a[224:227], a[32:35], v[124:127]
    s_waitcnt lgkmcnt(7)
    ds_read_b128 a[52:55], v206 offset:47104
    ds_read_b128 a[56:59], v208 offset:40960
    v_mfma_f32_16x16x32_bf16 v[32:35], a[228:231], a[20:23], v[32:35]
    ds_read_b64_tr_b16 a[240:241], v212 offset:16384
    ds_read_b64_tr_b16 a[242:243], v212 offset:18432
    v_mfma_f32_16x16x32_bf16 v[64:67], a[228:231], a[24:27], v[64:67]
    buffer_load_dwordx4 v0, s[12:15], s32 offen offset:1024 nt lds
    ds_read_b128 a[60:63], v207 offset:40960
    v_mfma_f32_16x16x32_bf16 v[96:99], a[228:231], a[28:31], v[96:99]
    ds_read_b128 a[64:67], v207 offset:43008
    ds_read_b128 a[68:71], v207 offset:45056
    v_mfma_f32_16x16x32_bf16 v[128:131], a[228:231], a[32:35], v[128:131]
    s_waitcnt lgkmcnt(12)
    ds_read_b128 a[72:75], v207 offset:47104
    ds_read_b128 a[76:79], v209 offset:40960
    v_mfma_f32_16x16x32_bf16 v[36:39], a[232:235], a[20:23], v[36:39]
    ds_read_b64_tr_b16 a[244:245], v212 offset:16392
    s_waitcnt lgkmcnt(14)
    ds_read_b64_tr_b16 a[246:247], v212 offset:18440
    v_mfma_f32_16x16x32_bf16 v[68:71], a[232:235], a[24:27], v[68:71]
    buffer_load_dwordx4 v0, s[12:15], s32 offen offset:2048 nt lds
    v_accvgpr_write_b32 a174, 0
    v_mfma_f32_16x16x32_bf16 v[100:103], a[232:235], a[28:31], v[100:103]
    v_accvgpr_write_b32 a175, 0
    v_accvgpr_write_b32 a176, 0
    v_mfma_f32_16x16x32_bf16 v[132:135], a[232:235], a[32:35], v[132:135]
    s_waitcnt lgkmcnt(13)
    v_accvgpr_write_b32 a177, 0
    v_accvgpr_write_b32 a178, 0
    v_mfma_f32_16x16x32_bf16 v[40:43], a[236:239], a[20:23], v[40:43]
    ds_read_b64_tr_b16 a[248:249], v213 offset:16384
    ds_read_b64_tr_b16 a[250:251], v213 offset:18432
    v_mfma_f32_16x16x32_bf16 v[72:75], a[236:239], a[24:27], v[72:75]
    buffer_load_dwordx4 v0, s[12:15], s32 offen offset:3072 nt lds
    v_accvgpr_write_b32 a179, 0
    v_mfma_f32_16x16x32_bf16 v[104:107], a[236:239], a[28:31], v[104:107]
    v_accvgpr_write_b32 a180, 0
    v_accvgpr_write_b32 a181, 0
    v_mfma_f32_16x16x32_bf16 v[136:139], a[236:239], a[32:35], v[136:139]
    s_waitcnt lgkmcnt(9)
    v_accvgpr_write_b32 a182, 0
    v_mfma_f32_16x16x32_bf16 v[44:47], a[240:243], a[20:23], v[44:47]
    s_add_u32 s32, s32, 16384
    ds_read_b64_tr_b16 a[252:253], v213 offset:16392
    ds_read_b64_tr_b16 a[254:255], v213 offset:18440
    v_mfma_f32_16x16x32_bf16 v[76:79], a[240:243], a[24:27], v[76:79]
    v_mfma_f32_16x16x32_bf16 v[108:111], a[240:243], a[28:31], v[108:111]
    v_mfma_f32_16x16x32_bf16 v[140:143], a[240:243], a[32:35], v[140:143]
    v_mfma_f32_16x16x32_bf16 v[156:159], a[240:243], a[36:39], v[156:159]
    s_waitcnt lgkmcnt(4)
    v_mfma_f32_16x16x32_bf16 v[48:51], a[244:247], a[20:23], v[48:51]
    ds_read_b64_tr_b16 a[224:225], v214 offset:0
    ds_read_b64_tr_b16 a[226:227], v214 offset:2048
    v_mfma_f32_16x16x32_bf16 v[80:83], a[244:247], a[24:27], v[80:83]
    v_mfma_f32_16x16x32_bf16 v[112:115], a[244:247], a[28:31], v[112:115]
    v_mfma_f32_16x16x32_bf16 v[144:147], a[244:247], a[32:35], v[144:147]
    v_mfma_f32_16x16x32_bf16 v[160:163], a[244:247], a[36:39], v[160:163]
    s_waitcnt lgkmcnt(4)
    v_mfma_f32_16x16x32_bf16 v[52:55], a[248:251], a[20:23], v[52:55]
    ds_read_b64_tr_b16 a[228:229], v214 offset:8
    ds_read_b64_tr_b16 a[230:231], v214 offset:2056
    v_mfma_f32_16x16x32_bf16 v[84:87], a[248:251], a[24:27], v[84:87]
    v_mfma_f32_16x16x32_bf16 v[116:119], a[248:251], a[28:31], v[116:119]
    v_mfma_f32_16x16x32_bf16 v[148:151], a[248:251], a[32:35], v[148:151]
    v_mfma_f32_16x16x32_bf16 v[164:167], a[248:251], a[36:39], v[164:167]
    s_waitcnt lgkmcnt(4)
    v_mfma_f32_16x16x32_bf16 v[56:59], a[252:255], a[20:23], v[56:59]
    ds_read_b64_tr_b16 a[232:233], v215 offset:0
    ds_read_b64_tr_b16 a[234:235], v215 offset:2048
    v_mfma_f32_16x16x32_bf16 v[88:91], a[252:255], a[24:27], v[88:91]
    v_mfma_f32_16x16x32_bf16 v[120:123], a[252:255], a[28:31], v[120:123]
    v_mfma_f32_16x16x32_bf16 v[152:155], a[252:255], a[32:35], v[152:155]
    v_mfma_f32_16x16x32_bf16 v[168:171], a[252:255], a[36:39], v[168:171]
    s_barrier
    s_waitcnt lgkmcnt(4)
    v_mfma_f32_16x16x32_bf16 v[28:31], a[224:227], a[40:43], v[28:31]
    s_add_u32 m0, s29, 16384
    s_nop 0
    buffer_load_dwordx4 v0, s[12:15], s32 offen offset:0 nt lds
    v_accvgpr_write_b32 a183, 0
    v_mfma_f32_16x16x32_bf16 v[60:63], a[224:227], a[44:47], v[60:63]
    ds_read_b64_tr_b16 a[236:237], v215 offset:8
    ds_read_b64_tr_b16 a[238:239], v215 offset:2056
    v_mfma_f32_16x16x32_bf16 v[92:95], a[224:227], a[48:51], v[92:95]
    v_accvgpr_write_b32 a184, 0
    v_accvgpr_write_b32 a185, 0
    v_mfma_f32_16x16x32_bf16 v[124:127], a[224:227], a[52:55], v[124:127]
    s_waitcnt lgkmcnt(4)
    v_accvgpr_write_b32 a186, 0
    v_accvgpr_write_b32 a187, 0
    v_mfma_f32_16x16x32_bf16 v[32:35], a[228:231], a[40:43], v[32:35]
    ds_read_b64_tr_b16 a[240:241], v216 offset:0
    ds_read_b64_tr_b16 a[242:243], v216 offset:2048
    v_mfma_f32_16x16x32_bf16 v[64:67], a[228:231], a[44:47], v[64:67]
    buffer_load_dwordx4 v0, s[12:15], s32 offen offset:1024 nt lds
    v_accvgpr_write_b32 a188, 0
    v_mfma_f32_16x16x32_bf16 v[96:99], a[228:231], a[48:51], v[96:99]
    v_accvgpr_write_b32 a189, 0
    v_accvgpr_write_b32 a190, 0
    v_mfma_f32_16x16x32_bf16 v[128:131], a[228:231], a[52:55], v[128:131]
    s_waitcnt lgkmcnt(4)
    v_accvgpr_write_b32 a191, 0
    v_mfma_f32_16x16x32_bf16 v[36:39], a[232:235], a[40:43], v[36:39]
    ds_read_b64_tr_b16 a[244:245], v216 offset:8
    ds_read_b64_tr_b16 a[246:247], v216 offset:2056
    v_mfma_f32_16x16x32_bf16 v[68:71], a[232:235], a[44:47], v[68:71]
    buffer_load_dwordx4 v0, s[12:15], s32 offen offset:2048 nt lds
    v_mfma_f32_16x16x32_bf16 v[100:103], a[232:235], a[48:51], v[100:103]
    v_mfma_f32_16x16x32_bf16 v[132:135], a[232:235], a[52:55], v[132:135]
    s_waitcnt lgkmcnt(4)
    v_mfma_f32_16x16x32_bf16 v[40:43], a[236:239], a[40:43], v[40:43]
    ds_read_b64_tr_b16 a[248:249], v217 offset:0
    ds_read_b64_tr_b16 a[250:251], v217 offset:2048
    v_mfma_f32_16x16x32_bf16 v[72:75], a[236:239], a[44:47], v[72:75]
    buffer_load_dwordx4 v0, s[12:15], s32 offen offset:3072 nt lds
    v_mfma_f32_16x16x32_bf16 v[104:107], a[236:239], a[48:51], v[104:107]
    v_mfma_f32_16x16x32_bf16 v[136:139], a[236:239], a[52:55], v[136:139]
    s_waitcnt lgkmcnt(4)
    v_mfma_f32_16x16x32_bf16 v[44:47], a[240:243], a[40:43], v[44:47]
    s_add_u32 s32, s32, 16384
    ds_read_b64_tr_b16 a[252:253], v217 offset:8
    ds_read_b64_tr_b16 a[254:255], v217 offset:2056
    v_mfma_f32_16x16x32_bf16 v[76:79], a[240:243], a[44:47], v[76:79]
    v_mfma_f32_16x16x32_bf16 v[108:111], a[240:243], a[48:51], v[108:111]
    v_mfma_f32_16x16x32_bf16 v[140:143], a[240:243], a[52:55], v[140:143]
    v_mfma_f32_16x16x32_bf16 v[156:159], a[240:243], a[56:59], v[156:159]
    s_waitcnt lgkmcnt(4)
    v_mfma_f32_16x16x32_bf16 v[48:51], a[244:247], a[40:43], v[48:51]
    ds_read_b64_tr_b16 a[224:225], v210 offset:32768
    ds_read_b64_tr_b16 a[226:227], v210 offset:34816
    v_mfma_f32_16x16x32_bf16 v[80:83], a[244:247], a[44:47], v[80:83]
    v_mfma_f32_16x16x32_bf16 v[112:115], a[244:247], a[48:51], v[112:115]
    v_mfma_f32_16x16x32_bf16 v[144:147], a[244:247], a[52:55], v[144:147]
    v_mfma_f32_16x16x32_bf16 v[160:163], a[244:247], a[56:59], v[160:163]
    s_waitcnt lgkmcnt(4)
    v_mfma_f32_16x16x32_bf16 v[52:55], a[248:251], a[40:43], v[52:55]
    ds_read_b64_tr_b16 a[228:229], v210 offset:32776
    ds_read_b64_tr_b16 a[230:231], v210 offset:34824
    v_mfma_f32_16x16x32_bf16 v[84:87], a[248:251], a[44:47], v[84:87]
    v_mfma_f32_16x16x32_bf16 v[116:119], a[248:251], a[48:51], v[116:119]
    v_mfma_f32_16x16x32_bf16 v[148:151], a[248:251], a[52:55], v[148:151]
    v_mfma_f32_16x16x32_bf16 v[164:167], a[248:251], a[56:59], v[164:167]
    s_waitcnt lgkmcnt(4)
    v_mfma_f32_16x16x32_bf16 v[56:59], a[252:255], a[40:43], v[56:59]
    ds_read_b64_tr_b16 a[232:233], v211 offset:32768
    ds_read_b64_tr_b16 a[234:235], v211 offset:34816
    v_mfma_f32_16x16x32_bf16 v[88:91], a[252:255], a[44:47], v[88:91]
    v_mfma_f32_16x16x32_bf16 v[120:123], a[252:255], a[48:51], v[120:123]
    v_mfma_f32_16x16x32_bf16 v[152:155], a[252:255], a[52:55], v[152:155]
    v_mfma_f32_16x16x32_bf16 v[168:171], a[252:255], a[56:59], v[168:171]
    s_waitcnt vmcnt(8)
    s_barrier
    s_waitcnt lgkmcnt(4)
    v_mfma_f32_16x16x32_bf16 v[28:31], a[224:227], a[60:63], v[28:31]
    s_add_u32 m0, s29, 65536
    s_nop 0
    buffer_load_dwordx4 v0, s[16:19], s33 offen offset:0 nt lds
    ds_read_b128 a[0:3], v206 offset:0
    v_mfma_f32_16x16x32_bf16 v[60:63], a[224:227], a[64:67], v[60:63]
    ds_read_b64_tr_b16 a[236:237], v211 offset:32776
    ds_read_b64_tr_b16 a[238:239], v211 offset:34824
    v_mfma_f32_16x16x32_bf16 v[92:95], a[224:227], a[68:71], v[92:95]
    ds_read_b128 a[4:7], v206 offset:2048
    ds_read_b128 a[8:11], v206 offset:4096
    v_mfma_f32_16x16x32_bf16 v[124:127], a[224:227], a[72:75], v[124:127]
    s_waitcnt lgkmcnt(7)
    ds_read_b128 a[12:15], v206 offset:6144
    ds_read_b128 a[16:19], v208 offset:0
    v_mfma_f32_16x16x32_bf16 v[32:35], a[228:231], a[60:63], v[32:35]
    ds_read_b64_tr_b16 a[240:241], v212 offset:32768
    ds_read_b64_tr_b16 a[242:243], v212 offset:34816
    v_mfma_f32_16x16x32_bf16 v[64:67], a[228:231], a[64:67], v[64:67]
    buffer_load_dwordx4 v0, s[16:19], s33 offen offset:1024 nt lds
    ds_read_b128 a[20:23], v207 offset:0
    v_mfma_f32_16x16x32_bf16 v[96:99], a[228:231], a[68:71], v[96:99]
    ds_read_b128 a[24:27], v207 offset:2048
    ds_read_b128 a[28:31], v207 offset:4096
    v_mfma_f32_16x16x32_bf16 v[128:131], a[228:231], a[72:75], v[128:131]
    s_waitcnt lgkmcnt(12)
    ds_read_b128 a[32:35], v207 offset:6144
    ds_read_b128 a[36:39], v209 offset:0
    v_mfma_f32_16x16x32_bf16 v[36:39], a[232:235], a[60:63], v[36:39]
    ds_read_b64_tr_b16 a[244:245], v212 offset:32776
    s_waitcnt lgkmcnt(14)
    ds_read_b64_tr_b16 a[246:247], v212 offset:34824
    v_mfma_f32_16x16x32_bf16 v[68:71], a[232:235], a[64:67], v[68:71]
    buffer_load_dwordx4 v0, s[16:19], s33 offen offset:2048 nt lds
    v_mfma_f32_16x16x32_bf16 v[100:103], a[232:235], a[68:71], v[100:103]
    v_mfma_f32_16x16x32_bf16 v[132:135], a[232:235], a[72:75], v[132:135]
    s_waitcnt lgkmcnt(13)
    v_mfma_f32_16x16x32_bf16 v[40:43], a[236:239], a[60:63], v[40:43]
    ds_read_b64_tr_b16 a[248:249], v213 offset:32768
    ds_read_b64_tr_b16 a[250:251], v213 offset:34816
    v_mfma_f32_16x16x32_bf16 v[72:75], a[236:239], a[64:67], v[72:75]
    buffer_load_dwordx4 v0, s[16:19], s33 offen offset:3072 nt lds
    v_mfma_f32_16x16x32_bf16 v[104:107], a[236:239], a[68:71], v[104:107]
    v_mfma_f32_16x16x32_bf16 v[136:139], a[236:239], a[72:75], v[136:139]
    s_waitcnt lgkmcnt(9)
    v_mfma_f32_16x16x32_bf16 v[44:47], a[240:243], a[60:63], v[44:47]
    s_add_u32 s33, s33, 16384
    ds_read_b64_tr_b16 a[252:253], v213 offset:32776
    ds_read_b64_tr_b16 a[254:255], v213 offset:34824
    v_mfma_f32_16x16x32_bf16 v[76:79], a[240:243], a[64:67], v[76:79]
    v_mfma_f32_16x16x32_bf16 v[108:111], a[240:243], a[68:71], v[108:111]
    v_mfma_f32_16x16x32_bf16 v[140:143], a[240:243], a[72:75], v[140:143]
    v_mfma_f32_16x16x32_bf16 v[156:159], a[240:243], a[76:79], v[156:159]
    s_waitcnt lgkmcnt(4)
    v_mfma_f32_16x16x32_bf16 v[48:51], a[244:247], a[60:63], v[48:51]
    ds_read_b64_tr_b16 a[224:225], v210 offset:49152
    ds_read_b64_tr_b16 a[226:227], v210 offset:51200
    v_mfma_f32_16x16x32_bf16 v[80:83], a[244:247], a[64:67], v[80:83]
    v_mfma_f32_16x16x32_bf16 v[112:115], a[244:247], a[68:71], v[112:115]
    v_mfma_f32_16x16x32_bf16 v[144:147], a[244:247], a[72:75], v[144:147]
    v_mfma_f32_16x16x32_bf16 v[160:163], a[244:247], a[76:79], v[160:163]
    s_waitcnt lgkmcnt(4)
    v_mfma_f32_16x16x32_bf16 v[52:55], a[248:251], a[60:63], v[52:55]
    ds_read_b64_tr_b16 a[228:229], v210 offset:49160
    ds_read_b64_tr_b16 a[230:231], v210 offset:51208
    v_mfma_f32_16x16x32_bf16 v[84:87], a[248:251], a[64:67], v[84:87]
    v_mfma_f32_16x16x32_bf16 v[116:119], a[248:251], a[68:71], v[116:119]
    v_mfma_f32_16x16x32_bf16 v[148:151], a[248:251], a[72:75], v[148:151]
    v_mfma_f32_16x16x32_bf16 v[164:167], a[248:251], a[76:79], v[164:167]
    s_waitcnt lgkmcnt(4)
    v_mfma_f32_16x16x32_bf16 v[56:59], a[252:255], a[60:63], v[56:59]
    ds_read_b64_tr_b16 a[232:233], v211 offset:49152
    ds_read_b64_tr_b16 a[234:235], v211 offset:51200
    v_mfma_f32_16x16x32_bf16 v[88:91], a[252:255], a[64:67], v[88:91]
    v_mfma_f32_16x16x32_bf16 v[120:123], a[252:255], a[68:71], v[120:123]
    v_mfma_f32_16x16x32_bf16 v[152:155], a[252:255], a[72:75], v[152:155]
    v_mfma_f32_16x16x32_bf16 v[168:171], a[252:255], a[76:79], v[168:171]
    s_barrier
    s_waitcnt lgkmcnt(4)
    v_mfma_f32_16x16x32_bf16 v[28:31], a[224:227], a[0:3], v[28:31]
    s_add_u32 m0, s29, 32768
    s_nop 0
    buffer_load_dwordx4 v0, s[12:15], s32 offen offset:0 nt lds
    v_mfma_f32_16x16x32_bf16 v[60:63], a[224:227], a[4:7], v[60:63]
    ds_read_b64_tr_b16 a[236:237], v211 offset:49160
    ds_read_b64_tr_b16 a[238:239], v211 offset:51208
    v_mfma_f32_16x16x32_bf16 v[92:95], a[224:227], a[8:11], v[92:95]
    v_mfma_f32_16x16x32_bf16 v[124:127], a[224:227], a[12:15], v[124:127]
    s_waitcnt lgkmcnt(4)
    v_mfma_f32_16x16x32_bf16 v[32:35], a[228:231], a[0:3], v[32:35]
    ds_read_b64_tr_b16 a[240:241], v212 offset:49152
    ds_read_b64_tr_b16 a[242:243], v212 offset:51200
    v_mfma_f32_16x16x32_bf16 v[64:67], a[228:231], a[4:7], v[64:67]
    buffer_load_dwordx4 v0, s[12:15], s32 offen offset:1024 nt lds
    v_mfma_f32_16x16x32_bf16 v[96:99], a[228:231], a[8:11], v[96:99]
    v_mfma_f32_16x16x32_bf16 v[128:131], a[228:231], a[12:15], v[128:131]
    s_waitcnt lgkmcnt(4)
    v_mfma_f32_16x16x32_bf16 v[36:39], a[232:235], a[0:3], v[36:39]
    ds_read_b64_tr_b16 a[244:245], v212 offset:49160
    ds_read_b64_tr_b16 a[246:247], v212 offset:51208
    v_mfma_f32_16x16x32_bf16 v[68:71], a[232:235], a[4:7], v[68:71]
    buffer_load_dwordx4 v0, s[12:15], s32 offen offset:2048 nt lds
    v_mfma_f32_16x16x32_bf16 v[100:103], a[232:235], a[8:11], v[100:103]
    v_mfma_f32_16x16x32_bf16 v[132:135], a[232:235], a[12:15], v[132:135]
    s_waitcnt lgkmcnt(4)
    v_mfma_f32_16x16x32_bf16 v[40:43], a[236:239], a[0:3], v[40:43]
    ds_read_b64_tr_b16 a[248:249], v213 offset:49152
    ds_read_b64_tr_b16 a[250:251], v213 offset:51200
    v_mfma_f32_16x16x32_bf16 v[72:75], a[236:239], a[4:7], v[72:75]
    buffer_load_dwordx4 v0, s[12:15], s32 offen offset:3072 nt lds
    v_mfma_f32_16x16x32_bf16 v[104:107], a[236:239], a[8:11], v[104:107]
    v_mfma_f32_16x16x32_bf16 v[136:139], a[236:239], a[12:15], v[136:139]
    s_waitcnt lgkmcnt(4)
    v_mfma_f32_16x16x32_bf16 v[44:47], a[240:243], a[0:3], v[44:47]
    s_add_u32 s32, s32, 16384
    ds_read_b64_tr_b16 a[252:253], v213 offset:49160
    ds_read_b64_tr_b16 a[254:255], v213 offset:51208
    v_mfma_f32_16x16x32_bf16 v[76:79], a[240:243], a[4:7], v[76:79]
    v_mfma_f32_16x16x32_bf16 v[108:111], a[240:243], a[8:11], v[108:111]
    v_mfma_f32_16x16x32_bf16 v[140:143], a[240:243], a[12:15], v[140:143]
    v_mfma_f32_16x16x32_bf16 v[156:159], a[240:243], a[16:19], v[156:159]
    s_waitcnt lgkmcnt(4)
    v_mfma_f32_16x16x32_bf16 v[48:51], a[244:247], a[0:3], v[48:51]
    ds_read_b64_tr_b16 a[224:225], v214 offset:16384
    ds_read_b64_tr_b16 a[226:227], v214 offset:18432
    v_mfma_f32_16x16x32_bf16 v[80:83], a[244:247], a[4:7], v[80:83]
    v_mfma_f32_16x16x32_bf16 v[112:115], a[244:247], a[8:11], v[112:115]
    v_mfma_f32_16x16x32_bf16 v[144:147], a[244:247], a[12:15], v[144:147]
    v_mfma_f32_16x16x32_bf16 v[160:163], a[244:247], a[16:19], v[160:163]
    s_waitcnt lgkmcnt(4)
    v_mfma_f32_16x16x32_bf16 v[52:55], a[248:251], a[0:3], v[52:55]
    ds_read_b64_tr_b16 a[228:229], v214 offset:16392
    ds_read_b64_tr_b16 a[230:231], v214 offset:18440
    v_mfma_f32_16x16x32_bf16 v[84:87], a[248:251], a[4:7], v[84:87]
    v_mfma_f32_16x16x32_bf16 v[116:119], a[248:251], a[8:11], v[116:119]
    v_mfma_f32_16x16x32_bf16 v[148:151], a[248:251], a[12:15], v[148:151]
    v_mfma_f32_16x16x32_bf16 v[164:167], a[248:251], a[16:19], v[164:167]
    s_waitcnt lgkmcnt(4)
    v_mfma_f32_16x16x32_bf16 v[56:59], a[252:255], a[0:3], v[56:59]
    ds_read_b64_tr_b16 a[232:233], v215 offset:16384
    ds_read_b64_tr_b16 a[234:235], v215 offset:18432
    v_mfma_f32_16x16x32_bf16 v[88:91], a[252:255], a[4:7], v[88:91]
    v_mfma_f32_16x16x32_bf16 v[120:123], a[252:255], a[8:11], v[120:123]
    v_mfma_f32_16x16x32_bf16 v[152:155], a[252:255], a[12:15], v[152:155]
    v_mfma_f32_16x16x32_bf16 v[168:171], a[252:255], a[16:19], v[168:171]
    s_barrier
    s_waitcnt lgkmcnt(4)
    v_mfma_f32_16x16x32_bf16 v[28:31], a[224:227], a[20:23], v[28:31]
    s_add_u32 m0, s29, 49152
    s_nop 0
    buffer_load_dwordx4 v0, s[12:15], s32 offen offset:0 nt lds
    v_mfma_f32_16x16x32_bf16 v[60:63], a[224:227], a[24:27], v[60:63]
    ds_read_b64_tr_b16 a[236:237], v215 offset:16392
    ds_read_b64_tr_b16 a[238:239], v215 offset:18440
    v_mfma_f32_16x16x32_bf16 v[92:95], a[224:227], a[28:31], v[92:95]
    v_mfma_f32_16x16x32_bf16 v[124:127], a[224:227], a[32:35], v[124:127]
    s_waitcnt lgkmcnt(4)
    v_mfma_f32_16x16x32_bf16 v[32:35], a[228:231], a[20:23], v[32:35]
    ds_read_b64_tr_b16 a[240:241], v216 offset:16384
    ds_read_b64_tr_b16 a[242:243], v216 offset:18432
    v_mfma_f32_16x16x32_bf16 v[64:67], a[228:231], a[24:27], v[64:67]
    buffer_load_dwordx4 v0, s[12:15], s32 offen offset:1024 nt lds
    v_mfma_f32_16x16x32_bf16 v[96:99], a[228:231], a[28:31], v[96:99]
    v_mfma_f32_16x16x32_bf16 v[128:131], a[228:231], a[32:35], v[128:131]
    s_waitcnt lgkmcnt(4)
    v_mfma_f32_16x16x32_bf16 v[36:39], a[232:235], a[20:23], v[36:39]
    ds_read_b64_tr_b16 a[244:245], v216 offset:16392
    ds_read_b64_tr_b16 a[246:247], v216 offset:18440
    v_mfma_f32_16x16x32_bf16 v[68:71], a[232:235], a[24:27], v[68:71]
    buffer_load_dwordx4 v0, s[12:15], s32 offen offset:2048 nt lds
    v_mfma_f32_16x16x32_bf16 v[100:103], a[232:235], a[28:31], v[100:103]
    v_mfma_f32_16x16x32_bf16 v[132:135], a[232:235], a[32:35], v[132:135]
    s_waitcnt lgkmcnt(4)
    v_mfma_f32_16x16x32_bf16 v[40:43], a[236:239], a[20:23], v[40:43]
    ds_read_b64_tr_b16 a[248:249], v217 offset:16384
    ds_read_b64_tr_b16 a[250:251], v217 offset:18432
    v_mfma_f32_16x16x32_bf16 v[72:75], a[236:239], a[24:27], v[72:75]
    buffer_load_dwordx4 v0, s[12:15], s32 offen offset:3072 nt lds
    v_mfma_f32_16x16x32_bf16 v[104:107], a[236:239], a[28:31], v[104:107]
    v_mfma_f32_16x16x32_bf16 v[136:139], a[236:239], a[32:35], v[136:139]
    s_waitcnt lgkmcnt(4)
    v_mfma_f32_16x16x32_bf16 v[44:47], a[240:243], a[20:23], v[44:47]
    s_add_u32 s32, s32, 16384
    ds_read_b64_tr_b16 a[252:253], v217 offset:16392
    ds_read_b64_tr_b16 a[254:255], v217 offset:18440
    v_mfma_f32_16x16x32_bf16 v[76:79], a[240:243], a[24:27], v[76:79]
    v_mfma_f32_16x16x32_bf16 v[108:111], a[240:243], a[28:31], v[108:111]
    v_mfma_f32_16x16x32_bf16 v[140:143], a[240:243], a[32:35], v[140:143]
    v_mfma_f32_16x16x32_bf16 v[156:159], a[240:243], a[36:39], v[156:159]
    s_waitcnt lgkmcnt(4)
    v_mfma_f32_16x16x32_bf16 v[48:51], a[244:247], a[20:23], v[48:51]
    v_mfma_f32_16x16x32_bf16 v[80:83], a[244:247], a[24:27], v[80:83]
    v_mfma_f32_16x16x32_bf16 v[112:115], a[244:247], a[28:31], v[112:115]
    v_mfma_f32_16x16x32_bf16 v[144:147], a[244:247], a[32:35], v[144:147]
    v_mfma_f32_16x16x32_bf16 v[160:163], a[244:247], a[36:39], v[160:163]
    s_waitcnt lgkmcnt(2)
    v_mfma_f32_16x16x32_bf16 v[52:55], a[248:251], a[20:23], v[52:55]
    v_mfma_f32_16x16x32_bf16 v[84:87], a[248:251], a[24:27], v[84:87]
    v_mfma_f32_16x16x32_bf16 v[116:119], a[248:251], a[28:31], v[116:119]
    v_mfma_f32_16x16x32_bf16 v[148:151], a[248:251], a[32:35], v[148:151]
    v_mfma_f32_16x16x32_bf16 v[164:167], a[248:251], a[36:39], v[164:167]
    s_waitcnt lgkmcnt(0)
    v_mfma_f32_16x16x32_bf16 v[56:59], a[252:255], a[20:23], v[56:59]
    v_mfma_f32_16x16x32_bf16 v[88:91], a[252:255], a[24:27], v[88:91]
    v_mfma_f32_16x16x32_bf16 v[120:123], a[252:255], a[28:31], v[120:123]
    v_mfma_f32_16x16x32_bf16 v[152:155], a[252:255], a[32:35], v[152:155]
    v_mfma_f32_16x16x32_bf16 v[168:171], a[252:255], a[36:39], v[168:171]
    s_barrier
    s_mov_b32 s100, 0x3db8aa3b
    s_mov_b32 s101, 0x3db8aa3b
    s_lshl_b32 s99, s30, 15
    s_lshl_b32 s96, s31, 12
    s_add_u32 s99, s99, s96
    s_lshl_b32 s97, s30, 11
    s_add_u32 s99, s99, s97
    s_add_u32 s99, s99, 81920
    v_lshlrev_b32 v220, 4, v200
    v_add_u32 v221, s99, v220
    v_xor_b32 v222, 0x800, v221
    s_xor_b32 s97, s97, 0x800
    s_add_u32 s96, s96, s97
    s_add_u32 s96, s96, 147456
    v_add_u32 v223, s96, v220
    v_pk_mul_f32 v[156:157], v[156:157], s[100:101]
    v_pk_mul_f32 v[158:159], v[158:159], s[100:101]
    v_pk_mul_f32 v[160:161], v[160:161], s[100:101]
    v_pk_mul_f32 v[162:163], v[162:163], s[100:101]
    v_cvt_pk_bf16_f32 v156, v156, v157
    v_cvt_pk_bf16_f32 v157, v158, v159
    v_cvt_pk_bf16_f32 v158, v160, v161
    v_cvt_pk_bf16_f32 v159, v162, v163
    ds_write_b128 v223, v[156:159] offset:0
    v_pk_mul_f32 v[164:165], v[164:165], s[100:101]
    v_pk_mul_f32 v[166:167], v[166:167], s[100:101]
    v_pk_mul_f32 v[168:169], v[168:169], s[100:101]
    v_pk_mul_f32 v[170:171], v[170:171], s[100:101]
    v_cvt_pk_bf16_f32 v164, v164, v165
    v_cvt_pk_bf16_f32 v165, v166, v167
    v_cvt_pk_bf16_f32 v166, v168, v169
    v_cvt_pk_bf16_f32 v167, v170, v171
    ds_write_b128 v223, v[164:167] offset:1024
    v_pk_mul_f32 v[28:29], v[28:29], s[100:101]
    v_pk_mul_f32 v[30:31], v[30:31], s[100:101]
    v_pk_mul_f32 v[32:33], v[32:33], s[100:101]
    v_pk_mul_f32 v[34:35], v[34:35], s[100:101]
    v_cvt_pk_bf16_f32 v28, v28, v29
    v_cvt_pk_bf16_f32 v29, v30, v31
    v_cvt_pk_bf16_f32 v30, v32, v33
    v_cvt_pk_bf16_f32 v31, v34, v35
    ds_write_b128 v221, v[28:31] offset:0
    v_pk_mul_f32 v[36:37], v[36:37], s[100:101]
    v_pk_mul_f32 v[38:39], v[38:39], s[100:101]
    v_pk_mul_f32 v[40:41], v[40:41], s[100:101]
    v_pk_mul_f32 v[42:43], v[42:43], s[100:101]
    v_cvt_pk_bf16_f32 v36, v36, v37
    v_cvt_pk_bf16_f32 v37, v38, v39
    v_cvt_pk_bf16_f32 v38, v40, v41
    v_cvt_pk_bf16_f32 v39, v42, v43
    ds_write_b128 v221, v[36:39] offset:1024
    v_pk_mul_f32 v[44:45], v[44:45], s[100:101]
    v_pk_mul_f32 v[46:47], v[46:47], s[100:101]
    v_pk_mul_f32 v[48:49], v[48:49], s[100:101]
    v_pk_mul_f32 v[50:51], v[50:51], s[100:101]
    v_cvt_pk_bf16_f32 v44, v44, v45
    v_cvt_pk_bf16_f32 v45, v46, v47
    v_cvt_pk_bf16_f32 v46, v48, v49
    v_cvt_pk_bf16_f32 v47, v50, v51
    ds_write_b128 v222, v[44:47] offset:0
    v_pk_mul_f32 v[52:53], v[52:53], s[100:101]
    v_pk_mul_f32 v[54:55], v[54:55], s[100:101]
    v_pk_mul_f32 v[56:57], v[56:57], s[100:101]
    v_pk_mul_f32 v[58:59], v[58:59], s[100:101]
    v_cvt_pk_bf16_f32 v52, v52, v53
    v_cvt_pk_bf16_f32 v53, v54, v55
    v_cvt_pk_bf16_f32 v54, v56, v57
    v_cvt_pk_bf16_f32 v55, v58, v59
    ds_write_b128 v222, v[52:55] offset:1024
    v_pk_mul_f32 v[60:61], v[60:61], s[100:101]
    v_pk_mul_f32 v[62:63], v[62:63], s[100:101]
    v_pk_mul_f32 v[64:65], v[64:65], s[100:101]
    v_pk_mul_f32 v[66:67], v[66:67], s[100:101]
    v_cvt_pk_bf16_f32 v60, v60, v61
    v_cvt_pk_bf16_f32 v61, v62, v63
    v_cvt_pk_bf16_f32 v62, v64, v65
    v_cvt_pk_bf16_f32 v63, v66, v67
    ds_write_b128 v221, v[60:63] offset:8192
    v_pk_mul_f32 v[68:69], v[68:69], s[100:101]
    v_pk_mul_f32 v[70:71], v[70:71], s[100:101]
    v_pk_mul_f32 v[72:73], v[72:73], s[100:101]
    v_pk_mul_f32 v[74:75], v[74:75], s[100:101]
    v_cvt_pk_bf16_f32 v68, v68, v69
    v_cvt_pk_bf16_f32 v69, v70, v71
    v_cvt_pk_bf16_f32 v70, v72, v73
    v_cvt_pk_bf16_f32 v71, v74, v75
    ds_write_b128 v221, v[68:71] offset:9216
    v_pk_mul_f32 v[76:77], v[76:77], s[100:101]
    v_pk_mul_f32 v[78:79], v[78:79], s[100:101]
    v_pk_mul_f32 v[80:81], v[80:81], s[100:101]
    v_pk_mul_f32 v[82:83], v[82:83], s[100:101]
    v_cvt_pk_bf16_f32 v76, v76, v77
    v_cvt_pk_bf16_f32 v77, v78, v79
    v_cvt_pk_bf16_f32 v78, v80, v81
    v_cvt_pk_bf16_f32 v79, v82, v83
    ds_write_b128 v222, v[76:79] offset:8192
    v_pk_mul_f32 v[84:85], v[84:85], s[100:101]
    v_pk_mul_f32 v[86:87], v[86:87], s[100:101]
    v_pk_mul_f32 v[88:89], v[88:89], s[100:101]
    v_pk_mul_f32 v[90:91], v[90:91], s[100:101]
    v_cvt_pk_bf16_f32 v84, v84, v85
    v_cvt_pk_bf16_f32 v85, v86, v87
    v_cvt_pk_bf16_f32 v86, v88, v89
    v_cvt_pk_bf16_f32 v87, v90, v91
    ds_write_b128 v222, v[84:87] offset:9216
    v_pk_mul_f32 v[92:93], v[92:93], s[100:101]
    v_pk_mul_f32 v[94:95], v[94:95], s[100:101]
    v_pk_mul_f32 v[96:97], v[96:97], s[100:101]
    v_pk_mul_f32 v[98:99], v[98:99], s[100:101]
    v_cvt_pk_bf16_f32 v92, v92, v93
    v_cvt_pk_bf16_f32 v93, v94, v95
    v_cvt_pk_bf16_f32 v94, v96, v97
    v_cvt_pk_bf16_f32 v95, v98, v99
    ds_write_b128 v221, v[92:95] offset:16384
    v_pk_mul_f32 v[100:101], v[100:101], s[100:101]
    v_pk_mul_f32 v[102:103], v[102:103], s[100:101]
    v_pk_mul_f32 v[104:105], v[104:105], s[100:101]
    v_pk_mul_f32 v[106:107], v[106:107], s[100:101]
    v_cvt_pk_bf16_f32 v100, v100, v101
    v_cvt_pk_bf16_f32 v101, v102, v103
    v_cvt_pk_bf16_f32 v102, v104, v105
    v_cvt_pk_bf16_f32 v103, v106, v107
    ds_write_b128 v221, v[100:103] offset:17408
    v_pk_mul_f32 v[108:109], v[108:109], s[100:101]
    v_pk_mul_f32 v[110:111], v[110:111], s[100:101]
    v_pk_mul_f32 v[112:113], v[112:113], s[100:101]
    v_pk_mul_f32 v[114:115], v[114:115], s[100:101]
    v_cvt_pk_bf16_f32 v108, v108, v109
    v_cvt_pk_bf16_f32 v109, v110, v111
    v_cvt_pk_bf16_f32 v110, v112, v113
    v_cvt_pk_bf16_f32 v111, v114, v115
    ds_write_b128 v222, v[108:111] offset:16384
    v_pk_mul_f32 v[116:117], v[116:117], s[100:101]
    v_pk_mul_f32 v[118:119], v[118:119], s[100:101]
    v_pk_mul_f32 v[120:121], v[120:121], s[100:101]
    v_pk_mul_f32 v[122:123], v[122:123], s[100:101]
    v_cvt_pk_bf16_f32 v116, v116, v117
    v_cvt_pk_bf16_f32 v117, v118, v119
    v_cvt_pk_bf16_f32 v118, v120, v121
    v_cvt_pk_bf16_f32 v119, v122, v123
    ds_write_b128 v222, v[116:119] offset:17408
    v_pk_mul_f32 v[124:125], v[124:125], s[100:101]
    v_pk_mul_f32 v[126:127], v[126:127], s[100:101]
    v_pk_mul_f32 v[128:129], v[128:129], s[100:101]
    v_pk_mul_f32 v[130:131], v[130:131], s[100:101]
    v_cvt_pk_bf16_f32 v124, v124, v125
    v_cvt_pk_bf16_f32 v125, v126, v127
    v_cvt_pk_bf16_f32 v126, v128, v129
    v_cvt_pk_bf16_f32 v127, v130, v131
    ds_write_b128 v221, v[124:127] offset:24576
    v_pk_mul_f32 v[132:133], v[132:133], s[100:101]
    v_pk_mul_f32 v[134:135], v[134:135], s[100:101]
    v_pk_mul_f32 v[136:137], v[136:137], s[100:101]
    v_pk_mul_f32 v[138:139], v[138:139], s[100:101]
    v_cvt_pk_bf16_f32 v132, v132, v133
    v_cvt_pk_bf16_f32 v133, v134, v135
    v_cvt_pk_bf16_f32 v134, v136, v137
    v_cvt_pk_bf16_f32 v135, v138, v139
    s_waitcnt lgkmcnt(14)
    ds_write_b128 v221, v[132:135] offset:25600
    v_pk_mul_f32 v[140:141], v[140:141], s[100:101]
    v_pk_mul_f32 v[142:143], v[142:143], s[100:101]
    v_pk_mul_f32 v[144:145], v[144:145], s[100:101]
    v_pk_mul_f32 v[146:147], v[146:147], s[100:101]
    v_cvt_pk_bf16_f32 v140, v140, v141
    v_cvt_pk_bf16_f32 v141, v142, v143
    v_cvt_pk_bf16_f32 v142, v144, v145
    v_cvt_pk_bf16_f32 v143, v146, v147
    s_waitcnt lgkmcnt(14)
    ds_write_b128 v222, v[140:143] offset:24576
    v_pk_mul_f32 v[148:149], v[148:149], s[100:101]
    v_pk_mul_f32 v[150:151], v[150:151], s[100:101]
    v_pk_mul_f32 v[152:153], v[152:153], s[100:101]
    v_pk_mul_f32 v[154:155], v[154:155], s[100:101]
    v_cvt_pk_bf16_f32 v148, v148, v149
    v_cvt_pk_bf16_f32 v149, v150, v151
    v_cvt_pk_bf16_f32 v150, v152, v153
    v_cvt_pk_bf16_f32 v151, v154, v155
    s_waitcnt lgkmcnt(14)
    ds_write_b128 v222, v[148:151] offset:25600
    s_lshl_b32 s99, s30, 15
    s_add_u32 s99, s99, 81920
    v_add_u32 v221, s99, v220
    v_add_u32 v222, 147456, v220
    s_waitcnt vmcnt(12)
    s_waitcnt lgkmcnt(0)
    s_barrier
    v_mov_b32 v24, 0
    v_mov_b32 v25, 0
    v_mov_b32 v26, 0
    v_mov_b32 v27, 0
    v_mov_b32 v28, 0
    s_mov_b32 s36, 0
    s_mov_b32 s37, 0
    s_mov_b32 s47, 0x3f803f80
    s_cmp_eq_u32 s30, 1
    s_cbranch_scc1 L_att1
    ds_read_b128 a[224:227], v4 offset:0
    ds_read_b128 a[0:3], v221 offset:0
    ds_read_b128 a[32:35], v221 offset:8192
    ds_read_b128 a[64:67], v221 offset:16384
    ds_read_b128 a[96:99], v221 offset:24576
    ds_read_b128 a[128:131], v222 offset:0
    ds_read_b128 a[228:231], v5 offset:0
    ds_read_b128 a[4:7], v221 offset:1024
    ds_read_b128 a[36:39], v221 offset:9216
    ds_read_b128 a[68:71], v221 offset:17408
    ds_read_b128 a[100:103], v221 offset:25600
    ds_read_b128 a[132:135], v222 offset:1024
    s_waitcnt lgkmcnt(10)
    v_mfma_f32_16x16x32_bf16 v[60:63], a[224:227], a[0:3], 0
    s_waitcnt lgkmcnt(9)
    ds_read_b128 a[232:235], v6 offset:0
    ds_read_b128 a[8:11], v221 offset:2048
    v_mfma_f32_16x16x32_bf16 v[64:67], a[224:227], a[32:35], 0
    s_waitcnt lgkmcnt(10)
    ds_read_b128 a[40:43], v221 offset:10240
    ds_read_b128 a[72:75], v221 offset:18432
    v_mfma_f32_16x16x32_bf16 v[68:71], a[224:227], a[64:67], 0
    s_waitcnt lgkmcnt(11)
    ds_read_b128 a[104:107], v221 offset:26624
    ds_read_b128 a[136:139], v222 offset:2048
    v_mfma_f32_16x16x32_bf16 v[72:75], a[224:227], a[96:99], 0
    s_waitcnt lgkmcnt(12)
    v_mov_b32 v128, 0
    v_mov_b32 v129, 0
    v_mfma_f32_16x16x32_bf16 v[92:95], a[224:227], a[128:131], 0
    s_waitcnt lgkmcnt(10)
    v_mov_b32 v130, 0
    v_mov_b32 v131, 0
    v_mfma_f32_16x16x32_bf16 v[60:63], a[228:231], a[4:7], v[60:63]
    s_waitcnt lgkmcnt(9)
    ds_read_b128 a[236:239], v7 offset:0
    ds_read_b128 a[12:15], v221 offset:3072
    v_mfma_f32_16x16x32_bf16 v[64:67], a[228:231], a[36:39], v[64:67]
    s_waitcnt lgkmcnt(10)
    ds_read_b128 a[44:47], v221 offset:11264
    ds_read_b128 a[76:79], v221 offset:19456
    v_mfma_f32_16x16x32_bf16 v[68:71], a[228:231], a[68:71], v[68:71]
    s_waitcnt lgkmcnt(11)
    ds_read_b128 a[108:111], v221 offset:27648
    ds_read_b128 a[140:143], v222 offset:3072
    v_mfma_f32_16x16x32_bf16 v[72:75], a[228:231], a[100:103], v[72:75]
    s_waitcnt lgkmcnt(12)
    v_mov_b32 v132, 0
    v_mov_b32 v133, 0
    v_mfma_f32_16x16x32_bf16 v[92:95], a[228:231], a[132:135], v[92:95]
    s_waitcnt lgkmcnt(10)
    v_mov_b32 v134, 0
    v_mov_b32 v135, 0
    v_mfma_f32_16x16x32_bf16 v[60:63], a[232:235], a[8:11], v[60:63]
    s_waitcnt lgkmcnt(9)
    ds_read_b128 a[240:243], v4 offset:256
    ds_read_b128 a[16:19], v221 offset:4096
    v_mfma_f32_16x16x32_bf16 v[64:67], a[232:235], a[40:43], v[64:67]
    s_waitcnt lgkmcnt(10)
    ds_read_b128 a[48:51], v221 offset:12288
    ds_read_b128 a[80:83], v221 offset:20480
    v_mfma_f32_16x16x32_bf16 v[68:71], a[232:235], a[72:75], v[68:71]
    s_waitcnt lgkmcnt(11)
    ds_read_b128 a[112:115], v221 offset:28672
    ds_read_b128 a[144:147], v222 offset:4096
    v_mfma_f32_16x16x32_bf16 v[72:75], a[232:235], a[104:107], v[72:75]
    s_waitcnt lgkmcnt(12)
    v_mov_b32 v136, 0
    v_mov_b32 v137, 0
    v_mfma_f32_16x16x32_bf16 v[92:95], a[232:235], a[136:139], v[92:95]
    s_waitcnt lgkmcnt(10)
    v_mov_b32 v138, 0
    v_mov_b32 v139, 0
    v_mfma_f32_16x16x32_bf16 v[60:63], a[236:239], a[12:15], v[60:63]
    s_waitcnt lgkmcnt(9)
    ds_read_b128 a[244:247], v5 offset:256
    ds_read_b128 a[20:23], v221 offset:5120
    v_mfma_f32_16x16x32_bf16 v[64:67], a[236:239], a[44:47], v[64:67]
    s_waitcnt lgkmcnt(10)
    ds_read_b128 a[52:55], v221 offset:13312
    ds_read_b128 a[84:87], v221 offset:21504
    v_mfma_f32_16x16x32_bf16 v[68:71], a[236:239], a[76:79], v[68:71]
    s_waitcnt lgkmcnt(11)
    ds_read_b128 a[116:119], v221 offset:29696
    ds_read_b128 a[148:151], v222 offset:5120
    v_mfma_f32_16x16x32_bf16 v[72:75], a[236:239], a[108:111], v[72:75]
    s_waitcnt lgkmcnt(12)
    v_mov_b32 v140, 0
    v_mov_b32 v141, 0
    v_mfma_f32_16x16x32_bf16 v[92:95], a[236:239], a[140:143], v[92:95]
    s_waitcnt lgkmcnt(10)
    v_mov_b32 v142, 0
    v_mov_b32 v143, 0
    v_mfma_f32_16x16x32_bf16 v[60:63], a[240:243], a[16:19], v[60:63]
    s_waitcnt lgkmcnt(9)
    ds_read_b128 a[248:251], v6 offset:256
    ds_read_b128 a[24:27], v221 offset:6144
    v_mfma_f32_16x16x32_bf16 v[64:67], a[240:243], a[48:51], v[64:67]
    s_waitcnt lgkmcnt(10)
    ds_read_b128 a[56:59], v221 offset:14336
    ds_read_b128 a[88:91], v221 offset:22528
    v_mfma_f32_16x16x32_bf16 v[68:71], a[240:243], a[80:83], v[68:71]
    s_waitcnt lgkmcnt(11)
    ds_read_b128 a[120:123], v221 offset:30720
    ds_read_b128 a[152:155], v222 offset:6144
    v_mfma_f32_16x16x32_bf16 v[72:75], a[240:243], a[112:115], v[72:75]
    s_waitcnt lgkmcnt(12)
    v_mov_b32 v144, 0
    v_mov_b32 v145, 0
    v_mfma_f32_16x16x32_bf16 v[92:95], a[240:243], a[144:147], v[92:95]
    s_waitcnt lgkmcnt(10)
    v_mov_b32 v146, 0
    v_mov_b32 v147, 0
    v_mfma_f32_16x16x32_bf16 v[60:63], a[244:247], a[20:23], v[60:63]
    s_waitcnt lgkmcnt(9)
    ds_read_b128 a[252:255], v7 offset:256
    ds_read_b128 a[28:31], v221 offset:7168
    v_mfma_f32_16x16x32_bf16 v[64:67], a[244:247], a[52:55], v[64:67]
    s_waitcnt lgkmcnt(10)
    ds_read_b128 a[60:63], v221 offset:15360
    ds_read_b128 a[92:95], v221 offset:23552
    v_mfma_f32_16x16x32_bf16 v[68:71], a[244:247], a[84:87], v[68:71]
    s_waitcnt lgkmcnt(11)
    ds_read_b128 a[124:127], v221 offset:31744
    ds_read_b128 a[156:159], v222 offset:7168
    v_mfma_f32_16x16x32_bf16 v[72:75], a[244:247], a[116:119], v[72:75]
    s_waitcnt lgkmcnt(12)
    v_mov_b32 v148, 0
    v_mov_b32 v149, 0
    v_mfma_f32_16x16x32_bf16 v[92:95], a[244:247], a[148:151], v[92:95]
    s_waitcnt lgkmcnt(10)
    v_mov_b32 v150, 0
    v_mov_b32 v151, 0
    v_mfma_f32_16x16x32_bf16 v[60:63], a[248:251], a[24:27], v[60:63]
    s_waitcnt lgkmcnt(9)
    v_mov_b32 v152, 0
    v_mov_b32 v153, 0
    v_mfma_f32_16x16x32_bf16 v[64:67], a[248:251], a[56:59], v[64:67]
    s_waitcnt lgkmcnt(8)
    v_mov_b32 v154, 0
    v_mov_b32 v155, 0
    v_mfma_f32_16x16x32_bf16 v[68:71], a[248:251], a[88:91], v[68:71]
    s_waitcnt lgkmcnt(7)
    v_mov_b32 v156, 0
    v_mov_b32 v157, 0
    v_mfma_f32_16x16x32_bf16 v[72:75], a[248:251], a[120:123], v[72:75]
    s_waitcnt lgkmcnt(6)
    v_mov_b32 v158, 0
    v_mov_b32 v159, 0
    v_mfma_f32_16x16x32_bf16 v[92:95], a[248:251], a[152:155], v[92:95]
    s_waitcnt lgkmcnt(4)
    v_mov_b32 v160, 0
    v_mov_b32 v161, 0
    v_mfma_f32_16x16x32_bf16 v[60:63], a[252:255], a[28:31], v[60:63]
    s_waitcnt lgkmcnt(3)
    v_mov_b32 v162, 0
    v_mov_b32 v163, 0
    v_mfma_f32_16x16x32_bf16 v[64:67], a[252:255], a[60:63], v[64:67]
    s_waitcnt lgkmcnt(2)
    v_mov_b32 v164, 0
    v_mov_b32 v165, 0
    v_mfma_f32_16x16x32_bf16 v[68:71], a[252:255], a[92:95], v[68:71]
    s_waitcnt lgkmcnt(1)
    v_mov_b32 v166, 0
    v_mov_b32 v167, 0
    v_mfma_f32_16x16x32_bf16 v[72:75], a[252:255], a[124:127], v[72:75]
    s_waitcnt lgkmcnt(0)
    v_mov_b32 v168, 0
    v_mov_b32 v169, 0
    v_mfma_f32_16x16x32_bf16 v[92:95], a[252:255], a[156:159], v[92:95]
    v_mov_b32 v170, 0
    v_mov_b32 v171, 0
    v_mov_b32 v200, 0
    v_mov_b32 v201, 0
    v_mov_b32 v202, 0
    v_mov_b32 v203, 0
    v_mov_b32 v204, 0
    v_mov_b32 v205, 0
    v_mov_b32 v206, 0
    v_mov_b32 v207, 0
    v_mov_b32 v208, 0
    v_mov_b32 v209, 0
    v_mov_b32 v210, 0
    v_mov_b32 v211, 0
    v_mov_b32 v212, 0
    v_mov_b32 v213, 0
    v_mov_b32 v214, 0
    v_mov_b32 v215, 0
    v_mov_b32 v216, 0
    v_mov_b32 v217, 0
    v_mov_b32 v218, 0
    v_mov_b32 v219, 0
    v_mov_b32 v220, 0
    v_mov_b32 v223, 0
    v_mov_b32 v224, 0
    v_mov_b32 v225, 0
    v_mov_b32 v221, 0
    v_mov_b32 v222, 0
    v_max3_f32 v96, v60, v61, v62
    v_max_f32 v96, v96, v63
    v_max3_f32 v97, v64, v65, v66
    v_max_f32 v97, v97, v67
    v_max3_f32 v98, v68, v69, v70
    v_max_f32 v98, v98, v71
    v_max3_f32 v99, v72, v73, v74
    v_max_f32 v99, v99, v75
    v_max3_f32 v100, v92, v93, v94
    v_max_f32 v100, v100, v95
    v_mov_b32 v104, v96
    v_mov_b32 v105, v97
    v_mov_b32 v106, v98
    v_mov_b32 v107, v99
    v_mov_b32 v108, v100
    v_permlane32_swap_b32 v96, v104
    v_permlane32_swap_b32 v97, v105
    v_permlane32_swap_b32 v98, v106
    v_permlane32_swap_b32 v99, v107
    v_permlane32_swap_b32 v100, v108
    v_max_f32 v96, v96, v104
    v_max_f32 v97, v97, v105
    v_max_f32 v98, v98, v106
    v_max_f32 v99, v99, v107
    v_max_f32 v100, v100, v108
    v_mov_b32 v104, v96
    v_mov_b32 v105, v97
    v_mov_b32 v106, v98
    v_mov_b32 v107, v99
    v_mov_b32 v108, v100
    v_permlane16_swap_b32 v96, v104
    v_permlane16_swap_b32 v97, v105
    v_permlane16_swap_b32 v98, v106
    v_permlane16_swap_b32 v99, v107
    v_permlane16_swap_b32 v100, v108
    v_max_f32 v96, v96, v104
    v_max_f32 v97, v97, v105
    v_max_f32 v98, v98, v106
    v_max_f32 v99, v99, v107
    v_max_f32 v100, v100, v108
    s_mul_i32 s99, s28, 1280
    v_add_u32 v101, s99, v3
    ds_write_b32 v101, v96 offset:4096
    ds_write_b32 v101, v97 offset:4352
    ds_write_b32 v101, v98 offset:4608
    ds_write_b32 v101, v99 offset:4864
    ds_write_b32 v101, v100 offset:5120
    s_xor_b32 s99, s28, 1
    s_mul_i32 s99, s99, 1280
    v_add_u32 v101, s99, v3
    s_waitcnt lgkmcnt(0)
    s_barrier
    ds_read_b32 v104, v101 offset:4096
    ds_read_b32 v105, v101 offset:4352
    ds_read_b32 v106, v101 offset:4608
    ds_read_b32 v107, v101 offset:4864
    ds_read_b32 v108, v3 offset:5120
    ds_read_b32 v109, v3 offset:6400
    s_cmp_eq_u32 s39, 0
    s_cselect_b64 vcc, 0, -1
    s_add_u32 m0, s29, 81920
    s_nop 0
    buffer_load_dwordx4 v0, s[16:19], s33 offen offset:0 nt lds
    buffer_load_dwordx4 v0, s[16:19], s33 offen offset:1024 nt lds
    buffer_load_dwordx4 v0, s[16:19], s33 offen offset:2048 nt lds
    buffer_load_dwordx4 v0, s[16:19], s33 offen offset:3072 nt lds
    s_add_u32 s33, s33, 16384
    s_add_u32 m0, s29, 0
    s_nop 0
    buffer_load_dwordx4 v0, s[12:15], s32 offen offset:0 nt lds
    buffer_load_dwordx4 v0, s[12:15], s32 offen offset:1024 nt lds
    buffer_load_dwordx4 v0, s[12:15], s32 offen offset:2048 nt lds
    buffer_load_dwordx4 v0, s[12:15], s32 offen offset:3072 nt lds
    s_add_u32 s32, s32, 16384
    s_waitcnt lgkmcnt(0)
    v_max_f32 v100, v108, v109
    v_sub_f32 v56, 0, v100
    v_sub_f32 v57, 0, v100
    v_sub_f32 v58, 0, v100
    v_sub_f32 v59, 0, v100
    v_sub_f32 v92, v92, v100
    v_sub_f32 v93, v93, v100
    v_sub_f32 v94, v94, v100
    v_sub_f32 v95, v95, v100
    v_max_f32 v96, v96, v104
    v_sub_f32 v40, 0, v96
    v_sub_f32 v41, 0, v96
    v_sub_f32 v42, 0, v96
    v_sub_f32 v43, 0, v96
    v_sub_f32 v60, v60, v96
    v_sub_f32 v61, v61, v96
    v_sub_f32 v62, v62, v96
    v_sub_f32 v63, v63, v96
    v_max_f32 v97, v97, v105
    v_sub_f32 v44, 0, v97
    v_sub_f32 v45, 0, v97
    v_sub_f32 v46, 0, v97
    v_sub_f32 v47, 0, v97
    v_sub_f32 v64, v64, v97
    v_sub_f32 v65, v65, v97
    v_sub_f32 v66, v66, v97
    v_sub_f32 v67, v67, v97
    v_max_f32 v98, v98, v106
    v_sub_f32 v48, 0, v98
    v_sub_f32 v49, 0, v98
    v_sub_f32 v50, 0, v98
    v_sub_f32 v51, 0, v98
    v_sub_f32 v68, v68, v98
    v_sub_f32 v69, v69, v98
    v_sub_f32 v70, v70, v98
    v_sub_f32 v71, v71, v98
    v_max_f32 v99, v99, v107
    v_sub_f32 v52, 0, v99
    v_sub_f32 v53, 0, v99
    v_sub_f32 v54, 0, v99
    v_sub_f32 v55, 0, v99
    v_sub_f32 v72, v72, v99
    v_sub_f32 v73, v73, v99
    v_sub_f32 v74, v74, v99
    v_sub_f32 v75, v75, v99
    v_exp_f32 v30, v92
    v_exp_f32 v31, v93
    v_add_f32 v28, v28, v30
    v_cvt_pk_bf16_f32 v36, v30, v31
    v_add_f32 v28, v28, v31
    v_exp_f32 v32, v94
    v_exp_f32 v33, v95
    v_add_f32 v28, v28, v32
    v_cvt_pk_bf16_f32 v37, v32, v33
    v_add_f32 v28, v28, v33
    ds_write_b64 v1, v[36:37] offset:2048
    v_exp_f32 v34, v60
    v_exp_f32 v35, v61
    v_add_f32 v24, v24, v34
    v_cvt_pk_bf16_f32 v96, v34, v35
    v_add_f32 v24, v24, v35
    v_exp_f32 v30, v62
    v_exp_f32 v31, v63
    v_add_f32 v24, v24, v30
    v_cvt_pk_bf16_f32 v97, v30, v31
    v_add_f32 v24, v24, v31
    s_mov_b32 s35, 0
    s_waitcnt lgkmcnt(0)
    ds_read_b128 a[224:227], v4 offset:16384
    ds_read_b128 a[228:231], v5 offset:16384
    ds_read_b128 a[232:235], v6 offset:16384
L_loop0:
    s_waitcnt lgkmcnt(2)
    v_mfma_f32_16x16x32_bf16 v[76:79], a[224:227], a[0:3], v[40:43]
    ds_read_b128 a[236:239], v7 offset:16384
    v_mfma_f32_16x16x32_bf16 v[80:83], a[224:227], a[32:35], v[44:47]
    s_add_u32 m0, s29, 98304
    s_waitcnt vmcnt(5)
    buffer_load_dwordx4 v0, s[16:19], s33 offen offset:0 nt lds
    v_mfma_f32_16x16x32_bf16 v[84:87], a[224:227], a[64:67], v[48:51]
    v_exp_f32 v30, v64
    v_mfma_f32_16x16x32_bf16 v[88:91], a[224:227], a[96:99], v[52:55]
    v_exp_f32 v31, v65
    v_mfma_f32_16x16x32_bf16 v[92:95], a[224:227], a[128:131], v[56:59]
    s_waitcnt lgkmcnt(2)
    v_add_f32 v25, v25, v30
    v_cvt_pk_bf16_f32 v100, v30, v31
    v_mfma_f32_16x16x32_bf16 v[76:79], a[228:231], a[4:7], v[76:79]
    ds_read_b128 a[240:243], v4 offset:16640
    v_add_f32 v25, v25, v31
    v_mfma_f32_16x16x32_bf16 v[80:83], a[228:231], a[36:39], v[80:83]
    v_exp_f32 v32, v66
    v_mfma_f32_16x16x32_bf16 v[84:87], a[228:231], a[68:71], v[84:87]
    s_waitcnt vmcnt(6)
    buffer_load_dwordx4 v0, s[16:19], s33 offen offset:1024 nt lds
    v_mfma_f32_16x16x32_bf16 v[88:91], a[228:231], a[100:103], v[88:91]
    v_exp_f32 v33, v67
    v_mfma_f32_16x16x32_bf16 v[92:95], a[228:231], a[132:135], v[92:95]
    s_waitcnt lgkmcnt(2)
    v_add_f32 v25, v25, v32
    v_cvt_pk_bf16_f32 v101, v32, v33
    v_mfma_f32_16x16x32_bf16 v[76:79], a[232:235], a[8:11], v[76:79]
    ds_read_b128 a[244:247], v5 offset:16640
    v_add_f32 v25, v25, v33
    v_mfma_f32_16x16x32_bf16 v[80:83], a[232:235], a[40:43], v[80:83]
    ds_write2st64_b64 v1, v[96:97], v[100:101] offset0:0 offset1:1
    v_mfma_f32_16x16x32_bf16 v[84:87], a[232:235], a[72:75], v[84:87]
    v_exp_f32 v34, v68
    v_mfma_f32_16x16x32_bf16 v[88:91], a[232:235], a[104:107], v[88:91]
    s_waitcnt vmcnt(5)
    buffer_load_dwordx4 v0, s[16:19], s33 offen offset:2048 nt lds
    v_mfma_f32_16x16x32_bf16 v[92:95], a[232:235], a[136:139], v[92:95]
    s_waitcnt lgkmcnt(3)
    v_exp_f32 v35, v69
    v_mfma_f32_16x16x32_bf16 v[76:79], a[236:239], a[12:15], v[76:79]
    ds_read_b128 a[248:251], v6 offset:16640
    v_add_f32 v26, v26, v34
    v_mfma_f32_16x16x32_bf16 v[80:83], a[236:239], a[44:47], v[80:83]
    v_cvt_pk_bf16_f32 v104, v34, v35
    v_add_f32 v26, v26, v35
    v_mfma_f32_16x16x32_bf16 v[84:87], a[236:239], a[76:79], v[84:87]
    v_exp_f32 v30, v70
    v_mfma_f32_16x16x32_bf16 v[88:91], a[236:239], a[108:111], v[88:91]
    v_exp_f32 v31, v71
    v_mfma_f32_16x16x32_bf16 v[92:95], a[236:239], a[140:143], v[92:95]
    s_waitcnt lgkmcnt(3)
    s_waitcnt vmcnt(6)
    buffer_load_dwordx4 v0, s[16:19], s33 offen offset:3072 nt lds
    v_mfma_f32_16x16x32_bf16 v[76:79], a[240:243], a[16:19], v[76:79]
    ds_read_b128 a[252:255], v7 offset:16640
    v_add_f32 v26, v26, v30
    v_mfma_f32_16x16x32_bf16 v[80:83], a[240:243], a[48:51], v[80:83]
    v_cvt_pk_bf16_f32 v105, v30, v31
    v_add_f32 v26, v26, v31
    v_mfma_f32_16x16x32_bf16 v[84:87], a[240:243], a[80:83], v[84:87]
    v_exp_f32 v32, v72
    v_mfma_f32_16x16x32_bf16 v[88:91], a[240:243], a[112:115], v[88:91]
    v_exp_f32 v33, v73
    v_mfma_f32_16x16x32_bf16 v[92:95], a[240:243], a[144:147], v[92:95]
    s_waitcnt lgkmcnt(3)
    v_add_f32 v27, v27, v32
    v_cvt_pk_bf16_f32 v108, v32, v33
    v_mfma_f32_16x16x32_bf16 v[76:79], a[244:247], a[20:23], v[76:79]
    s_add_u32 s33, s33, 16384
    v_add_f32 v27, v27, v33
    v_mfma_f32_16x16x32_bf16 v[80:83], a[244:247], a[52:55], v[80:83]
    v_exp_f32 v34, v74
    v_mfma_f32_16x16x32_bf16 v[84:87], a[244:247], a[84:87], v[84:87]
    v_exp_f32 v35, v75
    v_mfma_f32_16x16x32_bf16 v[88:91], a[244:247], a[116:119], v[88:91]
    v_add_f32 v27, v27, v34
    v_cvt_pk_bf16_f32 v109, v34, v35
    v_add_f32 v27, v27, v35
    ds_write2st64_b64 v1, v[104:105], v[108:109] offset0:2 offset1:3
    v_mfma_f32_16x16x32_bf16 v[92:95], a[244:247], a[148:151], v[92:95]
    s_waitcnt lgkmcnt(1)
    s_waitcnt lgkmcnt(0)
    s_waitcnt vmcnt(16)
    s_barrier
    v_mfma_f32_16x16x32_bf16 v[76:79], a[248:251], a[24:27], v[76:79]
    ds_read_b64 v[98:99], v2 offset:0
    ds_read_b64 v[102:103], v2 offset:512
    v_mfma_f32_16x16x32_bf16 v[80:83], a[248:251], a[56:59], v[80:83]
    ds_read_b64 v[106:107], v2 offset:1024
    ds_read_b64 v[110:111], v2 offset:1536
    v_mfma_f32_16x16x32_bf16 v[84:87], a[248:251], a[88:91], v[84:87]
    ds_read_b64 v[38:39], v2 offset:2048
    v_mfma_f32_16x16x32_bf16 v[88:91], a[248:251], a[120:123], v[88:91]
    ds_read_b64_tr_b16 a[224:225], v8 offset:0
    ds_read_b64_tr_b16 a[226:227], v16 offset:0
    v_mfma_f32_16x16x32_bf16 v[92:95], a[248:251], a[152:155], v[92:95]
    ds_read_b64_tr_b16 a[228:229], v9 offset:0
    ds_read_b64_tr_b16 a[230:231], v17 offset:0
    v_mfma_f32_16x16x32_bf16 v[76:79], a[252:255], a[28:31], v[76:79]
    ds_read_b64_tr_b16 a[232:233], v10 offset:0
    ds_read_b64_tr_b16 a[234:235], v18 offset:0
    v_mfma_f32_16x16x32_bf16 v[80:83], a[252:255], a[60:63], v[80:83]
    s_add_u32 m0, s29, 16384
    s_waitcnt vmcnt(5)
    buffer_load_dwordx4 v0, s[12:15], s32 offen offset:0 nt lds
    v_mfma_f32_16x16x32_bf16 v[84:87], a[252:255], a[92:95], v[84:87]
    v_mfma_f32_16x16x32_bf16 v[88:91], a[252:255], a[124:127], v[88:91]
    v_mfma_f32_16x16x32_bf16 v[92:95], a[252:255], a[156:159], v[92:95]
    s_cbranch_vccnz L_rare0
L_back0:
    s_waitcnt lgkmcnt(4)
    v_mfma_f32_16x16x32_bf16 v[128:131], a[224:227], v[96:99], v[128:131]
    ds_read_b64_tr_b16 a[236:237], v11 offset:0
    ds_read_b64_tr_b16 a[238:239], v19 offset:0
    v_mfma_f32_16x16x32_bf16 v[160:163], a[224:227], v[100:103], v[160:163]
    v_mfma_f32_16x16x32_bf16 v[192:195], a[224:227], v[104:107], v[192:195]
    v_mfma_f32_16x16x32_bf16 v[224:227], a[224:227], v[108:111], v[224:227]
    v_mfma_f32_16x16x32_bf16 a[160:163], a[224:227], v[36:39], a[160:163]
    s_waitcnt lgkmcnt(4)
    v_mfma_f32_16x16x32_bf16 v[132:135], a[228:231], v[96:99], v[132:135]
    s_waitcnt vmcnt(6)
    buffer_load_dwordx4 v0, s[12:15], s32 offen offset:1024 nt lds
    v_mfma_f32_16x16x32_bf16 v[164:167], a[228:231], v[100:103], v[164:167]
    ds_read_b64_tr_b16 a[240:241], v12 offset:0
    ds_read_b64_tr_b16 a[242:243], v20 offset:0
    v_mfma_f32_16x16x32_bf16 v[196:199], a[228:231], v[104:107], v[196:199]
    v_exp_f32 v30, v76
    v_mfma_f32_16x16x32_bf16 v[228:231], a[228:231], v[108:111], v[228:231]
    v_exp_f32 v31, v77
    v_mfma_f32_16x16x32_bf16 a[164:167], a[228:231], v[36:39], a[164:167]
    s_waitcnt lgkmcnt(4)
    v_add_f32 v24, v24, v30
    v_cvt_pk_bf16_f32 v112, v30, v31
    v_mfma_f32_16x16x32_bf16 v[136:139], a[232:235], v[96:99], v[136:139]
    ds_read_b64_tr_b16 a[244:245], v13 offset:0
    ds_read_b64_tr_b16 a[246:247], v21 offset:0
    v_mfma_f32_16x16x32_bf16 v[168:171], a[232:235], v[100:103], v[168:171]
    v_add_f32 v24, v24, v31
    v_mfma_f32_16x16x32_bf16 v[200:203], a[232:235], v[104:107], v[200:203]
    v_exp_f32 v32, v78
    v_mfma_f32_16x16x32_bf16 v[232:235], a[232:235], v[108:111], v[232:235]
    v_exp_f32 v33, v79
    v_mfma_f32_16x16x32_bf16 a[168:171], a[232:235], v[36:39], a[168:171]
    s_waitcnt lgkmcnt(4)
    v_add_f32 v24, v24, v32
    v_cvt_pk_bf16_f32 v113, v32, v33
    v_mfma_f32_16x16x32_bf16 v[140:143], a[236:239], v[96:99], v[140:143]
    ds_read_b64_tr_b16 a[248:249], v14 offset:0
    ds_read_b64_tr_b16 a[250:251], v22 offset:0
    v_mfma_f32_16x16x32_bf16 v[172:175], a[236:239], v[100:103], v[172:175]
    s_waitcnt vmcnt(5)
    buffer_load_dwordx4 v0, s[12:15], s32 offen offset:2048 nt lds
    v_add_f32 v24, v24, v33
    v_mfma_f32_16x16x32_bf16 v[204:207], a[236:239], v[104:107], v[204:207]
    v_exp_f32 v34, v80
    v_mfma_f32_16x16x32_bf16 v[236:239], a[236:239], v[108:111], v[236:239]
    v_exp_f32 v35, v81
    v_mfma_f32_16x16x32_bf16 a[172:175], a[236:239], v[36:39], a[172:175]
    s_waitcnt lgkmcnt(4)
    v_add_f32 v25, v25, v34
    v_cvt_pk_bf16_f32 v116, v34, v35
    v_mfma_f32_16x16x32_bf16 v[144:147], a[240:243], v[96:99], v[144:147]
    ds_read_b64_tr_b16 a[252:253], v15 offset:0
    ds_read_b64_tr_b16 a[254:255], v23 offset:0
    v_mfma_f32_16x16x32_bf16 v[176:179], a[240:243], v[100:103], v[176:179]
    v_add_f32 v25, v25, v35
    v_mfma_f32_16x16x32_bf16 v[208:211], a[240:243], v[104:107], v[208:211]
    v_exp_f32 v30, v82
    v_mfma_f32_16x16x32_bf16 v[240:243], a[240:243], v[108:111], v[240:243]
    v_exp_f32 v31, v83
    v_mfma_f32_16x16x32_bf16 a[176:179], a[240:243], v[36:39], a[176:179]
    s_waitcnt lgkmcnt(4)
    v_add_f32 v25, v25, v30
    v_cvt_pk_bf16_f32 v117, v30, v31
    v_mfma_f32_16x16x32_bf16 v[148:151], a[244:247], v[96:99], v[148:151]
    ds_read_b128 a[224:227], v4 offset:32768
    v_add_f32 v25, v25, v31
    v_mfma_f32_16x16x32_bf16 v[180:183], a[244:247], v[100:103], v[180:183]
    ds_write2st64_b64 v1, v[112:113], v[116:117] offset0:5 offset1:6
    v_mfma_f32_16x16x32_bf16 v[212:215], a[244:247], v[104:107], v[212:215]
    s_waitcnt vmcnt(6)
    buffer_load_dwordx4 v0, s[12:15], s32 offen offset:3072 nt lds
    v_mfma_f32_16x16x32_bf16 v[244:247], a[244:247], v[108:111], v[244:247]
    v_exp_f32 v32, v84
    v_mfma_f32_16x16x32_bf16 a[180:183], a[244:247], v[36:39], a[180:183]
    s_waitcnt lgkmcnt(4)
    v_exp_f32 v33, v85
    v_mfma_f32_16x16x32_bf16 v[152:155], a[248:251], v[96:99], v[152:155]
    ds_read_b128 a[228:231], v5 offset:32768
    v_add_f32 v26, v26, v32
    v_mfma_f32_16x16x32_bf16 v[184:187], a[248:251], v[100:103], v[184:187]
    v_cvt_pk_bf16_f32 v120, v32, v33
    v_add_f32 v26, v26, v33
    v_mfma_f32_16x16x32_bf16 v[216:219], a[248:251], v[104:107], v[216:219]
    v_exp_f32 v34, v86
    v_mfma_f32_16x16x32_bf16 v[248:251], a[248:251], v[108:111], v[248:251]
    v_exp_f32 v35, v87
    v_mfma_f32_16x16x32_bf16 a[184:187], a[248:251], v[36:39], a[184:187]
    s_waitcnt lgkmcnt(3)
    v_add_f32 v26, v26, v34
    v_cvt_pk_bf16_f32 v121, v34, v35
    v_mfma_f32_16x16x32_bf16 v[156:159], a[252:255], v[96:99], v[156:159]
    ds_read_b128 a[232:235], v6 offset:32768
    v_add_f32 v26, v26, v35
    v_mfma_f32_16x16x32_bf16 v[188:191], a[252:255], v[100:103], v[188:191]
    v_mfma_f32_16x16x32_bf16 v[220:223], a[252:255], v[104:107], v[220:223]
    v_mfma_f32_16x16x32_bf16 v[252:255], a[252:255], v[108:111], v[252:255]
    s_add_u32 s32, s32, 16384
    v_mfma_f32_16x16x32_bf16 a[188:191], a[252:255], v[36:39], a[188:191]
    s_cbranch_vccnz L_rare1
L_back1:
    s_waitcnt lgkmcnt(3)
    v_mfma_f32_16x16x32_bf16 v[60:63], a[224:227], a[0:3], v[40:43]
    ds_read_b128 a[236:239], v7 offset:32768
    v_mfma_f32_16x16x32_bf16 v[64:67], a[224:227], a[32:35], v[44:47]
    s_add_u32 m0, s29, 114688
    s_waitcnt vmcnt(5)
    buffer_load_dwordx4 v0, s[16:19], s33 offen offset:0 nt lds
    v_mfma_f32_16x16x32_bf16 v[68:71], a[224:227], a[64:67], v[48:51]
    v_exp_f32 v30, v88
    v_mfma_f32_16x16x32_bf16 v[72:75], a[224:227], a[96:99], v[52:55]
    s_waitcnt lgkmcnt(2)
    v_exp_f32 v31, v89
    v_mfma_f32_16x16x32_bf16 v[60:63], a[228:231], a[4:7], v[60:63]
    ds_read_b128 a[240:243], v4 offset:33024
    v_add_f32 v27, v27, v30
    v_mfma_f32_16x16x32_bf16 v[64:67], a[228:231], a[36:39], v[64:67]
    s_waitcnt vmcnt(6)
    buffer_load_dwordx4 v0, s[16:19], s33 offen offset:1024 nt lds
    v_cvt_pk_bf16_f32 v124, v30, v31
    v_mfma_f32_16x16x32_bf16 v[68:71], a[228:231], a[68:71], v[68:71]
    v_add_f32 v27, v27, v31
    v_mfma_f32_16x16x32_bf16 v[72:75], a[228:231], a[100:103], v[72:75]
    s_waitcnt lgkmcnt(2)
    v_exp_f32 v32, v90
    v_mfma_f32_16x16x32_bf16 v[60:63], a[232:235], a[8:11], v[60:63]
    ds_read_b128 a[244:247], v5 offset:33024
    v_mfma_f32_16x16x32_bf16 v[64:67], a[232:235], a[40:43], v[64:67]
    s_waitcnt vmcnt(5)
    buffer_load_dwordx4 v0, s[16:19], s33 offen offset:2048 nt lds
    v_mfma_f32_16x16x32_bf16 v[68:71], a[232:235], a[72:75], v[68:71]
    v_exp_f32 v33, v91
    v_mfma_f32_16x16x32_bf16 v[72:75], a[232:235], a[104:107], v[72:75]
    s_waitcnt lgkmcnt(2)
    v_add_f32 v27, v27, v32
    v_cvt_pk_bf16_f32 v125, v32, v33
    v_mfma_f32_16x16x32_bf16 v[60:63], a[236:239], a[12:15], v[60:63]
    ds_read_b128 a[248:251], v6 offset:33024
    v_add_f32 v27, v27, v33
    v_mfma_f32_16x16x32_bf16 v[64:67], a[236:239], a[44:47], v[64:67]
    s_waitcnt vmcnt(6)
    buffer_load_dwordx4 v0, s[16:19], s33 offen offset:3072 nt lds
    v_mfma_f32_16x16x32_bf16 v[68:71], a[236:239], a[76:79], v[68:71]
    ds_write2st64_b64 v1, v[120:121], v[124:125] offset0:7 offset1:8
    v_mfma_f32_16x16x32_bf16 v[72:75], a[236:239], a[108:111], v[72:75]
    s_waitcnt lgkmcnt(3)
    v_exp_f32 v34, v92
    v_mfma_f32_16x16x32_bf16 v[60:63], a[240:243], a[16:19], v[60:63]
    ds_read_b128 a[252:255], v7 offset:33024
    v_mfma_f32_16x16x32_bf16 v[64:67], a[240:243], a[48:51], v[64:67]
    s_add_u32 s33, s33, 16384
    v_exp_f32 v35, v93
    v_mfma_f32_16x16x32_bf16 v[68:71], a[240:243], a[80:83], v[68:71]
    v_add_f32 v28, v28, v34
    v_cvt_pk_bf16_f32 v36, v34, v35
    v_mfma_f32_16x16x32_bf16 v[72:75], a[240:243], a[112:115], v[72:75]
    s_waitcnt lgkmcnt(3)
    v_add_f32 v28, v28, v35
    v_mfma_f32_16x16x32_bf16 v[60:63], a[244:247], a[20:23], v[60:63]
    v_exp_f32 v30, v94
    v_exp_f32 v31, v95
    v_add_f32 v28, v28, v30
    v_cvt_pk_bf16_f32 v37, v30, v31
    v_add_f32 v28, v28, v31
    ds_write_b64 v1, v[36:37] offset:4608
    v_mfma_f32_16x16x32_bf16 v[64:67], a[244:247], a[52:55], v[64:67]
    s_waitcnt lgkmcnt(1)
    s_waitcnt lgkmcnt(0)
    s_waitcnt vmcnt(16)
    s_barrier
    v_mfma_f32_16x16x32_bf16 v[68:71], a[244:247], a[84:87], v[68:71]
    ds_read_b64 v[114:115], v2 offset:2560
    ds_read_b64 v[118:119], v2 offset:3072
    v_mfma_f32_16x16x32_bf16 v[72:75], a[244:247], a[116:119], v[72:75]
    ds_read_b64 v[122:123], v2 offset:3584
    ds_read_b64 v[126:127], v2 offset:4096
    v_mfma_f32_16x16x32_bf16 v[60:63], a[248:251], a[24:27], v[60:63]
    ds_read_b64 v[38:39], v2 offset:4608
    v_mfma_f32_16x16x32_bf16 v[64:67], a[248:251], a[56:59], v[64:67]
    ds_read_b64_tr_b16 a[224:225], v8 offset:16384
    ds_read_b64_tr_b16 a[226:227], v16 offset:16384
    v_mfma_f32_16x16x32_bf16 v[68:71], a[248:251], a[88:91], v[68:71]
    ds_read_b64_tr_b16 a[228:229], v9 offset:16384
    ds_read_b64_tr_b16 a[230:231], v17 offset:16384
    v_mfma_f32_16x16x32_bf16 v[72:75], a[248:251], a[120:123], v[72:75]
    ds_read_b64_tr_b16 a[232:233], v10 offset:16384
    ds_read_b64_tr_b16 a[234:235], v18 offset:16384
    v_mfma_f32_16x16x32_bf16 v[60:63], a[252:255], a[28:31], v[60:63]
    s_add_u32 m0, s29, 32768
    s_waitcnt vmcnt(5)
    buffer_load_dwordx4 v0, s[12:15], s32 offen offset:0 nt lds
    v_mfma_f32_16x16x32_bf16 v[64:67], a[252:255], a[60:63], v[64:67]
    v_mfma_f32_16x16x32_bf16 v[68:71], a[252:255], a[92:95], v[68:71]
    v_mfma_f32_16x16x32_bf16 v[72:75], a[252:255], a[124:127], v[72:75]
    s_cbranch_vccnz L_rare2
L_back2:
    s_waitcnt lgkmcnt(4)
    v_mfma_f32_16x16x32_bf16 v[128:131], a[224:227], v[112:115], v[128:131]
    ds_read_b64_tr_b16 a[236:237], v11 offset:16384
    ds_read_b64_tr_b16 a[238:239], v19 offset:16384
    v_mfma_f32_16x16x32_bf16 v[160:163], a[224:227], v[116:119], v[160:163]
    v_mfma_f32_16x16x32_bf16 v[192:195], a[224:227], v[120:123], v[192:195]
    v_mfma_f32_16x16x32_bf16 v[224:227], a[224:227], v[124:127], v[224:227]
    v_mfma_f32_16x16x32_bf16 a[160:163], a[224:227], v[36:39], a[160:163]
    s_waitcnt lgkmcnt(4)
    v_mfma_f32_16x16x32_bf16 v[132:135], a[228:231], v[112:115], v[132:135]
    s_waitcnt vmcnt(6)
    buffer_load_dwordx4 v0, s[12:15], s32 offen offset:1024 nt lds
    v_mfma_f32_16x16x32_bf16 v[164:167], a[228:231], v[116:119], v[164:167]
    ds_read_b64_tr_b16 a[240:241], v12 offset:16384
    ds_read_b64_tr_b16 a[242:243], v20 offset:16384
    v_mfma_f32_16x16x32_bf16 v[196:199], a[228:231], v[120:123], v[196:199]
    v_exp_f32 v32, v60
    v_mfma_f32_16x16x32_bf16 v[228:231], a[228:231], v[124:127], v[228:231]
    v_exp_f32 v33, v61
    v_mfma_f32_16x16x32_bf16 a[164:167], a[228:231], v[36:39], a[164:167]
    s_waitcnt lgkmcnt(4)
    v_add_f32 v24, v24, v32
    v_cvt_pk_bf16_f32 v96, v32, v33
    v_mfma_f32_16x16x32_bf16 v[136:139], a[232:235], v[112:115], v[136:139]
    ds_read_b64_tr_b16 a[244:245], v13 offset:16384
    ds_read_b64_tr_b16 a[246:247], v21 offset:16384
    v_mfma_f32_16x16x32_bf16 v[168:171], a[232:235], v[116:119], v[168:171]
    v_add_f32 v24, v24, v33
    v_mfma_f32_16x16x32_bf16 v[200:203], a[232:235], v[120:123], v[200:203]
    v_exp_f32 v34, v62
    v_mfma_f32_16x16x32_bf16 v[232:235], a[232:235], v[124:127], v[232:235]
    v_exp_f32 v35, v63
    v_mfma_f32_16x16x32_bf16 a[168:171], a[232:235], v[36:39], a[168:171]
    s_waitcnt lgkmcnt(4)
    v_add_f32 v24, v24, v34
    v_cvt_pk_bf16_f32 v97, v34, v35
    v_mfma_f32_16x16x32_bf16 v[140:143], a[236:239], v[112:115], v[140:143]
    ds_read_b64_tr_b16 a[248:249], v14 offset:16384
    ds_read_b64_tr_b16 a[250:251], v22 offset:16384
    v_mfma_f32_16x16x32_bf16 v[172:175], a[236:239], v[116:119], v[172:175]
    s_waitcnt vmcnt(5)
    buffer_load_dwordx4 v0, s[12:15], s32 offen offset:2048 nt lds
    v_add_f32 v24, v24, v35
    v_mfma_f32_16x16x32_bf16 v[204:207], a[236:239], v[120:123], v[204:207]
    v_exp_f32 v30, v64
    v_mfma_f32_16x16x32_bf16 v[236:239], a[236:239], v[124:127], v[236:239]
    v_exp_f32 v31, v65
    v_mfma_f32_16x16x32_bf16 a[172:175], a[236:239], v[36:39], a[172:175]
    s_waitcnt lgkmcnt(4)
    v_add_f32 v25, v25, v30
    v_cvt_pk_bf16_f32 v100, v30, v31
    v_mfma_f32_16x16x32_bf16 v[144:147], a[240:243], v[112:115], v[144:147]
    ds_read_b64_tr_b16 a[252:253], v15 offset:16384
    ds_read_b64_tr_b16 a[254:255], v23 offset:16384
    v_mfma_f32_16x16x32_bf16 v[176:179], a[240:243], v[116:119], v[176:179]
    v_add_f32 v25, v25, v31
    v_mfma_f32_16x16x32_bf16 v[208:211], a[240:243], v[120:123], v[208:211]
    v_exp_f32 v32, v66
    v_mfma_f32_16x16x32_bf16 v[240:243], a[240:243], v[124:127], v[240:243]
    v_exp_f32 v33, v67
    v_mfma_f32_16x16x32_bf16 a[176:179], a[240:243], v[36:39], a[176:179]
    s_waitcnt lgkmcnt(4)
    v_add_f32 v25, v25, v32
    v_cvt_pk_bf16_f32 v101, v32, v33
    v_mfma_f32_16x16x32_bf16 v[148:151], a[244:247], v[112:115], v[148:151]
    ds_read_b128 a[224:227], v4 offset:49152
    v_add_f32 v25, v25, v33
    v_mfma_f32_16x16x32_bf16 v[180:183], a[244:247], v[116:119], v[180:183]
    ds_write2st64_b64 v1, v[96:97], v[100:101] offset0:0 offset1:1
    v_mfma_f32_16x16x32_bf16 v[212:215], a[244:247], v[120:123], v[212:215]
    s_waitcnt vmcnt(6)
    buffer_load_dwordx4 v0, s[12:15], s32 offen offset:3072 nt lds
    v_mfma_f32_16x16x32_bf16 v[244:247], a[244:247], v[124:127], v[244:247]
    v_mfma_f32_16x16x32_bf16 a[180:183], a[244:247], v[36:39], a[180:183]
    s_waitcnt lgkmcnt(4)
    v_mfma_f32_16x16x32_bf16 v[152:155], a[248:251], v[112:115], v[152:155]
    ds_read_b128 a[228:231], v5 offset:49152
    v_mfma_f32_16x16x32_bf16 v[184:187], a[248:251], v[116:119], v[184:187]
    v_mfma_f32_16x16x32_bf16 v[216:219], a[248:251], v[120:123], v[216:219]
    v_mfma_f32_16x16x32_bf16 v[248:251], a[248:251], v[124:127], v[248:251]
    v_mfma_f32_16x16x32_bf16 a[184:187], a[248:251], v[36:39], a[184:187]
    s_waitcnt lgkmcnt(3)
    v_mfma_f32_16x16x32_bf16 v[156:159], a[252:255], v[112:115], v[156:159]
    ds_read_b128 a[232:235], v6 offset:49152
    v_mfma_f32_16x16x32_bf16 v[188:191], a[252:255], v[116:119], v[188:191]
    v_mfma_f32_16x16x32_bf16 v[220:223], a[252:255], v[120:123], v[220:223]
    v_mfma_f32_16x16x32_bf16 v[252:255], a[252:255], v[124:127], v[252:255]
    s_add_u32 s32, s32, 16384
    v_mfma_f32_16x16x32_bf16 a[188:191], a[252:255], v[36:39], a[188:191]
    s_cbranch_vccnz L_rare3
L_back3:
    s_waitcnt lgkmcnt(3)
    v_mfma_f32_16x16x32_bf16 v[76:79], a[224:227], a[0:3], v[40:43]
    ds_read_b128 a[236:239], v7 offset:49152
    v_mfma_f32_16x16x32_bf16 v[80:83], a[224:227], a[32:35], v[44:47]
    s_add_u32 m0, s29, 65536
    s_waitcnt vmcnt(5)
    buffer_load_dwordx4 v0, s[16:19], s33 offen offset:0 nt lds
    v_mfma_f32_16x16x32_bf16 v[84:87], a[224:227], a[64:67], v[48:51]
    v_exp_f32 v34, v68
    v_mfma_f32_16x16x32_bf16 v[88:91], a[224:227], a[96:99], v[52:55]
    s_waitcnt lgkmcnt(2)
    v_exp_f32 v35, v69
    v_mfma_f32_16x16x32_bf16 v[76:79], a[228:231], a[4:7], v[76:79]
    ds_read_b128 a[240:243], v4 offset:49408
    v_add_f32 v26, v26, v34
    v_mfma_f32_16x16x32_bf16 v[80:83], a[228:231], a[36:39], v[80:83]
    s_waitcnt vmcnt(6)
    buffer_load_dwordx4 v0, s[16:19], s33 offen offset:1024 nt lds
    v_cvt_pk_bf16_f32 v104, v34, v35
    v_mfma_f32_16x16x32_bf16 v[84:87], a[228:231], a[68:71], v[84:87]
    v_add_f32 v26, v26, v35
    v_mfma_f32_16x16x32_bf16 v[88:91], a[228:231], a[100:103], v[88:91]
    s_waitcnt lgkmcnt(2)
    v_exp_f32 v30, v70
    v_mfma_f32_16x16x32_bf16 v[76:79], a[232:235], a[8:11], v[76:79]
    ds_read_b128 a[244:247], v5 offset:49408
    v_mfma_f32_16x16x32_bf16 v[80:83], a[232:235], a[40:43], v[80:83]
    s_waitcnt vmcnt(5)
    buffer_load_dwordx4 v0, s[16:19], s33 offen offset:2048 nt lds
    v_mfma_f32_16x16x32_bf16 v[84:87], a[232:235], a[72:75], v[84:87]
    v_exp_f32 v31, v71
    v_mfma_f32_16x16x32_bf16 v[88:91], a[232:235], a[104:107], v[88:91]
    s_waitcnt lgkmcnt(2)
    v_add_f32 v26, v26, v30
    v_cvt_pk_bf16_f32 v105, v30, v31
    v_mfma_f32_16x16x32_bf16 v[76:79], a[236:239], a[12:15], v[76:79]
    ds_read_b128 a[248:251], v6 offset:49408
    v_add_f32 v26, v26, v31
    v_mfma_f32_16x16x32_bf16 v[80:83], a[236:239], a[44:47], v[80:83]
    s_waitcnt vmcnt(6)
    buffer_load_dwordx4 v0, s[16:19], s33 offen offset:3072 nt lds
    v_mfma_f32_16x16x32_bf16 v[84:87], a[236:239], a[76:79], v[84:87]
    v_exp_f32 v32, v72
    v_mfma_f32_16x16x32_bf16 v[88:91], a[236:239], a[108:111], v[88:91]
    s_waitcnt lgkmcnt(2)
    v_exp_f32 v33, v73
    v_mfma_f32_16x16x32_bf16 v[76:79], a[240:243], a[16:19], v[76:79]
    ds_read_b128 a[252:255], v7 offset:49408
    v_add_f32 v27, v27, v32
    v_mfma_f32_16x16x32_bf16 v[80:83], a[240:243], a[48:51], v[80:83]
    s_add_u32 s33, s33, 16384
    v_cvt_pk_bf16_f32 v108, v32, v33
    v_add_f32 v27, v27, v33
    v_mfma_f32_16x16x32_bf16 v[84:87], a[240:243], a[80:83], v[84:87]
    v_exp_f32 v34, v74
    v_mfma_f32_16x16x32_bf16 v[88:91], a[240:243], a[112:115], v[88:91]
    s_waitcnt lgkmcnt(2)
    v_exp_f32 v35, v75
    v_mfma_f32_16x16x32_bf16 v[76:79], a[244:247], a[20:23], v[76:79]
    v_add_f32 v27, v27, v34
    v_cvt_pk_bf16_f32 v109, v34, v35
    v_add_f32 v27, v27, v35
    ds_write2st64_b64 v1, v[104:105], v[108:109] offset0:2 offset1:3
    v_mfma_f32_16x16x32_bf16 v[80:83], a[244:247], a[52:55], v[80:83]
    s_waitcnt lgkmcnt(1)
    s_waitcnt lgkmcnt(0)
    s_waitcnt vmcnt(16)
    s_barrier
    v_mfma_f32_16x16x32_bf16 v[84:87], a[244:247], a[84:87], v[84:87]
    ds_read_b64 v[98:99], v2 offset:0
    ds_read_b64 v[102:103], v2 offset:512
    v_mfma_f32_16x16x32_bf16 v[88:91], a[244:247], a[116:119], v[88:91]
    ds_read_b64 v[106:107], v2 offset:1024
    ds_read_b64 v[110:111], v2 offset:1536
    v_mfma_f32_16x16x32_bf16 v[76:79], a[248:251], a[24:27], v[76:79]
    ds_read_b64_tr_b16 a[224:225], v8 offset:32768
    ds_read_b64_tr_b16 a[226:227], v16 offset:32768
    v_mfma_f32_16x16x32_bf16 v[80:83], a[248:251], a[56:59], v[80:83]
    ds_read_b64_tr_b16 a[228:229], v9 offset:32768
    ds_read_b64_tr_b16 a[230:231], v17 offset:32768
    v_mfma_f32_16x16x32_bf16 v[84:87], a[248:251], a[88:91], v[84:87]
    s_add_u32 m0, s29, 49152
    s_waitcnt vmcnt(5)
    buffer_load_dwordx4 v0, s[12:15], s32 offen offset:0 nt lds
    v_mfma_f32_16x16x32_bf16 v[88:91], a[248:251], a[120:123], v[88:91]
    ds_read_b64_tr_b16 a[232:233], v10 offset:32768
    ds_read_b64_tr_b16 a[234:235], v18 offset:32768
    v_mfma_f32_16x16x32_bf16 v[76:79], a[252:255], a[28:31], v[76:79]
    v_mfma_f32_16x16x32_bf16 v[80:83], a[252:255], a[60:63], v[80:83]
    v_mfma_f32_16x16x32_bf16 v[84:87], a[252:255], a[92:95], v[84:87]
    v_mfma_f32_16x16x32_bf16 v[88:91], a[252:255], a[124:127], v[88:91]
    s_cbranch_vccnz L_rare4
L_back4:
    s_waitcnt lgkmcnt(4)
    v_mfma_f32_16x16x32_bf16 v[128:131], a[224:227], v[96:99], v[128:131]
    ds_read_b64_tr_b16 a[236:237], v11 offset:32768
    ds_read_b64_tr_b16 a[238:239], v19 offset:32768
    v_mfma_f32_16x16x32_bf16 v[160:163], a[224:227], v[100:103], v[160:163]
    v_mfma_f32_16x16x32_bf16 v[192:195], a[224:227], v[104:107], v[192:195]
    v_mfma_f32_16x16x32_bf16 v[224:227], a[224:227], v[108:111], v[224:227]
    s_waitcnt lgkmcnt(4)
    s_waitcnt vmcnt(6)
    buffer_load_dwordx4 v0, s[12:15], s32 offen offset:1024 nt lds
    v_mfma_f32_16x16x32_bf16 v[132:135], a[228:231], v[96:99], v[132:135]
    ds_read_b64_tr_b16 a[240:241], v12 offset:32768
    ds_read_b64_tr_b16 a[242:243], v20 offset:32768
    v_mfma_f32_16x16x32_bf16 v[164:167], a[228:231], v[100:103], v[164:167]
    v_exp_f32 v30, v76
    v_mfma_f32_16x16x32_bf16 v[196:199], a[228:231], v[104:107], v[196:199]
    v_exp_f32 v31, v77
    v_mfma_f32_16x16x32_bf16 v[228:231], a[228:231], v[108:111], v[228:231]
    s_waitcnt lgkmcnt(4)
    v_add_f32 v24, v24, v30
    v_cvt_pk_bf16_f32 v112, v30, v31
    v_mfma_f32_16x16x32_bf16 v[136:139], a[232:235], v[96:99], v[136:139]
    ds_read_b64_tr_b16 a[244:245], v13 offset:32768
    ds_read_b64_tr_b16 a[246:247], v21 offset:32768
    v_mfma_f32_16x16x32_bf16 v[168:171], a[232:235], v[100:103], v[168:171]
    v_add_f32 v24, v24, v31
    v_mfma_f32_16x16x32_bf16 v[200:203], a[232:235], v[104:107], v[200:203]
    v_exp_f32 v32, v78
    v_mfma_f32_16x16x32_bf16 v[232:235], a[232:235], v[108:111], v[232:235]
    s_waitcnt lgkmcnt(4)
    v_exp_f32 v33, v79
    v_mfma_f32_16x16x32_bf16 v[140:143], a[236:239], v[96:99], v[140:143]
    s_waitcnt vmcnt(5)
    buffer_load_dwordx4 v0, s[12:15], s32 offen offset:2048 nt lds
    v_add_f32 v24, v24, v32
    v_mfma_f32_16x16x32_bf16 v[172:175], a[236:239], v[100:103], v[172:175]
    ds_read_b64_tr_b16 a[248:249], v14 offset:32768
    ds_read_b64_tr_b16 a[250:251], v22 offset:32768
    v_mfma_f32_16x16x32_bf16 v[204:207], a[236:239], v[104:107], v[204:207]
    v_cvt_pk_bf16_f32 v113, v32, v33
    v_add_f32 v24, v24, v33
    v_mfma_f32_16x16x32_bf16 v[236:239], a[236:239], v[108:111], v[236:239]
    s_waitcnt lgkmcnt(4)
    v_exp_f32 v34, v80
    v_mfma_f32_16x16x32_bf16 v[144:147], a[240:243], v[96:99], v[144:147]
    ds_read_b64_tr_b16 a[252:253], v15 offset:32768
    ds_read_b64_tr_b16 a[254:255], v23 offset:32768
    v_mfma_f32_16x16x32_bf16 v[176:179], a[240:243], v[100:103], v[176:179]
    v_exp_f32 v35, v81
    v_mfma_f32_16x16x32_bf16 v[208:211], a[240:243], v[104:107], v[208:211]
    v_add_f32 v25, v25, v34
    v_cvt_pk_bf16_f32 v116, v34, v35
    v_mfma_f32_16x16x32_bf16 v[240:243], a[240:243], v[108:111], v[240:243]
    s_waitcnt lgkmcnt(4)
    v_add_f32 v25, v25, v35
    v_mfma_f32_16x16x32_bf16 v[148:151], a[244:247], v[96:99], v[148:151]
    ds_read_b128 a[224:227], v4 offset:0
    v_mfma_f32_16x16x32_bf16 v[180:183], a[244:247], v[100:103], v[180:183]
    s_waitcnt vmcnt(6)
    buffer_load_dwordx4 v0, s[12:15], s32 offen offset:3072 nt lds
    v_mfma_f32_16x16x32_bf16 v[212:215], a[244:247], v[104:107], v[212:215]
    v_exp_f32 v30, v82
    v_mfma_f32_16x16x32_bf16 v[244:247], a[244:247], v[108:111], v[244:247]
    s_waitcnt lgkmcnt(3)
    v_exp_f32 v31, v83
    v_mfma_f32_16x16x32_bf16 v[152:155], a[248:251], v[96:99], v[152:155]
    ds_read_b128 a[228:231], v5 offset:0
    v_add_f32 v25, v25, v30
    v_mfma_f32_16x16x32_bf16 v[184:187], a[248:251], v[100:103], v[184:187]
    v_cvt_pk_bf16_f32 v117, v30, v31
    v_add_f32 v25, v25, v31
    v_mfma_f32_16x16x32_bf16 v[216:219], a[248:251], v[104:107], v[216:219]
    ds_write2st64_b64 v1, v[112:113], v[116:117] offset0:5 offset1:6
    v_mfma_f32_16x16x32_bf16 v[248:251], a[248:251], v[108:111], v[248:251]
    s_waitcnt lgkmcnt(3)
    v_mfma_f32_16x16x32_bf16 v[156:159], a[252:255], v[96:99], v[156:159]
    ds_read_b128 a[232:235], v6 offset:0
    v_mfma_f32_16x16x32_bf16 v[188:191], a[252:255], v[100:103], v[188:191]
    v_mfma_f32_16x16x32_bf16 v[220:223], a[252:255], v[104:107], v[220:223]
    s_add_u32 s32, s32, 16384
    v_mfma_f32_16x16x32_bf16 v[252:255], a[252:255], v[108:111], v[252:255]
    s_cbranch_vccnz L_rare5
L_back5:
    s_waitcnt lgkmcnt(3)
    v_mfma_f32_16x16x32_bf16 v[60:63], a[224:227], a[0:3], v[40:43]
    ds_read_b128 a[236:239], v7 offset:0
    v_mfma_f32_16x16x32_bf16 v[64:67], a[224:227], a[32:35], v[44:47]
    s_add_u32 m0, s29, 81920
    s_waitcnt vmcnt(5)
    buffer_load_dwordx4 v0, s[16:19], s33 offen offset:0 nt lds
    v_mfma_f32_16x16x32_bf16 v[68:71], a[224:227], a[64:67], v[48:51]
    v_exp_f32 v32, v84
    v_mfma_f32_16x16x32_bf16 v[72:75], a[224:227], a[96:99], v[52:55]
    v_exp_f32 v33, v85
    v_mfma_f32_16x16x32_bf16 v[92:95], a[224:227], a[128:131], v[56:59]
    s_waitcnt lgkmcnt(3)
    v_add_f32 v26, v26, v32
    v_cvt_pk_bf16_f32 v120, v32, v33
    v_mfma_f32_16x16x32_bf16 v[60:63], a[228:231], a[4:7], v[60:63]
    ds_read_b128 a[240:243], v4 offset:256
    v_add_f32 v26, v26, v33
    v_mfma_f32_16x16x32_bf16 v[64:67], a[228:231], a[36:39], v[64:67]
    v_exp_f32 v34, v86
    v_mfma_f32_16x16x32_bf16 v[68:71], a[228:231], a[68:71], v[68:71]
    s_waitcnt vmcnt(6)
    buffer_load_dwordx4 v0, s[16:19], s33 offen offset:1024 nt lds
    v_mfma_f32_16x16x32_bf16 v[72:75], a[228:231], a[100:103], v[72:75]
    v_exp_f32 v35, v87
    v_mfma_f32_16x16x32_bf16 v[92:95], a[228:231], a[132:135], v[92:95]
    s_waitcnt lgkmcnt(2)
    v_add_f32 v26, v26, v34
    v_cvt_pk_bf16_f32 v121, v34, v35
    v_mfma_f32_16x16x32_bf16 v[60:63], a[232:235], a[8:11], v[60:63]
    ds_read_b128 a[244:247], v5 offset:256
    v_add_f32 v26, v26, v35
    v_mfma_f32_16x16x32_bf16 v[64:67], a[232:235], a[40:43], v[64:67]
    v_exp_f32 v30, v88
    v_mfma_f32_16x16x32_bf16 v[68:71], a[232:235], a[72:75], v[68:71]
    v_exp_f32 v31, v89
    v_mfma_f32_16x16x32_bf16 v[72:75], a[232:235], a[104:107], v[72:75]
    s_waitcnt vmcnt(5)
    buffer_load_dwordx4 v0, s[16:19], s33 offen offset:2048 nt lds
    v_add_f32 v27, v27, v30
    v_mfma_f32_16x16x32_bf16 v[92:95], a[232:235], a[136:139], v[92:95]
    s_waitcnt lgkmcnt(2)
    v_cvt_pk_bf16_f32 v124, v30, v31
    v_add_f32 v27, v27, v31
    v_mfma_f32_16x16x32_bf16 v[60:63], a[236:239], a[12:15], v[60:63]
    ds_read_b128 a[248:251], v6 offset:256
    v_mfma_f32_16x16x32_bf16 v[64:67], a[236:239], a[44:47], v[64:67]
    v_exp_f32 v32, v90
    v_mfma_f32_16x16x32_bf16 v[68:71], a[236:239], a[76:79], v[68:71]
    v_exp_f32 v33, v91
    v_mfma_f32_16x16x32_bf16 v[72:75], a[236:239], a[108:111], v[72:75]
    v_add_f32 v27, v27, v32
    v_cvt_pk_bf16_f32 v125, v32, v33
    v_mfma_f32_16x16x32_bf16 v[92:95], a[236:239], a[140:143], v[92:95]
    s_waitcnt lgkmcnt(2)
    s_waitcnt vmcnt(6)
    buffer_load_dwordx4 v0, s[16:19], s33 offen offset:3072 nt lds
    v_mfma_f32_16x16x32_bf16 v[60:63], a[240:243], a[16:19], v[60:63]
    ds_read_b128 a[252:255], v7 offset:256
    v_add_f32 v27, v27, v33
    v_mfma_f32_16x16x32_bf16 v[64:67], a[240:243], a[48:51], v[64:67]
    ds_write2st64_b64 v1, v[120:121], v[124:125] offset0:7 offset1:8
    v_mfma_f32_16x16x32_bf16 v[68:71], a[240:243], a[80:83], v[68:71]
    v_mfma_f32_16x16x32_bf16 v[72:75], a[240:243], a[112:115], v[72:75]
    v_mfma_f32_16x16x32_bf16 v[92:95], a[240:243], a[144:147], v[92:95]
    s_waitcnt lgkmcnt(3)
    v_mfma_f32_16x16x32_bf16 v[60:63], a[244:247], a[20:23], v[60:63]
    s_add_u32 s33, s33, 16384
    v_mfma_f32_16x16x32_bf16 v[64:67], a[244:247], a[52:55], v[64:67]
    v_mfma_f32_16x16x32_bf16 v[68:71], a[244:247], a[84:87], v[68:71]
    v_mfma_f32_16x16x32_bf16 v[72:75], a[244:247], a[116:119], v[72:75]
    v_mfma_f32_16x16x32_bf16 v[92:95], a[244:247], a[148:151], v[92:95]
    s_waitcnt lgkmcnt(1)
    s_waitcnt lgkmcnt(0)
    s_waitcnt vmcnt(16)
    s_barrier
    v_mfma_f32_16x16x32_bf16 v[60:63], a[248:251], a[24:27], v[60:63]
    ds_read_b64 v[114:115], v2 offset:2560
    ds_read_b64 v[118:119], v2 offset:3072
    v_mfma_f32_16x16x32_bf16 v[64:67], a[248:251], a[56:59], v[64:67]
    ds_read_b64 v[122:123], v2 offset:3584
    ds_read_b64 v[126:127], v2 offset:4096
    v_mfma_f32_16x16x32_bf16 v[68:71], a[248:251], a[88:91], v[68:71]
    ds_read_b64_tr_b16 a[224:225], v8 offset:49152
    ds_read_b64_tr_b16 a[226:227], v16 offset:49152
    v_mfma_f32_16x16x32_bf16 v[72:75], a[248:251], a[120:123], v[72:75]
    ds_read_b64_tr_b16 a[228:229], v9 offset:49152
    ds_read_b64_tr_b16 a[230:231], v17 offset:49152
    v_mfma_f32_16x16x32_bf16 v[92:95], a[248:251], a[152:155], v[92:95]
    s_add_u32 m0, s29, 0
    s_waitcnt vmcnt(5)
    buffer_load_dwordx4 v0, s[12:15], s32 offen offset:0 nt lds
    v_mfma_f32_16x16x32_bf16 v[60:63], a[252:255], a[28:31], v[60:63]
    ds_read_b64_tr_b16 a[232:233], v10 offset:49152
    ds_read_b64_tr_b16 a[234:235], v18 offset:49152
    v_mfma_f32_16x16x32_bf16 v[64:67], a[252:255], a[60:63], v[64:67]
    v_mfma_f32_16x16x32_bf16 v[68:71], a[252:255], a[92:95], v[68:71]
    v_mfma_f32_16x16x32_bf16 v[72:75], a[252:255], a[124:127], v[72:75]
    v_mfma_f32_16x16x32_bf16 v[92:95], a[252:255], a[156:159], v[92:95]
    s_cbranch_vccnz L_rare6
L_back6:
    s_waitcnt lgkmcnt(4)
    v_mfma_f32_16x16x32_bf16 v[128:131], a[224:227], v[112:115], v[128:131]
    ds_read_b64_tr_b16 a[236:237], v11 offset:49152
    ds_read_b64_tr_b16 a[238:239], v19 offset:49152
    v_mfma_f32_16x16x32_bf16 v[160:163], a[224:227], v[116:119], v[160:163]
    v_mfma_f32_16x16x32_bf16 v[192:195], a[224:227], v[120:123], v[192:195]
    v_mfma_f32_16x16x32_bf16 v[224:227], a[224:227], v[124:127], v[224:227]
    s_waitcnt lgkmcnt(4)
    s_waitcnt vmcnt(6)
    buffer_load_dwordx4 v0, s[12:15], s32 offen offset:1024 nt lds
    v_mfma_f32_16x16x32_bf16 v[132:135], a[228:231], v[112:115], v[132:135]
    ds_read_b64_tr_b16 a[240:241], v12 offset:49152
    ds_read_b64_tr_b16 a[242:243], v20 offset:49152
    v_mfma_f32_16x16x32_bf16 v[164:167], a[228:231], v[116:119], v[164:167]
    v_exp_f32 v34, v92
    v_mfma_f32_16x16x32_bf16 v[196:199], a[228:231], v[120:123], v[196:199]
    v_exp_f32 v35, v93
    v_mfma_f32_16x16x32_bf16 v[228:231], a[228:231], v[124:127], v[228:231]
    s_waitcnt lgkmcnt(4)
    v_add_f32 v28, v28, v34
    v_cvt_pk_bf16_f32 v36, v34, v35
    v_mfma_f32_16x16x32_bf16 v[136:139], a[232:235], v[112:115], v[136:139]
    ds_read_b64_tr_b16 a[244:245], v13 offset:49152
    ds_read_b64_tr_b16 a[246:247], v21 offset:49152
    v_mfma_f32_16x16x32_bf16 v[168:171], a[232:235], v[116:119], v[168:171]
    v_add_f32 v28, v28, v35
    v_mfma_f32_16x16x32_bf16 v[200:203], a[232:235], v[120:123], v[200:203]
    v_exp_f32 v30, v94
    v_mfma_f32_16x16x32_bf16 v[232:235], a[232:235], v[124:127], v[232:235]
    s_waitcnt lgkmcnt(4)
    v_exp_f32 v31, v95
    v_mfma_f32_16x16x32_bf16 v[140:143], a[236:239], v[112:115], v[140:143]
    s_waitcnt vmcnt(5)
    buffer_load_dwordx4 v0, s[12:15], s32 offen offset:2048 nt lds
    v_add_f32 v28, v28, v30
    v_mfma_f32_16x16x32_bf16 v[172:175], a[236:239], v[116:119], v[172:175]
    ds_read_b64_tr_b16 a[248:249], v14 offset:49152
    ds_read_b64_tr_b16 a[250:251], v22 offset:49152
    v_mfma_f32_16x16x32_bf16 v[204:207], a[236:239], v[120:123], v[204:207]
    v_cvt_pk_bf16_f32 v37, v30, v31
    v_add_f32 v28, v28, v31
    v_mfma_f32_16x16x32_bf16 v[236:239], a[236:239], v[124:127], v[236:239]
    s_waitcnt lgkmcnt(4)
    ds_write_b64 v1, v[36:37] offset:2048
    v_mfma_f32_16x16x32_bf16 v[144:147], a[240:243], v[112:115], v[144:147]
    ds_read_b64_tr_b16 a[252:253], v15 offset:49152
    ds_read_b64_tr_b16 a[254:255], v23 offset:49152
    v_mfma_f32_16x16x32_bf16 v[176:179], a[240:243], v[116:119], v[176:179]
    v_exp_f32 v32, v60
    v_mfma_f32_16x16x32_bf16 v[208:211], a[240:243], v[120:123], v[208:211]
    v_exp_f32 v33, v61
    v_mfma_f32_16x16x32_bf16 v[240:243], a[240:243], v[124:127], v[240:243]
    s_waitcnt lgkmcnt(5)
    v_add_f32 v24, v24, v32
    v_cvt_pk_bf16_f32 v96, v32, v33
    v_mfma_f32_16x16x32_bf16 v[148:151], a[244:247], v[112:115], v[148:151]
    ds_read_b128 a[224:227], v4 offset:16384
    v_add_f32 v24, v24, v33
    v_mfma_f32_16x16x32_bf16 v[180:183], a[244:247], v[116:119], v[180:183]
    s_waitcnt vmcnt(6)
    buffer_load_dwordx4 v0, s[12:15], s32 offen offset:3072 nt lds
    v_mfma_f32_16x16x32_bf16 v[212:215], a[244:247], v[120:123], v[212:215]
    v_exp_f32 v34, v62
    v_mfma_f32_16x16x32_bf16 v[244:247], a[244:247], v[124:127], v[244:247]
    s_waitcnt lgkmcnt(4)
    v_exp_f32 v35, v63
    v_mfma_f32_16x16x32_bf16 v[152:155], a[248:251], v[112:115], v[152:155]
    ds_read_b128 a[228:231], v5 offset:16384
    v_add_f32 v24, v24, v34
    v_mfma_f32_16x16x32_bf16 v[184:187], a[248:251], v[116:119], v[184:187]
    v_cvt_pk_bf16_f32 v97, v34, v35
    v_add_f32 v24, v24, v35
    v_mfma_f32_16x16x32_bf16 v[216:219], a[248:251], v[120:123], v[216:219]
    v_mfma_f32_16x16x32_bf16 v[248:251], a[248:251], v[124:127], v[248:251]
    s_waitcnt lgkmcnt(2)
    v_mfma_f32_16x16x32_bf16 v[156:159], a[252:255], v[112:115], v[156:159]
    ds_read_b128 a[232:235], v6 offset:16384
    v_mfma_f32_16x16x32_bf16 v[188:191], a[252:255], v[116:119], v[188:191]
    v_mfma_f32_16x16x32_bf16 v[220:223], a[252:255], v[120:123], v[220:223]
    s_add_u32 s32, s32, 16384
    v_mfma_f32_16x16x32_bf16 v[252:255], a[252:255], v[124:127], v[252:255]
    s_cbranch_vccnz L_rare7
L_back7:
    s_add_u32 s35, s35, 1
    s_cmp_lt_u32 s35, 6
    s_cbranch_scc1 L_loop0
    s_waitcnt lgkmcnt(2)
    v_mfma_f32_16x16x32_bf16 v[76:79], a[224:227], a[0:3], v[40:43]
    ds_read_b128 a[236:239], v7 offset:16384
    v_mfma_f32_16x16x32_bf16 v[80:83], a[224:227], a[32:35], v[44:47]
    s_add_u32 m0, s29, 98304
    s_waitcnt vmcnt(5)
    buffer_load_dwordx4 v0, s[16:19], s33 offen offset:0 nt lds
    v_mfma_f32_16x16x32_bf16 v[84:87], a[224:227], a[64:67], v[48:51]
    v_exp_f32 v30, v64
    v_mfma_f32_16x16x32_bf16 v[88:91], a[224:227], a[96:99], v[52:55]
    v_exp_f32 v31, v65
    v_mfma_f32_16x16x32_bf16 v[92:95], a[224:227], a[128:131], v[56:59]
    s_waitcnt lgkmcnt(2)
    v_add_f32 v25, v25, v30
    v_cvt_pk_bf16_f32 v100, v30, v31
    v_mfma_f32_16x16x32_bf16 v[76:79], a[228:231], a[4:7], v[76:79]
    ds_read_b128 a[240:243], v4 offset:16640
    v_add_f32 v25, v25, v31
    v_mfma_f32_16x16x32_bf16 v[80:83], a[228:231], a[36:39], v[80:83]
    v_exp_f32 v32, v66
    v_mfma_f32_16x16x32_bf16 v[84:87], a[228:231], a[68:71], v[84:87]
    s_waitcnt vmcnt(6)
    buffer_load_dwordx4 v0, s[16:19], s33 offen offset:1024 nt lds
    v_mfma_f32_16x16x32_bf16 v[88:91], a[228:231], a[100:103], v[88:91]
    v_exp_f32 v33, v67
    v_mfma_f32_16x16x32_bf16 v[92:95], a[228:231], a[132:135], v[92:95]
    s_waitcnt lgkmcnt(2)
    v_add_f32 v25, v25, v32
    v_cvt_pk_bf16_f32 v101, v32, v33
    v_mfma_f32_16x16x32_bf16 v[76:79], a[232:235], a[8:11], v[76:79]
    ds_read_b128 a[244:247], v5 offset:16640
    v_add_f32 v25, v25, v33
    v_mfma_f32_16x16x32_bf16 v[80:83], a[232:235], a[40:43], v[80:83]
    ds_write2st64_b64 v1, v[96:97], v[100:101] offset0:0 offset1:1
    v_mfma_f32_16x16x32_bf16 v[84:87], a[232:235], a[72:75], v[84:87]
    v_exp_f32 v34, v68
    v_mfma_f32_16x16x32_bf16 v[88:91], a[232:235], a[104:107], v[88:91]
    s_waitcnt vmcnt(5)
    buffer_load_dwordx4 v0, s[16:19], s33 offen offset:2048 nt lds
    v_mfma_f32_16x16x32_bf16 v[92:95], a[232:235], a[136:139], v[92:95]
    s_waitcnt lgkmcnt(3)
    v_exp_f32 v35, v69
    v_mfma_f32_16x16x32_bf16 v[76:79], a[236:239], a[12:15], v[76:79]
    ds_read_b128 a[248:251], v6 offset:16640
    v_add_f32 v26, v26, v34
    v_mfma_f32_16x16x32_bf16 v[80:83], a[236:239], a[44:47], v[80:83]
    v_cvt_pk_bf16_f32 v104, v34, v35
    v_add_f32 v26, v26, v35
    v_mfma_f32_16x16x32_bf16 v[84:87], a[236:239], a[76:79], v[84:87]
    v_exp_f32 v30, v70
    v_mfma_f32_16x16x32_bf16 v[88:91], a[236:239], a[108:111], v[88:91]
    v_exp_f32 v31, v71
    v_mfma_f32_16x16x32_bf16 v[92:95], a[236:239], a[140:143], v[92:95]
    s_waitcnt lgkmcnt(3)
    s_waitcnt vmcnt(6)
    buffer_load_dwordx4 v0, s[16:19], s33 offen offset:3072 nt lds
    v_mfma_f32_16x16x32_bf16 v[76:79], a[240:243], a[16:19], v[76:79]
    ds_read_b128 a[252:255], v7 offset:16640
    v_add_f32 v26, v26, v30
    v_mfma_f32_16x16x32_bf16 v[80:83], a[240:243], a[48:51], v[80:83]
    v_cvt_pk_bf16_f32 v105, v30, v31
    v_add_f32 v26, v26, v31
    v_mfma_f32_16x16x32_bf16 v[84:87], a[240:243], a[80:83], v[84:87]
    v_exp_f32 v32, v72
    v_mfma_f32_16x16x32_bf16 v[88:91], a[240:243], a[112:115], v[88:91]
    v_exp_f32 v33, v73
    v_mfma_f32_16x16x32_bf16 v[92:95], a[240:243], a[144:147], v[92:95]
    s_waitcnt lgkmcnt(3)
    v_add_f32 v27, v27, v32
    v_cvt_pk_bf16_f32 v108, v32, v33
    v_mfma_f32_16x16x32_bf16 v[76:79], a[244:247], a[20:23], v[76:79]
    s_add_u32 s33, s33, 16384
    v_add_f32 v27, v27, v33
    v_mfma_f32_16x16x32_bf16 v[80:83], a[244:247], a[52:55], v[80:83]
    v_exp_f32 v34, v74
    v_mfma_f32_16x16x32_bf16 v[84:87], a[244:247], a[84:87], v[84:87]
    v_exp_f32 v35, v75
    v_mfma_f32_16x16x32_bf16 v[88:91], a[244:247], a[116:119], v[88:91]
    v_add_f32 v27, v27, v34
    v_cvt_pk_bf16_f32 v109, v34, v35
    v_add_f32 v27, v27, v35
    ds_write2st64_b64 v1, v[104:105], v[108:109] offset0:2 offset1:3
    v_mfma_f32_16x16x32_bf16 v[92:95], a[244:247], a[148:151], v[92:95]
    s_waitcnt lgkmcnt(1)
    s_waitcnt lgkmcnt(0)
    s_waitcnt vmcnt(16)
    s_barrier
    v_mfma_f32_16x16x32_bf16 v[76:79], a[248:251], a[24:27], v[76:79]
    ds_read_b64 v[98:99], v2 offset:0
    ds_read_b64 v[102:103], v2 offset:512
    v_mfma_f32_16x16x32_bf16 v[80:83], a[248:251], a[56:59], v[80:83]
    ds_read_b64 v[106:107], v2 offset:1024
    ds_read_b64 v[110:111], v2 offset:1536
    v_mfma_f32_16x16x32_bf16 v[84:87], a[248:251], a[88:91], v[84:87]
    ds_read_b64 v[38:39], v2 offset:2048
    v_mfma_f32_16x16x32_bf16 v[88:91], a[248:251], a[120:123], v[88:91]
    ds_read_b64_tr_b16 a[224:225], v8 offset:0
    ds_read_b64_tr_b16 a[226:227], v16 offset:0
    v_mfma_f32_16x16x32_bf16 v[92:95], a[248:251], a[152:155], v[92:95]
    ds_read_b64_tr_b16 a[228:229], v9 offset:0
    ds_read_b64_tr_b16 a[230:231], v17 offset:0
    v_mfma_f32_16x16x32_bf16 v[76:79], a[252:255], a[28:31], v[76:79]
    ds_read_b64_tr_b16 a[232:233], v10 offset:0
    ds_read_b64_tr_b16 a[234:235], v18 offset:0
    v_mfma_f32_16x16x32_bf16 v[80:83], a[252:255], a[60:63], v[80:83]
    s_add_u32 m0, s29, 16384
    s_waitcnt vmcnt(5)
    buffer_load_dwordx4 v0, s[12:15], s32 offen offset:0 nt lds
    v_mfma_f32_16x16x32_bf16 v[84:87], a[252:255], a[92:95], v[84:87]
    v_mfma_f32_16x16x32_bf16 v[88:91], a[252:255], a[124:127], v[88:91]
    v_mfma_f32_16x16x32_bf16 v[92:95], a[252:255], a[156:159], v[92:95]
    s_cbranch_vccnz L_rare8
L_back8:
    s_waitcnt lgkmcnt(4)
    v_mfma_f32_16x16x32_bf16 v[128:131], a[224:227], v[96:99], v[128:131]
    ds_read_b64_tr_b16 a[236:237], v11 offset:0
    ds_read_b64_tr_b16 a[238:239], v19 offset:0
    v_mfma_f32_16x16x32_bf16 v[160:163], a[224:227], v[100:103], v[160:163]
    v_mfma_f32_16x16x32_bf16 v[192:195], a[224:227], v[104:107], v[192:195]
    v_mfma_f32_16x16x32_bf16 v[224:227], a[224:227], v[108:111], v[224:227]
    v_mfma_f32_16x16x32_bf16 a[160:163], a[224:227], v[36:39], a[160:163]
    s_waitcnt lgkmcnt(4)
    v_mfma_f32_16x16x32_bf16 v[132:135], a[228:231], v[96:99], v[132:135]
    s_waitcnt vmcnt(6)
    buffer_load_dwordx4 v0, s[12:15], s32 offen offset:1024 nt lds
    v_mfma_f32_16x16x32_bf16 v[164:167], a[228:231], v[100:103], v[164:167]
    ds_read_b64_tr_b16 a[240:241], v12 offset:0
    ds_read_b64_tr_b16 a[242:243], v20 offset:0
    v_mfma_f32_16x16x32_bf16 v[196:199], a[228:231], v[104:107], v[196:199]
    v_exp_f32 v30, v76
    v_mfma_f32_16x16x32_bf16 v[228:231], a[228:231], v[108:111], v[228:231]
    v_exp_f32 v31, v77
    v_mfma_f32_16x16x32_bf16 a[164:167], a[228:231], v[36:39], a[164:167]
    s_waitcnt lgkmcnt(4)
    v_add_f32 v24, v24, v30
    v_cvt_pk_bf16_f32 v112, v30, v31
    v_mfma_f32_16x16x32_bf16 v[136:139], a[232:235], v[96:99], v[136:139]
    ds_read_b64_tr_b16 a[244:245], v13 offset:0
    ds_read_b64_tr_b16 a[246:247], v21 offset:0
    v_mfma_f32_16x16x32_bf16 v[168:171], a[232:235], v[100:103], v[168:171]
    v_add_f32 v24, v24, v31
    v_mfma_f32_16x16x32_bf16 v[200:203], a[232:235], v[104:107], v[200:203]
    v_exp_f32 v32, v78
    v_mfma_f32_16x16x32_bf16 v[232:235], a[232:235], v[108:111], v[232:235]
    v_exp_f32 v33, v79
    v_mfma_f32_16x16x32_bf16 a[168:171], a[232:235], v[36:39], a[168:171]
    s_waitcnt lgkmcnt(4)
    v_add_f32 v24, v24, v32
    v_cvt_pk_bf16_f32 v113, v32, v33
    v_mfma_f32_16x16x32_bf16 v[140:143], a[236:239], v[96:99], v[140:143]
    ds_read_b64_tr_b16 a[248:249], v14 offset:0
    ds_read_b64_tr_b16 a[250:251], v22 offset:0
    v_mfma_f32_16x16x32_bf16 v[172:175], a[236:239], v[100:103], v[172:175]
    s_waitcnt vmcnt(5)
    buffer_load_dwordx4 v0, s[12:15], s32 offen offset:2048 nt lds
    v_add_f32 v24, v24, v33
    v_mfma_f32_16x16x32_bf16 v[204:207], a[236:239], v[104:107], v[204:207]
    v_exp_f32 v34, v80
    v_mfma_f32_16x16x32_bf16 v[236:239], a[236:239], v[108:111], v[236:239]
    v_exp_f32 v35, v81
    v_mfma_f32_16x16x32_bf16 a[172:175], a[236:239], v[36:39], a[172:175]
    s_waitcnt lgkmcnt(4)
    v_add_f32 v25, v25, v34
    v_cvt_pk_bf16_f32 v116, v34, v35
    v_mfma_f32_16x16x32_bf16 v[144:147], a[240:243], v[96:99], v[144:147]
    ds_read_b64_tr_b16 a[252:253], v15 offset:0
    ds_read_b64_tr_b16 a[254:255], v23 offset:0
    v_mfma_f32_16x16x32_bf16 v[176:179], a[240:243], v[100:103], v[176:179]
    v_add_f32 v25, v25, v35
    v_mfma_f32_16x16x32_bf16 v[208:211], a[240:243], v[104:107], v[208:211]
    v_exp_f32 v30, v82
    v_mfma_f32_16x16x32_bf16 v[240:243], a[240:243], v[108:111], v[240:243]
    v_exp_f32 v31, v83
    v_mfma_f32_16x16x32_bf16 a[176:179], a[240:243], v[36:39], a[176:179]
    s_waitcnt lgkmcnt(4)
    v_add_f32 v25, v25, v30
    v_cvt_pk_bf16_f32 v117, v30, v31
    v_mfma_f32_16x16x32_bf16 v[148:151], a[244:247], v[96:99], v[148:151]
    ds_read_b128 a[224:227], v4 offset:32768
    v_add_f32 v25, v25, v31
    v_mfma_f32_16x16x32_bf16 v[180:183], a[244:247], v[100:103], v[180:183]
    ds_write2st64_b64 v1, v[112:113], v[116:117] offset0:5 offset1:6
    v_mfma_f32_16x16x32_bf16 v[212:215], a[244:247], v[104:107], v[212:215]
    s_waitcnt vmcnt(6)
    buffer_load_dwordx4 v0, s[12:15], s32 offen offset:3072 nt lds
    v_mfma_f32_16x16x32_bf16 v[244:247], a[244:247], v[108:111], v[244:247]
    v_exp_f32 v32, v84
    v_mfma_f32_16x16x32_bf16 a[180:183], a[244:247], v[36:39], a[180:183]
    s_waitcnt lgkmcnt(4)
    v_exp_f32 v33, v85
    v_mfma_f32_16x16x32_bf16 v[152:155], a[248:251], v[96:99], v[152:155]
    ds_read_b128 a[228:231], v5 offset:32768
    v_add_f32 v26, v26, v32
    v_mfma_f32_16x16x32_bf16 v[184:187], a[248:251], v[100:103], v[184:187]
    v_cvt_pk_bf16_f32 v120, v32, v33
    v_add_f32 v26, v26, v33
    v_mfma_f32_16x16x32_bf16 v[216:219], a[248:251], v[104:107], v[216:219]
    v_exp_f32 v34, v86
    v_mfma_f32_16x16x32_bf16 v[248:251], a[248:251], v[108:111], v[248:251]
    v_exp_f32 v35, v87
    v_mfma_f32_16x16x32_bf16 a[184:187], a[248:251], v[36:39], a[184:187]
    s_waitcnt lgkmcnt(3)
    v_add_f32 v26, v26, v34
    v_cvt_pk_bf16_f32 v121, v34, v35
    v_mfma_f32_16x16x32_bf16 v[156:159], a[252:255], v[96:99], v[156:159]
    ds_read_b128 a[232:235], v6 offset:32768
    v_add_f32 v26, v26, v35
    v_mfma_f32_16x16x32_bf16 v[188:191], a[252:255], v[100:103], v[188:191]
    v_mfma_f32_16x16x32_bf16 v[220:223], a[252:255], v[104:107], v[220:223]
    v_mfma_f32_16x16x32_bf16 v[252:255], a[252:255], v[108:111], v[252:255]
    s_add_u32 s32, s32, 16384
    v_mfma_f32_16x16x32_bf16 a[188:191], a[252:255], v[36:39], a[188:191]
    s_cbranch_vccnz L_rare9
L_back9:
    s_waitcnt lgkmcnt(3)
    v_mfma_f32_16x16x32_bf16 v[60:63], a[224:227], a[0:3], v[40:43]
    ds_read_b128 a[236:239], v7 offset:32768
    v_mfma_f32_16x16x32_bf16 v[64:67], a[224:227], a[32:35], v[44:47]
    s_add_u32 m0, s29, 114688
    s_waitcnt vmcnt(5)
    buffer_load_dwordx4 v0, s[16:19], s33 offen offset:0 nt lds
    v_mfma_f32_16x16x32_bf16 v[68:71], a[224:227], a[64:67], v[48:51]
    v_exp_f32 v30, v88
    v_mfma_f32_16x16x32_bf16 v[72:75], a[224:227], a[96:99], v[52:55]
    s_waitcnt lgkmcnt(2)
    v_exp_f32 v31, v89
    v_mfma_f32_16x16x32_bf16 v[60:63], a[228:231], a[4:7], v[60:63]
    ds_read_b128 a[240:243], v4 offset:33024
    v_add_f32 v27, v27, v30
    v_mfma_f32_16x16x32_bf16 v[64:67], a[228:231], a[36:39], v[64:67]
    s_waitcnt vmcnt(6)
    buffer_load_dwordx4 v0, s[16:19], s33 offen offset:1024 nt lds
    v_cvt_pk_bf16_f32 v124, v30, v31
    v_mfma_f32_16x16x32_bf16 v[68:71], a[228:231], a[68:71], v[68:71]
    v_add_f32 v27, v27, v31
    v_mfma_f32_16x16x32_bf16 v[72:75], a[228:231], a[100:103], v[72:75]
    s_waitcnt lgkmcnt(2)
    v_exp_f32 v32, v90
    v_mfma_f32_16x16x32_bf16 v[60:63], a[232:235], a[8:11], v[60:63]
    ds_read_b128 a[244:247], v5 offset:33024
    v_mfma_f32_16x16x32_bf16 v[64:67], a[232:235], a[40:43], v[64:67]
    s_waitcnt vmcnt(5)
    buffer_load_dwordx4 v0, s[16:19], s33 offen offset:2048 nt lds
    v_mfma_f32_16x16x32_bf16 v[68:71], a[232:235], a[72:75], v[68:71]
    v_exp_f32 v33, v91
    v_mfma_f32_16x16x32_bf16 v[72:75], a[232:235], a[104:107], v[72:75]
    s_waitcnt lgkmcnt(2)
    v_add_f32 v27, v27, v32
    v_cvt_pk_bf16_f32 v125, v32, v33
    v_mfma_f32_16x16x32_bf16 v[60:63], a[236:239], a[12:15], v[60:63]
    ds_read_b128 a[248:251], v6 offset:33024
    v_add_f32 v27, v27, v33
    v_mfma_f32_16x16x32_bf16 v[64:67], a[236:239], a[44:47], v[64:67]
    s_waitcnt vmcnt(6)
    buffer_load_dwordx4 v0, s[16:19], s33 offen offset:3072 nt lds
    v_mfma_f32_16x16x32_bf16 v[68:71], a[236:239], a[76:79], v[68:71]
    ds_write2st64_b64 v1, v[120:121], v[124:125] offset0:7 offset1:8
    v_mfma_f32_16x16x32_bf16 v[72:75], a[236:239], a[108:111], v[72:75]
    s_waitcnt lgkmcnt(3)
    v_exp_f32 v34, v92
    v_mfma_f32_16x16x32_bf16 v[60:63], a[240:243], a[16:19], v[60:63]
    ds_read_b128 a[252:255], v7 offset:33024
    v_mfma_f32_16x16x32_bf16 v[64:67], a[240:243], a[48:51], v[64:67]
    s_add_u32 s33, s33, 16384
    v_exp_f32 v35, v93
    v_mfma_f32_16x16x32_bf16 v[68:71], a[240:243], a[80:83], v[68:71]
    v_add_f32 v28, v28, v34
    v_cvt_pk_bf16_f32 v36, v34, v35
    v_mfma_f32_16x16x32_bf16 v[72:75], a[240:243], a[112:115], v[72:75]
    s_waitcnt lgkmcnt(3)
    v_add_f32 v28, v28, v35
    v_mfma_f32_16x16x32_bf16 v[60:63], a[244:247], a[20:23], v[60:63]
    v_exp_f32 v30, v94
    v_exp_f32 v31, v95
    v_add_f32 v28, v28, v30
    v_cvt_pk_bf16_f32 v37, v30, v31
    v_add_f32 v28, v28, v31
    ds_write_b64 v1, v[36:37] offset:4608
    v_mfma_f32_16x16x32_bf16 v[64:67], a[244:247], a[52:55], v[64:67]
    s_waitcnt lgkmcnt(1)
    s_waitcnt lgkmcnt(0)
    s_waitcnt vmcnt(16)
    s_barrier
    v_mfma_f32_16x16x32_bf16 v[68:71], a[244:247], a[84:87], v[68:71]
    ds_read_b64 v[114:115], v2 offset:2560
    ds_read_b64 v[118:119], v2 offset:3072
    v_mfma_f32_16x16x32_bf16 v[72:75], a[244:247], a[116:119], v[72:75]
    ds_read_b64 v[122:123], v2 offset:3584
    ds_read_b64 v[126:127], v2 offset:4096
    v_mfma_f32_16x16x32_bf16 v[60:63], a[248:251], a[24:27], v[60:63]
    ds_read_b64 v[38:39], v2 offset:4608
    v_mfma_f32_16x16x32_bf16 v[64:67], a[248:251], a[56:59], v[64:67]
    ds_read_b64_tr_b16 a[224:225], v8 offset:16384
    ds_read_b64_tr_b16 a[226:227], v16 offset:16384
    v_mfma_f32_16x16x32_bf16 v[68:71], a[248:251], a[88:91], v[68:71]
    ds_read_b64_tr_b16 a[228:229], v9 offset:16384
    ds_read_b64_tr_b16 a[230:231], v17 offset:16384
    v_mfma_f32_16x16x32_bf16 v[72:75], a[248:251], a[120:123], v[72:75]
    ds_read_b64_tr_b16 a[232:233], v10 offset:16384
    ds_read_b64_tr_b16 a[234:235], v18 offset:16384
    v_mfma_f32_16x16x32_bf16 v[60:63], a[252:255], a[28:31], v[60:63]
    s_add_u32 m0, s29, 32768
    s_waitcnt vmcnt(5)
    buffer_load_dwordx4 v0, s[12:15], s32 offen offset:0 nt lds
    v_mfma_f32_16x16x32_bf16 v[64:67], a[252:255], a[60:63], v[64:67]
    v_mfma_f32_16x16x32_bf16 v[68:71], a[252:255], a[92:95], v[68:71]
    v_mfma_f32_16x16x32_bf16 v[72:75], a[252:255], a[124:127], v[72:75]
    s_cbranch_vccnz L_rare10
L_back10:
    s_waitcnt lgkmcnt(4)
    v_mfma_f32_16x16x32_bf16 v[128:131], a[224:227], v[112:115], v[128:131]
    ds_read_b64_tr_b16 a[236:237], v11 offset:16384
    ds_read_b64_tr_b16 a[238:239], v19 offset:16384
    v_mfma_f32_16x16x32_bf16 v[160:163], a[224:227], v[116:119], v[160:163]
    v_mfma_f32_16x16x32_bf16 v[192:195], a[224:227], v[120:123], v[192:195]
    v_mfma_f32_16x16x32_bf16 v[224:227], a[224:227], v[124:127], v[224:227]
    v_mfma_f32_16x16x32_bf16 a[160:163], a[224:227], v[36:39], a[160:163]
    s_waitcnt lgkmcnt(4)
    v_mfma_f32_16x16x32_bf16 v[132:135], a[228:231], v[112:115], v[132:135]
    s_waitcnt vmcnt(6)
    buffer_load_dwordx4 v0, s[12:15], s32 offen offset:1024 nt lds
    v_mfma_f32_16x16x32_bf16 v[164:167], a[228:231], v[116:119], v[164:167]
    ds_read_b64_tr_b16 a[240:241], v12 offset:16384
    ds_read_b64_tr_b16 a[242:243], v20 offset:16384
    v_mfma_f32_16x16x32_bf16 v[196:199], a[228:231], v[120:123], v[196:199]
    v_exp_f32 v32, v60
    v_mfma_f32_16x16x32_bf16 v[228:231], a[228:231], v[124:127], v[228:231]
    v_exp_f32 v33, v61
    v_mfma_f32_16x16x32_bf16 a[164:167], a[228:231], v[36:39], a[164:167]
    s_waitcnt lgkmcnt(4)
    v_add_f32 v24, v24, v32
    v_cvt_pk_bf16_f32 v96, v32, v33
    v_mfma_f32_16x16x32_bf16 v[136:139], a[232:235], v[112:115], v[136:139]
    ds_read_b64_tr_b16 a[244:245], v13 offset:16384
    ds_read_b64_tr_b16 a[246:247], v21 offset:16384
    v_mfma_f32_16x16x32_bf16 v[168:171], a[232:235], v[116:119], v[168:171]
    v_add_f32 v24, v24, v33
    v_mfma_f32_16x16x32_bf16 v[200:203], a[232:235], v[120:123], v[200:203]
    v_exp_f32 v34, v62
    v_mfma_f32_16x16x32_bf16 v[232:235], a[232:235], v[124:127], v[232:235]
    v_exp_f32 v35, v63
    v_mfma_f32_16x16x32_bf16 a[168:171], a[232:235], v[36:39], a[168:171]
    s_waitcnt lgkmcnt(4)
    v_add_f32 v24, v24, v34
    v_cvt_pk_bf16_f32 v97, v34, v35
    v_mfma_f32_16x16x32_bf16 v[140:143], a[236:239], v[112:115], v[140:143]
    ds_read_b64_tr_b16 a[248:249], v14 offset:16384
    ds_read_b64_tr_b16 a[250:251], v22 offset:16384
    v_mfma_f32_16x16x32_bf16 v[172:175], a[236:239], v[116:119], v[172:175]
    s_waitcnt vmcnt(5)
    buffer_load_dwordx4 v0, s[12:15], s32 offen offset:2048 nt lds
    v_add_f32 v24, v24, v35
    v_mfma_f32_16x16x32_bf16 v[204:207], a[236:239], v[120:123], v[204:207]
    v_exp_f32 v30, v64
    v_mfma_f32_16x16x32_bf16 v[236:239], a[236:239], v[124:127], v[236:239]
    v_exp_f32 v31, v65
    v_mfma_f32_16x16x32_bf16 a[172:175], a[236:239], v[36:39], a[172:175]
    s_waitcnt lgkmcnt(4)
    v_add_f32 v25, v25, v30
    v_cvt_pk_bf16_f32 v100, v30, v31
    v_mfma_f32_16x16x32_bf16 v[144:147], a[240:243], v[112:115], v[144:147]
    ds_read_b64_tr_b16 a[252:253], v15 offset:16384
    ds_read_b64_tr_b16 a[254:255], v23 offset:16384
    v_mfma_f32_16x16x32_bf16 v[176:179], a[240:243], v[116:119], v[176:179]
    v_add_f32 v25, v25, v31
    v_mfma_f32_16x16x32_bf16 v[208:211], a[240:243], v[120:123], v[208:211]
    v_exp_f32 v32, v66
    v_mfma_f32_16x16x32_bf16 v[240:243], a[240:243], v[124:127], v[240:243]
    v_exp_f32 v33, v67
    v_mfma_f32_16x16x32_bf16 a[176:179], a[240:243], v[36:39], a[176:179]
    s_waitcnt lgkmcnt(4)
    v_add_f32 v25, v25, v32
    v_cvt_pk_bf16_f32 v101, v32, v33
    v_mfma_f32_16x16x32_bf16 v[148:151], a[244:247], v[112:115], v[148:151]
    ds_read_b128 a[224:227], v4 offset:49152
    v_add_f32 v25, v25, v33
    v_mfma_f32_16x16x32_bf16 v[180:183], a[244:247], v[116:119], v[180:183]
    ds_write2st64_b64 v1, v[96:97], v[100:101] offset0:0 offset1:1
    v_mfma_f32_16x16x32_bf16 v[212:215], a[244:247], v[120:123], v[212:215]
    s_waitcnt vmcnt(6)
    buffer_load_dwordx4 v0, s[12:15], s32 offen offset:3072 nt lds
    v_mfma_f32_16x16x32_bf16 v[244:247], a[244:247], v[124:127], v[244:247]
    v_mfma_f32_16x16x32_bf16 a[180:183], a[244:247], v[36:39], a[180:183]
    s_waitcnt lgkmcnt(4)
    v_mfma_f32_16x16x32_bf16 v[152:155], a[248:251], v[112:115], v[152:155]
    ds_read_b128 a[228:231], v5 offset:49152
    v_mfma_f32_16x16x32_bf16 v[184:187], a[248:251], v[116:119], v[184:187]
    v_mfma_f32_16x16x32_bf16 v[216:219], a[248:251], v[120:123], v[216:219]
    v_mfma_f32_16x16x32_bf16 v[248:251], a[248:251], v[124:127], v[248:251]
    v_mfma_f32_16x16x32_bf16 a[184:187], a[248:251], v[36:39], a[184:187]
    s_waitcnt lgkmcnt(3)
    v_mfma_f32_16x16x32_bf16 v[156:159], a[252:255], v[112:115], v[156:159]
    ds_read_b128 a[232:235], v6 offset:49152
    v_mfma_f32_16x16x32_bf16 v[188:191], a[252:255], v[116:119], v[188:191]
    v_mfma_f32_16x16x32_bf16 v[220:223], a[252:255], v[120:123], v[220:223]
    v_mfma_f32_16x16x32_bf16 v[252:255], a[252:255], v[124:127], v[252:255]
    s_add_u32 s32, s32, 16384
    v_mfma_f32_16x16x32_bf16 a[188:191], a[252:255], v[36:39], a[188:191]
    s_cbranch_vccnz L_rare11
L_back11:
    s_waitcnt lgkmcnt(3)
    v_mfma_f32_16x16x32_bf16 v[76:79], a[224:227], a[0:3], v[40:43]
    ds_read_b128 a[236:239], v7 offset:49152
    v_mfma_f32_16x16x32_bf16 v[80:83], a[224:227], a[32:35], v[44:47]
    s_add_u32 m0, s29, 65536
    s_waitcnt vmcnt(5)
    buffer_load_dwordx4 v0, s[16:19], s33 offen offset:0 nt lds
    v_mfma_f32_16x16x32_bf16 v[84:87], a[224:227], a[64:67], v[48:51]
    v_exp_f32 v34, v68
    v_mfma_f32_16x16x32_bf16 v[88:91], a[224:227], a[96:99], v[52:55]
    s_waitcnt lgkmcnt(2)
    v_exp_f32 v35, v69
    v_mfma_f32_16x16x32_bf16 v[76:79], a[228:231], a[4:7], v[76:79]
    ds_read_b128 a[240:243], v4 offset:49408
    v_add_f32 v26, v26, v34
    v_mfma_f32_16x16x32_bf16 v[80:83], a[228:231], a[36:39], v[80:83]
    s_waitcnt vmcnt(6)
    buffer_load_dwordx4 v0, s[16:19], s33 offen offset:1024 nt lds
    v_cvt_pk_bf16_f32 v104, v34, v35
    v_mfma_f32_16x16x32_bf16 v[84:87], a[228:231], a[68:71], v[84:87]
    v_add_f32 v26, v26, v35
    v_mfma_f32_16x16x32_bf16 v[88:91], a[228:231], a[100:103], v[88:91]
    s_waitcnt lgkmcnt(2)
    v_exp_f32 v30, v70
    v_mfma_f32_16x16x32_bf16 v[76:79], a[232:235], a[8:11], v[76:79]
    ds_read_b128 a[244:247], v5 offset:49408
    v_mfma_f32_16x16x32_bf16 v[80:83], a[232:235], a[40:43], v[80:83]
    s_waitcnt vmcnt(5)
    buffer_load_dwordx4 v0, s[16:19], s33 offen offset:2048 nt lds
    v_mfma_f32_16x16x32_bf16 v[84:87], a[232:235], a[72:75], v[84:87]
    v_exp_f32 v31, v71
    v_mfma_f32_16x16x32_bf16 v[88:91], a[232:235], a[104:107], v[88:91]
    s_waitcnt lgkmcnt(2)
    v_add_f32 v26, v26, v30
    v_cvt_pk_bf16_f32 v105, v30, v31
    v_mfma_f32_16x16x32_bf16 v[76:79], a[236:239], a[12:15], v[76:79]
    ds_read_b128 a[248:251], v6 offset:49408
    v_add_f32 v26, v26, v31
    v_mfma_f32_16x16x32_bf16 v[80:83], a[236:239], a[44:47], v[80:83]
    s_waitcnt vmcnt(6)
    buffer_load_dwordx4 v0, s[16:19], s33 offen offset:3072 nt lds
    v_mfma_f32_16x16x32_bf16 v[84:87], a[236:239], a[76:79], v[84:87]
    v_exp_f32 v32, v72
    v_mfma_f32_16x16x32_bf16 v[88:91], a[236:239], a[108:111], v[88:91]
    s_waitcnt lgkmcnt(2)
    v_exp_f32 v33, v73
    v_mfma_f32_16x16x32_bf16 v[76:79], a[240:243], a[16:19], v[76:79]
    ds_read_b128 a[252:255], v7 offset:49408
    v_add_f32 v27, v27, v32
    v_mfma_f32_16x16x32_bf16 v[80:83], a[240:243], a[48:51], v[80:83]
    s_add_u32 s33, s33, 16384
    v_cvt_pk_bf16_f32 v108, v32, v33
    v_add_f32 v27, v27, v33
    v_mfma_f32_16x16x32_bf16 v[84:87], a[240:243], a[80:83], v[84:87]
    v_exp_f32 v34, v74
    v_mfma_f32_16x16x32_bf16 v[88:91], a[240:243], a[112:115], v[88:91]
    s_waitcnt lgkmcnt(2)
    v_exp_f32 v35, v75
    v_mfma_f32_16x16x32_bf16 v[76:79], a[244:247], a[20:23], v[76:79]
    v_add_f32 v27, v27, v34
    v_cvt_pk_bf16_f32 v109, v34, v35
    v_add_f32 v27, v27, v35
    ds_write2st64_b64 v1, v[104:105], v[108:109] offset0:2 offset1:3
    v_mfma_f32_16x16x32_bf16 v[80:83], a[244:247], a[52:55], v[80:83]
    s_waitcnt lgkmcnt(1)
    s_waitcnt lgkmcnt(0)
    s_barrier
    v_mfma_f32_16x16x32_bf16 v[84:87], a[244:247], a[84:87], v[84:87]
    ds_read_b64 v[98:99], v2 offset:0
    ds_read_b64 v[102:103], v2 offset:512
    v_mfma_f32_16x16x32_bf16 v[88:91], a[244:247], a[116:119], v[88:91]
    ds_read_b64 v[106:107], v2 offset:1024
    ds_read_b64 v[110:111], v2 offset:1536
    v_mfma_f32_16x16x32_bf16 v[76:79], a[248:251], a[24:27], v[76:79]
    ds_read_b64_tr_b16 a[224:225], v8 offset:32768
    ds_read_b64_tr_b16 a[226:227], v16 offset:32768
    v_mfma_f32_16x16x32_bf16 v[80:83], a[248:251], a[56:59], v[80:83]
    ds_read_b64_tr_b16 a[228:229], v9 offset:32768
    ds_read_b64_tr_b16 a[230:231], v17 offset:32768
    v_mfma_f32_16x16x32_bf16 v[84:87], a[248:251], a[88:91], v[84:87]
    s_add_u32 m0, s29, 49152
    s_waitcnt vmcnt(5)
    buffer_load_dwordx4 v0, s[12:15], s32 offen offset:0 nt lds
    v_mfma_f32_16x16x32_bf16 v[88:91], a[248:251], a[120:123], v[88:91]
    ds_read_b64_tr_b16 a[232:233], v10 offset:32768
    ds_read_b64_tr_b16 a[234:235], v18 offset:32768
    v_mfma_f32_16x16x32_bf16 v[76:79], a[252:255], a[28:31], v[76:79]
    v_mfma_f32_16x16x32_bf16 v[80:83], a[252:255], a[60:63], v[80:83]
    v_mfma_f32_16x16x32_bf16 v[84:87], a[252:255], a[92:95], v[84:87]
    v_mfma_f32_16x16x32_bf16 v[88:91], a[252:255], a[124:127], v[88:91]
    s_cbranch_vccnz L_rare12
L_back12:
    s_waitcnt lgkmcnt(4)
    v_mfma_f32_16x16x32_bf16 v[128:131], a[224:227], v[96:99], v[128:131]
    ds_read_b64_tr_b16 a[236:237], v11 offset:32768
    ds_read_b64_tr_b16 a[238:239], v19 offset:32768
    v_mfma_f32_16x16x32_bf16 v[160:163], a[224:227], v[100:103], v[160:163]
    v_mfma_f32_16x16x32_bf16 v[192:195], a[224:227], v[104:107], v[192:195]
    v_mfma_f32_16x16x32_bf16 v[224:227], a[224:227], v[108:111], v[224:227]
    s_waitcnt lgkmcnt(4)
    s_waitcnt vmcnt(6)
    buffer_load_dwordx4 v0, s[12:15], s32 offen offset:1024 nt lds
    v_mfma_f32_16x16x32_bf16 v[132:135], a[228:231], v[96:99], v[132:135]
    ds_read_b64_tr_b16 a[240:241], v12 offset:32768
    ds_read_b64_tr_b16 a[242:243], v20 offset:32768
    v_mfma_f32_16x16x32_bf16 v[164:167], a[228:231], v[100:103], v[164:167]
    v_exp_f32 v30, v76
    v_mfma_f32_16x16x32_bf16 v[196:199], a[228:231], v[104:107], v[196:199]
    v_exp_f32 v31, v77
    v_mfma_f32_16x16x32_bf16 v[228:231], a[228:231], v[108:111], v[228:231]
    s_waitcnt lgkmcnt(4)
    v_add_f32 v24, v24, v30
    v_cvt_pk_bf16_f32 v112, v30, v31
    v_mfma_f32_16x16x32_bf16 v[136:139], a[232:235], v[96:99], v[136:139]
    ds_read_b64_tr_b16 a[244:245], v13 offset:32768
    ds_read_b64_tr_b16 a[246:247], v21 offset:32768
    v_mfma_f32_16x16x32_bf16 v[168:171], a[232:235], v[100:103], v[168:171]
    v_add_f32 v24, v24, v31
    v_mfma_f32_16x16x32_bf16 v[200:203], a[232:235], v[104:107], v[200:203]
    v_exp_f32 v32, v78
    v_mfma_f32_16x16x32_bf16 v[232:235], a[232:235], v[108:111], v[232:235]
    s_waitcnt lgkmcnt(4)
    v_exp_f32 v33, v79
    v_mfma_f32_16x16x32_bf16 v[140:143], a[236:239], v[96:99], v[140:143]
    s_waitcnt vmcnt(5)
    buffer_load_dwordx4 v0, s[12:15], s32 offen offset:2048 nt lds
    v_add_f32 v24, v24, v32
    v_mfma_f32_16x16x32_bf16 v[172:175], a[236:239], v[100:103], v[172:175]
    ds_read_b64_tr_b16 a[248:249], v14 offset:32768
    ds_read_b64_tr_b16 a[250:251], v22 offset:32768
    v_mfma_f32_16x16x32_bf16 v[204:207], a[236:239], v[104:107], v[204:207]
    v_cvt_pk_bf16_f32 v113, v32, v33
    v_add_f32 v24, v24, v33
    v_mfma_f32_16x16x32_bf16 v[236:239], a[236:239], v[108:111], v[236:239]
    s_waitcnt lgkmcnt(4)
    v_exp_f32 v34, v80
    v_mfma_f32_16x16x32_bf16 v[144:147], a[240:243], v[96:99], v[144:147]
    ds_read_b64_tr_b16 a[252:253], v15 offset:32768
    ds_read_b64_tr_b16 a[254:255], v23 offset:32768
    v_mfma_f32_16x16x32_bf16 v[176:179], a[240:243], v[100:103], v[176:179]
    v_exp_f32 v35, v81
    v_mfma_f32_16x16x32_bf16 v[208:211], a[240:243], v[104:107], v[208:211]
    v_add_f32 v25, v25, v34
    v_cvt_pk_bf16_f32 v116, v34, v35
    v_mfma_f32_16x16x32_bf16 v[240:243], a[240:243], v[108:111], v[240:243]
    s_waitcnt lgkmcnt(4)
    v_add_f32 v25, v25, v35
    v_mfma_f32_16x16x32_bf16 v[148:151], a[244:247], v[96:99], v[148:151]
    ds_read_b128 a[224:227], v4 offset:0
    v_mfma_f32_16x16x32_bf16 v[180:183], a[244:247], v[100:103], v[180:183]
    s_waitcnt vmcnt(6)
    buffer_load_dwordx4 v0, s[12:15], s32 offen offset:3072 nt lds
    v_mfma_f32_16x16x32_bf16 v[212:215], a[244:247], v[104:107], v[212:215]
    v_exp_f32 v30, v82
    v_mfma_f32_16x16x32_bf16 v[244:247], a[244:247], v[108:111], v[244:247]
    s_waitcnt lgkmcnt(3)
    v_exp_f32 v31, v83
    v_mfma_f32_16x16x32_bf16 v[152:155], a[248:251], v[96:99], v[152:155]
    ds_read_b128 a[228:231], v5 offset:0
    v_add_f32 v25, v25, v30
    v_mfma_f32_16x16x32_bf16 v[184:187], a[248:251], v[100:103], v[184:187]
    v_cvt_pk_bf16_f32 v117, v30, v31
    v_add_f32 v25, v25, v31
    v_mfma_f32_16x16x32_bf16 v[216:219], a[248:251], v[104:107], v[216:219]
    ds_write2st64_b64 v1, v[112:113], v[116:117] offset0:5 offset1:6
    v_mfma_f32_16x16x32_bf16 v[248:251], a[248:251], v[108:111], v[248:251]
    s_waitcnt lgkmcnt(3)
    v_mfma_f32_16x16x32_bf16 v[156:159], a[252:255], v[96:99], v[156:159]
    ds_read_b128 a[232:235], v6 offset:0
    v_mfma_f32_16x16x32_bf16 v[188:191], a[252:255], v[100:103], v[188:191]
    v_mfma_f32_16x16x32_bf16 v[220:223], a[252:255], v[104:107], v[220:223]
    s_add_u32 s32, s32, 16384
    v_mfma_f32_16x16x32_bf16 v[252:255], a[252:255], v[108:111], v[252:255]
    s_cbranch_vccnz L_rare13
L_back13:
    v_mbcnt_lo_u32_b32 v30, -1, 0
    v_mbcnt_hi_u32_b32 v30, -1, v30
    v_lshrrev_b32 v29, 4, v30
    v_lshlrev_b32 v29, 1, v29
    v_xor_b32 v29, v29, v30
    v_and_b32 v29, 7, v29
    v_lshlrev_b32 v29, 4, v29
    v_lshrrev_b32 v30, 3, v30
    v_mul_u32_u24 v30, 896, v30
    v_add_u32 v29, v29, v30
    s_mul_i32 s99, s28, 28672
    v_add_u32 v29, s99, v29
    s_waitcnt lgkmcnt(3)
    v_mfma_f32_16x16x32_bf16 v[60:63], a[224:227], a[0:3], v[40:43]
    ds_read_b128 a[236:239], v7 offset:0
    v_mfma_f32_16x16x32_bf16 v[64:67], a[224:227], a[32:35], v[44:47]
    s_add_u32 m0, s29, 81920
    s_waitcnt vmcnt(5)
    buffer_load_dwordx4 v0, s[16:19], s33 offen offset:0 nt lds
    v_mfma_f32_16x16x32_bf16 v[68:71], a[224:227], a[64:67], v[48:51]
    v_exp_f32 v32, v84
    v_mfma_f32_16x16x32_bf16 v[72:75], a[224:227], a[96:99], v[52:55]
    v_exp_f32 v33, v85
    v_mfma_f32_16x16x32_bf16 v[92:95], a[224:227], a[128:131], v[56:59]
    s_waitcnt lgkmcnt(3)
    v_add_f32 v26, v26, v32
    v_cvt_pk_bf16_f32 v120, v32, v33
    v_mfma_f32_16x16x32_bf16 v[60:63], a[228:231], a[4:7], v[60:63]
    ds_read_b128 a[240:243], v4 offset:256
    v_add_f32 v26, v26, v33
    v_mfma_f32_16x16x32_bf16 v[64:67], a[228:231], a[36:39], v[64:67]
    v_exp_f32 v34, v86
    v_mfma_f32_16x16x32_bf16 v[68:71], a[228:231], a[68:71], v[68:71]
    s_waitcnt vmcnt(6)
    buffer_load_dwordx4 v0, s[16:19], s33 offen offset:1024 nt lds
    v_mfma_f32_16x16x32_bf16 v[72:75], a[228:231], a[100:103], v[72:75]
    v_exp_f32 v35, v87
    v_mfma_f32_16x16x32_bf16 v[92:95], a[228:231], a[132:135], v[92:95]
    s_waitcnt lgkmcnt(2)
    v_add_f32 v26, v26, v34
    v_cvt_pk_bf16_f32 v121, v34, v35
    v_mfma_f32_16x16x32_bf16 v[60:63], a[232:235], a[8:11], v[60:63]
    ds_read_b128 a[244:247], v5 offset:256
    v_add_f32 v26, v26, v35
    v_mfma_f32_16x16x32_bf16 v[64:67], a[232:235], a[40:43], v[64:67]
    v_exp_f32 v30, v88
    v_mfma_f32_16x16x32_bf16 v[68:71], a[232:235], a[72:75], v[68:71]
    v_exp_f32 v31, v89
    v_mfma_f32_16x16x32_bf16 v[72:75], a[232:235], a[104:107], v[72:75]
    s_waitcnt vmcnt(5)
    buffer_load_dwordx4 v0, s[16:19], s33 offen offset:2048 nt lds
    v_add_f32 v27, v27, v30
    v_mfma_f32_16x16x32_bf16 v[92:95], a[232:235], a[136:139], v[92:95]
    s_waitcnt lgkmcnt(2)
    v_cvt_pk_bf16_f32 v124, v30, v31
    v_add_f32 v27, v27, v31
    v_mfma_f32_16x16x32_bf16 v[60:63], a[236:239], a[12:15], v[60:63]
    ds_read_b128 a[248:251], v6 offset:256
    v_mfma_f32_16x16x32_bf16 v[64:67], a[236:239], a[44:47], v[64:67]
    v_exp_f32 v32, v90
    v_mfma_f32_16x16x32_bf16 v[68:71], a[236:239], a[76:79], v[68:71]
    v_exp_f32 v33, v91
    v_mfma_f32_16x16x32_bf16 v[72:75], a[236:239], a[108:111], v[72:75]
    v_add_f32 v27, v27, v32
    v_cvt_pk_bf16_f32 v125, v32, v33
    v_mfma_f32_16x16x32_bf16 v[92:95], a[236:239], a[140:143], v[92:95]
    s_waitcnt lgkmcnt(2)
    s_waitcnt vmcnt(6)
    buffer_load_dwordx4 v0, s[16:19], s33 offen offset:3072 nt lds
    v_mfma_f32_16x16x32_bf16 v[60:63], a[240:243], a[16:19], v[60:63]
    ds_read_b128 a[252:255], v7 offset:256
    v_add_f32 v27, v27, v33
    v_mfma_f32_16x16x32_bf16 v[64:67], a[240:243], a[48:51], v[64:67]
    ds_write2st64_b64 v1, v[120:121], v[124:125] offset0:7 offset1:8
    v_mfma_f32_16x16x32_bf16 v[68:71], a[240:243], a[80:83], v[68:71]
    v_mfma_f32_16x16x32_bf16 v[72:75], a[240:243], a[112:115], v[72:75]
    v_mfma_f32_16x16x32_bf16 v[92:95], a[240:243], a[144:147], v[92:95]
    s_waitcnt lgkmcnt(3)
    v_mfma_f32_16x16x32_bf16 v[60:63], a[244:247], a[20:23], v[60:63]
    s_add_u32 s33, s33, 16384
    v_mfma_f32_16x16x32_bf16 v[64:67], a[244:247], a[52:55], v[64:67]
    v_mfma_f32_16x16x32_bf16 v[68:71], a[244:247], a[84:87], v[68:71]
    v_mfma_f32_16x16x32_bf16 v[72:75], a[244:247], a[116:119], v[72:75]
    v_mfma_f32_16x16x32_bf16 v[92:95], a[244:247], a[148:151], v[92:95]
    s_waitcnt lgkmcnt(1)
    s_waitcnt lgkmcnt(0)
    s_barrier
    v_mfma_f32_16x16x32_bf16 v[60:63], a[248:251], a[24:27], v[60:63]
    ds_read_b64 v[114:115], v2 offset:2560
    ds_read_b64 v[118:119], v2 offset:3072
    v_mfma_f32_16x16x32_bf16 v[64:67], a[248:251], a[56:59], v[64:67]
    ds_read_b64 v[122:123], v2 offset:3584
    ds_read_b64 v[126:127], v2 offset:4096
    v_mfma_f32_16x16x32_bf16 v[68:71], a[248:251], a[88:91], v[68:71]
    ds_read_b64_tr_b16 a[224:225], v8 offset:49152
    ds_read_b64_tr_b16 a[226:227], v16 offset:49152
    v_mfma_f32_16x16x32_bf16 v[72:75], a[248:251], a[120:123], v[72:75]
    ds_read_b64_tr_b16 a[228:229], v9 offset:49152
    ds_read_b64_tr_b16 a[230:231], v17 offset:49152
    v_mfma_f32_16x16x32_bf16 v[92:95], a[248:251], a[152:155], v[92:95]
    s_add_u32 m0, s29, 0
    s_mov_b32 s34, 128
    buffer_load_dwordx4 v29, s[20:23], s34 offen offset:0 nt lds
    v_mfma_f32_16x16x32_bf16 v[60:63], a[252:255], a[28:31], v[60:63]
    ds_read_b64_tr_b16 a[232:233], v10 offset:49152
    ds_read_b64_tr_b16 a[234:235], v18 offset:49152
    v_mfma_f32_16x16x32_bf16 v[64:67], a[252:255], a[60:63], v[64:67]
    v_mfma_f32_16x16x32_bf16 v[68:71], a[252:255], a[92:95], v[68:71]
    v_mfma_f32_16x16x32_bf16 v[72:75], a[252:255], a[124:127], v[72:75]
    v_mfma_f32_16x16x32_bf16 v[92:95], a[252:255], a[156:159], v[92:95]
    s_cbranch_vccnz L_rare14
L_back14:
    s_waitcnt lgkmcnt(4)
    v_mfma_f32_16x16x32_bf16 v[128:131], a[224:227], v[112:115], v[128:131]
    ds_read_b64_tr_b16 a[236:237], v11 offset:49152
    ds_read_b64_tr_b16 a[238:239], v19 offset:49152
    v_mfma_f32_16x16x32_bf16 v[160:163], a[224:227], v[116:119], v[160:163]
    v_mfma_f32_16x16x32_bf16 v[192:195], a[224:227], v[120:123], v[192:195]
    v_mfma_f32_16x16x32_bf16 v[224:227], a[224:227], v[124:127], v[224:227]
    s_waitcnt lgkmcnt(4)
    s_mov_b32 s34, 6272
    buffer_load_dwordx4 v29, s[20:23], s34 offen offset:1024 nt lds
    v_mfma_f32_16x16x32_bf16 v[132:135], a[228:231], v[112:115], v[132:135]
    ds_read_b64_tr_b16 a[240:241], v12 offset:49152
    ds_read_b64_tr_b16 a[242:243], v20 offset:49152
    v_mfma_f32_16x16x32_bf16 v[164:167], a[228:231], v[116:119], v[164:167]
    v_exp_f32 v34, v92
    v_mfma_f32_16x16x32_bf16 v[196:199], a[228:231], v[120:123], v[196:199]
    v_exp_f32 v35, v93
    v_mfma_f32_16x16x32_bf16 v[228:231], a[228:231], v[124:127], v[228:231]
    s_waitcnt lgkmcnt(4)
    v_add_f32 v28, v28, v34
    v_cvt_pk_bf16_f32 v36, v34, v35
    v_mfma_f32_16x16x32_bf16 v[136:139], a[232:235], v[112:115], v[136:139]
    ds_read_b64_tr_b16 a[244:245], v13 offset:49152
    ds_read_b64_tr_b16 a[246:247], v21 offset:49152
    v_mfma_f32_16x16x32_bf16 v[168:171], a[232:235], v[116:119], v[168:171]
    v_add_f32 v28, v28, v35
    v_mfma_f32_16x16x32_bf16 v[200:203], a[232:235], v[120:123], v[200:203]
    v_exp_f32 v30, v94
    v_mfma_f32_16x16x32_bf16 v[232:235], a[232:235], v[124:127], v[232:235]
    s_waitcnt lgkmcnt(4)
    v_exp_f32 v31, v95
    v_mfma_f32_16x16x32_bf16 v[140:143], a[236:239], v[112:115], v[140:143]
    s_mov_b32 s34, 12416
    buffer_load_dwordx4 v29, s[20:23], s34 offen offset:2048 nt lds
    v_add_f32 v28, v28, v30
    v_mfma_f32_16x16x32_bf16 v[172:175], a[236:239], v[116:119], v[172:175]
    ds_read_b64_tr_b16 a[248:249], v14 offset:49152
    ds_read_b64_tr_b16 a[250:251], v22 offset:49152
    v_mfma_f32_16x16x32_bf16 v[204:207], a[236:239], v[120:123], v[204:207]
    v_cvt_pk_bf16_f32 v37, v30, v31
    v_add_f32 v28, v28, v31
    v_mfma_f32_16x16x32_bf16 v[236:239], a[236:239], v[124:127], v[236:239]
    s_waitcnt lgkmcnt(4)
    ds_write_b64 v1, v[36:37] offset:2048
    v_mfma_f32_16x16x32_bf16 v[144:147], a[240:243], v[112:115], v[144:147]
    ds_read_b64_tr_b16 a[252:253], v15 offset:49152
    ds_read_b64_tr_b16 a[254:255], v23 offset:49152
    v_mfma_f32_16x16x32_bf16 v[176:179], a[240:243], v[116:119], v[176:179]
    v_exp_f32 v32, v60
    v_mfma_f32_16x16x32_bf16 v[208:211], a[240:243], v[120:123], v[208:211]
    v_exp_f32 v33, v61
    v_mfma_f32_16x16x32_bf16 v[240:243], a[240:243], v[124:127], v[240:243]
    s_waitcnt lgkmcnt(5)
    v_add_f32 v24, v24, v32
    v_cvt_pk_bf16_f32 v96, v32, v33
    v_mfma_f32_16x16x32_bf16 v[148:151], a[244:247], v[112:115], v[148:151]
    ds_read_b128 a[224:227], v4 offset:16384
    v_add_f32 v24, v24, v33
    v_mfma_f32_16x16x32_bf16 v[180:183], a[244:247], v[116:119], v[180:183]
    s_mov_b32 s34, 18560
    buffer_load_dwordx4 v29, s[20:23], s34 offen offset:3072 nt lds
    v_mfma_f32_16x16x32_bf16 v[212:215], a[244:247], v[120:123], v[212:215]
    v_exp_f32 v34, v62
    v_mfma_f32_16x16x32_bf16 v[244:247], a[244:247], v[124:127], v[244:247]
    s_waitcnt lgkmcnt(4)
    v_exp_f32 v35, v63
    v_mfma_f32_16x16x32_bf16 v[152:155], a[248:251], v[112:115], v[152:155]
    ds_read_b128 a[228:231], v5 offset:16384
    v_add_f32 v24, v24, v34
    v_mfma_f32_16x16x32_bf16 v[184:187], a[248:251], v[116:119], v[184:187]
    v_cvt_pk_bf16_f32 v97, v34, v35
    v_add_f32 v24, v24, v35
    v_mfma_f32_16x16x32_bf16 v[216:219], a[248:251], v[120:123], v[216:219]
    v_mfma_f32_16x16x32_bf16 v[248:251], a[248:251], v[124:127], v[248:251]
    s_waitcnt lgkmcnt(2)
    v_mfma_f32_16x16x32_bf16 v[156:159], a[252:255], v[112:115], v[156:159]
    ds_read_b128 a[232:235], v6 offset:16384
    v_mfma_f32_16x16x32_bf16 v[188:191], a[252:255], v[116:119], v[188:191]
    v_mfma_f32_16x16x32_bf16 v[220:223], a[252:255], v[120:123], v[220:223]
    v_mfma_f32_16x16x32_bf16 v[252:255], a[252:255], v[124:127], v[252:255]
    s_cbranch_vccnz L_rare15
L_back15:
    s_waitcnt lgkmcnt(2)
    v_mfma_f32_16x16x32_bf16 v[76:79], a[224:227], a[0:3], v[40:43]
    ds_read_b128 a[236:239], v7 offset:16384
    v_mfma_f32_16x16x32_bf16 v[80:83], a[224:227], a[32:35], v[44:47]
    s_add_u32 m0, s29, 98304
    s_waitcnt vmcnt(5)
    buffer_load_dwordx4 v0, s[16:19], s33 offen offset:0 nt lds
    v_mfma_f32_16x16x32_bf16 v[84:87], a[224:227], a[64:67], v[48:51]
    v_exp_f32 v30, v64
    v_mfma_f32_16x16x32_bf16 v[88:91], a[224:227], a[96:99], v[52:55]
    v_exp_f32 v31, v65
    v_mfma_f32_16x16x32_bf16 v[92:95], a[224:227], a[128:131], v[56:59]
    s_waitcnt lgkmcnt(2)
    v_add_f32 v25, v25, v30
    v_cvt_pk_bf16_f32 v100, v30, v31
    v_mfma_f32_16x16x32_bf16 v[76:79], a[228:231], a[4:7], v[76:79]
    ds_read_b128 a[240:243], v4 offset:16640
    v_add_f32 v25, v25, v31
    v_mfma_f32_16x16x32_bf16 v[80:83], a[228:231], a[36:39], v[80:83]
    v_exp_f32 v32, v66
    v_mfma_f32_16x16x32_bf16 v[84:87], a[228:231], a[68:71], v[84:87]
    s_waitcnt vmcnt(6)
    buffer_load_dwordx4 v0, s[16:19], s33 offen offset:1024 nt lds
    v_mfma_f32_16x16x32_bf16 v[88:91], a[228:231], a[100:103], v[88:91]
    v_exp_f32 v33, v67
    v_mfma_f32_16x16x32_bf16 v[92:95], a[228:231], a[132:135], v[92:95]
    s_waitcnt lgkmcnt(2)
    v_add_f32 v25, v25, v32
    v_cvt_pk_bf16_f32 v101, v32, v33
    v_mfma_f32_16x16x32_bf16 v[76:79], a[232:235], a[8:11], v[76:79]
    ds_read_b128 a[244:247], v5 offset:16640
    v_add_f32 v25, v25, v33
    v_mfma_f32_16x16x32_bf16 v[80:83], a[232:235], a[40:43], v[80:83]
    ds_write2st64_b64 v1, v[96:97], v[100:101] offset0:0 offset1:1
    v_mfma_f32_16x16x32_bf16 v[84:87], a[232:235], a[72:75], v[84:87]
    v_exp_f32 v34, v68
    v_mfma_f32_16x16x32_bf16 v[88:91], a[232:235], a[104:107], v[88:91]
    s_waitcnt vmcnt(5)
    buffer_load_dwordx4 v0, s[16:19], s33 offen offset:2048 nt lds
    v_mfma_f32_16x16x32_bf16 v[92:95], a[232:235], a[136:139], v[92:95]
    s_waitcnt lgkmcnt(3)
    v_exp_f32 v35, v69
    v_mfma_f32_16x16x32_bf16 v[76:79], a[236:239], a[12:15], v[76:79]
    ds_read_b128 a[248:251], v6 offset:16640
    v_add_f32 v26, v26, v34
    v_mfma_f32_16x16x32_bf16 v[80:83], a[236:239], a[44:47], v[80:83]
    v_cvt_pk_bf16_f32 v104, v34, v35
    v_add_f32 v26, v26, v35
    v_mfma_f32_16x16x32_bf16 v[84:87], a[236:239], a[76:79], v[84:87]
    v_exp_f32 v30, v70
    v_mfma_f32_16x16x32_bf16 v[88:91], a[236:239], a[108:111], v[88:91]
    v_exp_f32 v31, v71
    v_mfma_f32_16x16x32_bf16 v[92:95], a[236:239], a[140:143], v[92:95]
    s_waitcnt lgkmcnt(3)
    s_waitcnt vmcnt(6)
    buffer_load_dwordx4 v0, s[16:19], s33 offen offset:3072 nt lds
    v_mfma_f32_16x16x32_bf16 v[76:79], a[240:243], a[16:19], v[76:79]
    ds_read_b128 a[252:255], v7 offset:16640
    v_add_f32 v26, v26, v30
    v_mfma_f32_16x16x32_bf16 v[80:83], a[240:243], a[48:51], v[80:83]
    v_cvt_pk_bf16_f32 v105, v30, v31
    v_add_f32 v26, v26, v31
    v_mfma_f32_16x16x32_bf16 v[84:87], a[240:243], a[80:83], v[84:87]
    v_exp_f32 v32, v72
    v_mfma_f32_16x16x32_bf16 v[88:91], a[240:243], a[112:115], v[88:91]
    v_exp_f32 v33, v73
    v_mfma_f32_16x16x32_bf16 v[92:95], a[240:243], a[144:147], v[92:95]
    s_waitcnt lgkmcnt(3)
    v_add_f32 v27, v27, v32
    v_cvt_pk_bf16_f32 v108, v32, v33
    v_mfma_f32_16x16x32_bf16 v[76:79], a[244:247], a[20:23], v[76:79]
    s_add_u32 s33, s33, 16384
    v_add_f32 v27, v27, v33
    v_mfma_f32_16x16x32_bf16 v[80:83], a[244:247], a[52:55], v[80:83]
    v_exp_f32 v34, v74
    v_mfma_f32_16x16x32_bf16 v[84:87], a[244:247], a[84:87], v[84:87]
    v_exp_f32 v35, v75
    v_mfma_f32_16x16x32_bf16 v[88:91], a[244:247], a[116:119], v[88:91]
    v_add_f32 v27, v27, v34
    v_cvt_pk_bf16_f32 v109, v34, v35
    v_add_f32 v27, v27, v35
    ds_write2st64_b64 v1, v[104:105], v[108:109] offset0:2 offset1:3
    v_mfma_f32_16x16x32_bf16 v[92:95], a[244:247], a[148:151], v[92:95]
    s_waitcnt lgkmcnt(1)
    s_waitcnt lgkmcnt(0)
    s_barrier
    v_mfma_f32_16x16x32_bf16 v[76:79], a[248:251], a[24:27], v[76:79]
    ds_read_b64 v[98:99], v2 offset:0
    ds_read_b64 v[102:103], v2 offset:512
    v_mfma_f32_16x16x32_bf16 v[80:83], a[248:251], a[56:59], v[80:83]
    ds_read_b64 v[106:107], v2 offset:1024
    ds_read_b64 v[110:111], v2 offset:1536
    v_mfma_f32_16x16x32_bf16 v[84:87], a[248:251], a[88:91], v[84:87]
    ds_read_b64 v[38:39], v2 offset:2048
    v_mfma_f32_16x16x32_bf16 v[88:91], a[248:251], a[120:123], v[88:91]
    ds_read_b64_tr_b16 a[224:225], v8 offset:0
    ds_read_b64_tr_b16 a[226:227], v16 offset:0
    v_mfma_f32_16x16x32_bf16 v[92:95], a[248:251], a[152:155], v[92:95]
    ds_read_b64_tr_b16 a[228:229], v9 offset:0
    ds_read_b64_tr_b16 a[230:231], v17 offset:0
    v_mfma_f32_16x16x32_bf16 v[76:79], a[252:255], a[28:31], v[76:79]
    ds_read_b64_tr_b16 a[232:233], v10 offset:0
    ds_read_b64_tr_b16 a[234:235], v18 offset:0
    v_mfma_f32_16x16x32_bf16 v[80:83], a[252:255], a[60:63], v[80:83]
    s_add_u32 m0, s29, 16384
    s_mov_b32 s34, 114816
    buffer_load_dwordx4 v29, s[20:23], s34 offen offset:0 nt lds
    v_mfma_f32_16x16x32_bf16 v[84:87], a[252:255], a[92:95], v[84:87]
    v_mfma_f32_16x16x32_bf16 v[88:91], a[252:255], a[124:127], v[88:91]
    v_mfma_f32_16x16x32_bf16 v[92:95], a[252:255], a[156:159], v[92:95]
    s_cbranch_vccnz L_rare16
L_back16:
    s_waitcnt lgkmcnt(4)
    v_mfma_f32_16x16x32_bf16 v[128:131], a[224:227], v[96:99], v[128:131]
    ds_read_b64_tr_b16 a[236:237], v11 offset:0
    ds_read_b64_tr_b16 a[238:239], v19 offset:0
    v_mfma_f32_16x16x32_bf16 v[160:163], a[224:227], v[100:103], v[160:163]
    v_mfma_f32_16x16x32_bf16 v[192:195], a[224:227], v[104:107], v[192:195]
    v_mfma_f32_16x16x32_bf16 v[224:227], a[224:227], v[108:111], v[224:227]
    v_mfma_f32_16x16x32_bf16 a[160:163], a[224:227], v[36:39], a[160:163]
    s_waitcnt lgkmcnt(4)
    v_mfma_f32_16x16x32_bf16 v[132:135], a[228:231], v[96:99], v[132:135]
    s_mov_b32 s34, 120960
    buffer_load_dwordx4 v29, s[20:23], s34 offen offset:1024 nt lds
    v_mfma_f32_16x16x32_bf16 v[164:167], a[228:231], v[100:103], v[164:167]
    ds_read_b64_tr_b16 a[240:241], v12 offset:0
    ds_read_b64_tr_b16 a[242:243], v20 offset:0
    v_mfma_f32_16x16x32_bf16 v[196:199], a[228:231], v[104:107], v[196:199]
    v_exp_f32 v30, v76
    v_mfma_f32_16x16x32_bf16 v[228:231], a[228:231], v[108:111], v[228:231]
    v_exp_f32 v31, v77
    v_mfma_f32_16x16x32_bf16 a[164:167], a[228:231], v[36:39], a[164:167]
    s_waitcnt lgkmcnt(4)
    v_add_f32 v24, v24, v30
    v_cvt_pk_bf16_f32 v112, v30, v31
    v_mfma_f32_16x16x32_bf16 v[136:139], a[232:235], v[96:99], v[136:139]
    ds_read_b64_tr_b16 a[244:245], v13 offset:0
    ds_read_b64_tr_b16 a[246:247], v21 offset:0
    v_mfma_f32_16x16x32_bf16 v[168:171], a[232:235], v[100:103], v[168:171]
    v_add_f32 v24, v24, v31
    v_mfma_f32_16x16x32_bf16 v[200:203], a[232:235], v[104:107], v[200:203]
    v_exp_f32 v32, v78
    v_mfma_f32_16x16x32_bf16 v[232:235], a[232:235], v[108:111], v[232:235]
    v_exp_f32 v33, v79
    v_mfma_f32_16x16x32_bf16 a[168:171], a[232:235], v[36:39], a[168:171]
    s_waitcnt lgkmcnt(4)
    v_add_f32 v24, v24, v32
    v_cvt_pk_bf16_f32 v113, v32, v33
    v_mfma_f32_16x16x32_bf16 v[140:143], a[236:239], v[96:99], v[140:143]
    ds_read_b64_tr_b16 a[248:249], v14 offset:0
    ds_read_b64_tr_b16 a[250:251], v22 offset:0
    v_mfma_f32_16x16x32_bf16 v[172:175], a[236:239], v[100:103], v[172:175]
    s_mov_b32 s34, 127104
    buffer_load_dwordx4 v29, s[20:23], s34 offen offset:2048 nt lds
    v_add_f32 v24, v24, v33
    v_mfma_f32_16x16x32_bf16 v[204:207], a[236:239], v[104:107], v[204:207]
    v_exp_f32 v34, v80
    v_mfma_f32_16x16x32_bf16 v[236:239], a[236:239], v[108:111], v[236:239]
    v_exp_f32 v35, v81
    v_mfma_f32_16x16x32_bf16 a[172:175], a[236:239], v[36:39], a[172:175]
    s_waitcnt lgkmcnt(4)
    v_add_f32 v25, v25, v34
    v_cvt_pk_bf16_f32 v116, v34, v35
    v_mfma_f32_16x16x32_bf16 v[144:147], a[240:243], v[96:99], v[144:147]
    ds_read_b64_tr_b16 a[252:253], v15 offset:0
    ds_read_b64_tr_b16 a[254:255], v23 offset:0
    v_mfma_f32_16x16x32_bf16 v[176:179], a[240:243], v[100:103], v[176:179]
    v_add_f32 v25, v25, v35
    v_mfma_f32_16x16x32_bf16 v[208:211], a[240:243], v[104:107], v[208:211]
    v_exp_f32 v30, v82
    v_mfma_f32_16x16x32_bf16 v[240:243], a[240:243], v[108:111], v[240:243]
    v_exp_f32 v31, v83
    v_mfma_f32_16x16x32_bf16 a[176:179], a[240:243], v[36:39], a[176:179]
    s_waitcnt lgkmcnt(4)
    v_add_f32 v25, v25, v30
    v_cvt_pk_bf16_f32 v117, v30, v31
    v_mfma_f32_16x16x32_bf16 v[148:151], a[244:247], v[96:99], v[148:151]
    ds_read_b128 a[224:227], v4 offset:32768
    v_add_f32 v25, v25, v31
    v_mfma_f32_16x16x32_bf16 v[180:183], a[244:247], v[100:103], v[180:183]
    ds_write2st64_b64 v1, v[112:113], v[116:117] offset0:5 offset1:6
    v_mfma_f32_16x16x32_bf16 v[212:215], a[244:247], v[104:107], v[212:215]
    s_mov_b32 s34, 133248
    buffer_load_dwordx4 v29, s[20:23], s34 offen offset:3072 nt lds
    v_mfma_f32_16x16x32_bf16 v[244:247], a[244:247], v[108:111], v[244:247]
    v_exp_f32 v32, v84
    v_mfma_f32_16x16x32_bf16 a[180:183], a[244:247], v[36:39], a[180:183]
    s_waitcnt lgkmcnt(4)
    v_exp_f32 v33, v85
    v_mfma_f32_16x16x32_bf16 v[152:155], a[248:251], v[96:99], v[152:155]
    ds_read_b128 a[228:231], v5 offset:32768
    v_add_f32 v26, v26, v32
    v_mfma_f32_16x16x32_bf16 v[184:187], a[248:251], v[100:103], v[184:187]
    v_cvt_pk_bf16_f32 v120, v32, v33
    v_add_f32 v26, v26, v33
    v_mfma_f32_16x16x32_bf16 v[216:219], a[248:251], v[104:107], v[216:219]
    v_exp_f32 v34, v86
    v_mfma_f32_16x16x32_bf16 v[248:251], a[248:251], v[108:111], v[248:251]
    v_exp_f32 v35, v87
    v_mfma_f32_16x16x32_bf16 a[184:187], a[248:251], v[36:39], a[184:187]
    s_waitcnt lgkmcnt(3)
    v_add_f32 v26, v26, v34
    v_cvt_pk_bf16_f32 v121, v34, v35
    v_mfma_f32_16x16x32_bf16 v[156:159], a[252:255], v[96:99], v[156:159]
    ds_read_b128 a[232:235], v6 offset:32768
    v_add_f32 v26, v26, v35
    v_mfma_f32_16x16x32_bf16 v[188:191], a[252:255], v[100:103], v[188:191]
    v_mfma_f32_16x16x32_bf16 v[220:223], a[252:255], v[104:107], v[220:223]
    v_mfma_f32_16x16x32_bf16 v[252:255], a[252:255], v[108:111], v[252:255]
    v_mfma_f32_16x16x32_bf16 a[188:191], a[252:255], v[36:39], a[188:191]
    s_cbranch_vccnz L_rare17
L_back17:
    s_waitcnt lgkmcnt(3)
    v_mfma_f32_16x16x32_bf16 v[60:63], a[224:227], a[0:3], v[40:43]
    ds_read_b128 a[236:239], v7 offset:32768
    v_mfma_f32_16x16x32_bf16 v[64:67], a[224:227], a[32:35], v[44:47]
    s_add_u32 m0, s29, 114688
    s_waitcnt vmcnt(5)
    buffer_load_dwordx4 v0, s[16:19], s33 offen offset:0 nt lds
    v_mfma_f32_16x16x32_bf16 v[68:71], a[224:227], a[64:67], v[48:51]
    v_exp_f32 v30, v88
    v_mfma_f32_16x16x32_bf16 v[72:75], a[224:227], a[96:99], v[52:55]
    s_waitcnt lgkmcnt(2)
    v_exp_f32 v31, v89
    v_mfma_f32_16x16x32_bf16 v[60:63], a[228:231], a[4:7], v[60:63]
    ds_read_b128 a[240:243], v4 offset:33024
    v_add_f32 v27, v27, v30
    v_mfma_f32_16x16x32_bf16 v[64:67], a[228:231], a[36:39], v[64:67]
    s_waitcnt vmcnt(6)
    buffer_load_dwordx4 v0, s[16:19], s33 offen offset:1024 nt lds
    v_cvt_pk_bf16_f32 v124, v30, v31
    v_mfma_f32_16x16x32_bf16 v[68:71], a[228:231], a[68:71], v[68:71]
    v_add_f32 v27, v27, v31
    v_mfma_f32_16x16x32_bf16 v[72:75], a[228:231], a[100:103], v[72:75]
    s_waitcnt lgkmcnt(2)
    v_exp_f32 v32, v90
    v_mfma_f32_16x16x32_bf16 v[60:63], a[232:235], a[8:11], v[60:63]
    ds_read_b128 a[244:247], v5 offset:33024
    v_mfma_f32_16x16x32_bf16 v[64:67], a[232:235], a[40:43], v[64:67]
    s_waitcnt vmcnt(5)
    buffer_load_dwordx4 v0, s[16:19], s33 offen offset:2048 nt lds
    v_mfma_f32_16x16x32_bf16 v[68:71], a[232:235], a[72:75], v[68:71]
    v_exp_f32 v33, v91
    v_mfma_f32_16x16x32_bf16 v[72:75], a[232:235], a[104:107], v[72:75]
    s_waitcnt lgkmcnt(2)
    v_add_f32 v27, v27, v32
    v_cvt_pk_bf16_f32 v125, v32, v33
    v_mfma_f32_16x16x32_bf16 v[60:63], a[236:239], a[12:15], v[60:63]
    ds_read_b128 a[248:251], v6 offset:33024
    v_add_f32 v27, v27, v33
    v_mfma_f32_16x16x32_bf16 v[64:67], a[236:239], a[44:47], v[64:67]
    s_waitcnt vmcnt(6)
    buffer_load_dwordx4 v0, s[16:19], s33 offen offset:3072 nt lds
    v_mfma_f32_16x16x32_bf16 v[68:71], a[236:239], a[76:79], v[68:71]
    ds_write2st64_b64 v1, v[120:121], v[124:125] offset0:7 offset1:8
    v_mfma_f32_16x16x32_bf16 v[72:75], a[236:239], a[108:111], v[72:75]
    s_waitcnt lgkmcnt(3)
    v_exp_f32 v34, v92
    v_mfma_f32_16x16x32_bf16 v[60:63], a[240:243], a[16:19], v[60:63]
    ds_read_b128 a[252:255], v7 offset:33024
    v_mfma_f32_16x16x32_bf16 v[64:67], a[240:243], a[48:51], v[64:67]
    s_add_u32 s33, s33, 16384
    v_exp_f32 v35, v93
    v_mfma_f32_16x16x32_bf16 v[68:71], a[240:243], a[80:83], v[68:71]
    v_add_f32 v28, v28, v34
    v_cvt_pk_bf16_f32 v36, v34, v35
    v_mfma_f32_16x16x32_bf16 v[72:75], a[240:243], a[112:115], v[72:75]
    s_waitcnt lgkmcnt(3)
    v_add_f32 v28, v28, v35
    v_mfma_f32_16x16x32_bf16 v[60:63], a[244:247], a[20:23], v[60:63]
    v_exp_f32 v30, v94
    v_exp_f32 v31, v95
    v_add_f32 v28, v28, v30
    v_cvt_pk_bf16_f32 v37, v30, v31
    v_add_f32 v28, v28, v31
    ds_write_b64 v1, v[36:37] offset:4608
    v_mfma_f32_16x16x32_bf16 v[64:67], a[244:247], a[52:55], v[64:67]
    s_waitcnt lgkmcnt(1)
    s_waitcnt lgkmcnt(0)
    s_barrier
    v_mfma_f32_16x16x32_bf16 v[68:71], a[244:247], a[84:87], v[68:71]
    ds_read_b64 v[114:115], v2 offset:2560
    ds_read_b64 v[118:119], v2 offset:3072
    v_mfma_f32_16x16x32_bf16 v[72:75], a[244:247], a[116:119], v[72:75]
    ds_read_b64 v[122:123], v2 offset:3584
    ds_read_b64 v[126:127], v2 offset:4096
    v_mfma_f32_16x16x32_bf16 v[60:63], a[248:251], a[24:27], v[60:63]
    ds_read_b64 v[38:39], v2 offset:4608
    v_mfma_f32_16x16x32_bf16 v[64:67], a[248:251], a[56:59], v[64:67]
    ds_read_b64_tr_b16 a[224:225], v8 offset:16384
    ds_read_b64_tr_b16 a[226:227], v16 offset:16384
    v_mfma_f32_16x16x32_bf16 v[68:71], a[248:251], a[88:91], v[68:71]
    ds_read_b64_tr_b16 a[228:229], v9 offset:16384
    ds_read_b64_tr_b16 a[230:231], v17 offset:16384
    v_mfma_f32_16x16x32_bf16 v[72:75], a[248:251], a[120:123], v[72:75]
    ds_read_b64_tr_b16 a[232:233], v10 offset:16384
    ds_read_b64_tr_b16 a[234:235], v18 offset:16384
    v_mfma_f32_16x16x32_bf16 v[60:63], a[252:255], a[28:31], v[60:63]
    s_add_u32 m0, s29, 65536
    s_mov_b32 s34, 0
    buffer_load_dwordx4 v29, s[20:23], s34 offen offset:0 nt lds
    v_mfma_f32_16x16x32_bf16 v[64:67], a[252:255], a[60:63], v[64:67]
    v_mfma_f32_16x16x32_bf16 v[68:71], a[252:255], a[92:95], v[68:71]
    v_mfma_f32_16x16x32_bf16 v[72:75], a[252:255], a[124:127], v[72:75]
    s_cbranch_vccnz L_rare18
L_back18:
    s_waitcnt lgkmcnt(4)
    v_mfma_f32_16x16x32_bf16 v[128:131], a[224:227], v[112:115], v[128:131]
    ds_read_b64_tr_b16 a[236:237], v11 offset:16384
    ds_read_b64_tr_b16 a[238:239], v19 offset:16384
    v_mfma_f32_16x16x32_bf16 v[160:163], a[224:227], v[116:119], v[160:163]
    v_mfma_f32_16x16x32_bf16 v[192:195], a[224:227], v[120:123], v[192:195]
    v_mfma_f32_16x16x32_bf16 v[224:227], a[224:227], v[124:127], v[224:227]
    v_mfma_f32_16x16x32_bf16 a[160:163], a[224:227], v[36:39], a[160:163]
    s_waitcnt lgkmcnt(4)
    v_mfma_f32_16x16x32_bf16 v[132:135], a[228:231], v[112:115], v[132:135]
    s_mov_b32 s34, 6144
    buffer_load_dwordx4 v29, s[20:23], s34 offen offset:1024 nt lds
    v_mfma_f32_16x16x32_bf16 v[164:167], a[228:231], v[116:119], v[164:167]
    ds_read_b64_tr_b16 a[240:241], v12 offset:16384
    ds_read_b64_tr_b16 a[242:243], v20 offset:16384
    v_mfma_f32_16x16x32_bf16 v[196:199], a[228:231], v[120:123], v[196:199]
    v_exp_f32 v32, v60
    v_mfma_f32_16x16x32_bf16 v[228:231], a[228:231], v[124:127], v[228:231]
    v_exp_f32 v33, v61
    v_mfma_f32_16x16x32_bf16 a[164:167], a[228:231], v[36:39], a[164:167]
    s_waitcnt lgkmcnt(4)
    v_add_f32 v24, v24, v32
    v_cvt_pk_bf16_f32 v96, v32, v33
    v_mfma_f32_16x16x32_bf16 v[136:139], a[232:235], v[112:115], v[136:139]
    ds_read_b64_tr_b16 a[244:245], v13 offset:16384
    ds_read_b64_tr_b16 a[246:247], v21 offset:16384
    v_mfma_f32_16x16x32_bf16 v[168:171], a[232:235], v[116:119], v[168:171]
    v_add_f32 v24, v24, v33
    v_mfma_f32_16x16x32_bf16 v[200:203], a[232:235], v[120:123], v[200:203]
    v_exp_f32 v34, v62
    v_mfma_f32_16x16x32_bf16 v[232:235], a[232:235], v[124:127], v[232:235]
    v_exp_f32 v35, v63
    v_mfma_f32_16x16x32_bf16 a[168:171], a[232:235], v[36:39], a[168:171]
    s_waitcnt lgkmcnt(4)
    v_add_f32 v24, v24, v34
    v_cvt_pk_bf16_f32 v97, v34, v35
    v_mfma_f32_16x16x32_bf16 v[140:143], a[236:239], v[112:115], v[140:143]
    ds_read_b64_tr_b16 a[248:249], v14 offset:16384
    ds_read_b64_tr_b16 a[250:251], v22 offset:16384
    v_mfma_f32_16x16x32_bf16 v[172:175], a[236:239], v[116:119], v[172:175]
    s_mov_b32 s34, 12288
    buffer_load_dwordx4 v29, s[20:23], s34 offen offset:2048 nt lds
    v_add_f32 v24, v24, v35
    v_mfma_f32_16x16x32_bf16 v[204:207], a[236:239], v[120:123], v[204:207]
    v_exp_f32 v30, v64
    v_mfma_f32_16x16x32_bf16 v[236:239], a[236:239], v[124:127], v[236:239]
    v_exp_f32 v31, v65
    v_mfma_f32_16x16x32_bf16 a[172:175], a[236:239], v[36:39], a[172:175]
    s_waitcnt lgkmcnt(4)
    v_add_f32 v25, v25, v30
    v_cvt_pk_bf16_f32 v100, v30, v31
    v_mfma_f32_16x16x32_bf16 v[144:147], a[240:243], v[112:115], v[144:147]
    ds_read_b64_tr_b16 a[252:253], v15 offset:16384
    ds_read_b64_tr_b16 a[254:255], v23 offset:16384
    v_mfma_f32_16x16x32_bf16 v[176:179], a[240:243], v[116:119], v[176:179]
    v_add_f32 v25, v25, v31
    v_mfma_f32_16x16x32_bf16 v[208:211], a[240:243], v[120:123], v[208:211]
    v_exp_f32 v32, v66
    v_mfma_f32_16x16x32_bf16 v[240:243], a[240:243], v[124:127], v[240:243]
    v_exp_f32 v33, v67
    v_mfma_f32_16x16x32_bf16 a[176:179], a[240:243], v[36:39], a[176:179]
    s_waitcnt lgkmcnt(4)
    v_add_f32 v25, v25, v32
    v_cvt_pk_bf16_f32 v101, v32, v33
    v_mfma_f32_16x16x32_bf16 v[148:151], a[244:247], v[112:115], v[148:151]
    ds_read_b128 a[224:227], v4 offset:49152
    v_add_f32 v25, v25, v33
    v_mfma_f32_16x16x32_bf16 v[180:183], a[244:247], v[116:119], v[180:183]
    ds_write2st64_b64 v1, v[96:97], v[100:101] offset0:0 offset1:1
    v_mfma_f32_16x16x32_bf16 v[212:215], a[244:247], v[120:123], v[212:215]
    s_mov_b32 s34, 18432
    buffer_load_dwordx4 v29, s[20:23], s34 offen offset:3072 nt lds
    v_mfma_f32_16x16x32_bf16 v[244:247], a[244:247], v[124:127], v[244:247]
    v_mfma_f32_16x16x32_bf16 a[180:183], a[244:247], v[36:39], a[180:183]
    s_waitcnt lgkmcnt(4)
    v_mfma_f32_16x16x32_bf16 v[152:155], a[248:251], v[112:115], v[152:155]
    ds_read_b128 a[228:231], v5 offset:49152
    v_mfma_f32_16x16x32_bf16 v[184:187], a[248:251], v[116:119], v[184:187]
    v_mfma_f32_16x16x32_bf16 v[216:219], a[248:251], v[120:123], v[216:219]
    v_mfma_f32_16x16x32_bf16 v[248:251], a[248:251], v[124:127], v[248:251]
    v_mfma_f32_16x16x32_bf16 a[184:187], a[248:251], v[36:39], a[184:187]
    s_waitcnt lgkmcnt(3)
    v_mfma_f32_16x16x32_bf16 v[156:159], a[252:255], v[112:115], v[156:159]
    ds_read_b128 a[232:235], v6 offset:49152
    v_mfma_f32_16x16x32_bf16 v[188:191], a[252:255], v[116:119], v[188:191]
    v_mfma_f32_16x16x32_bf16 v[220:223], a[252:255], v[120:123], v[220:223]
    v_mfma_f32_16x16x32_bf16 v[252:255], a[252:255], v[124:127], v[252:255]
    v_mfma_f32_16x16x32_bf16 a[188:191], a[252:255], v[36:39], a[188:191]
    s_cbranch_vccnz L_rare19
L_back19:
    s_waitcnt lgkmcnt(3)
    v_mfma_f32_16x16x32_bf16 v[76:79], a[224:227], a[0:3], v[40:43]
    ds_read_b128 a[236:239], v7 offset:49152
    v_mfma_f32_16x16x32_bf16 v[80:83], a[224:227], a[32:35], v[44:47]
    v_exp_f32 v34, v68
    v_mfma_f32_16x16x32_bf16 v[84:87], a[224:227], a[64:67], v[48:51]
    v_exp_f32 v35, v69
    v_mfma_f32_16x16x32_bf16 v[88:91], a[224:227], a[96:99], v[52:55]
    s_waitcnt lgkmcnt(2)
    v_add_f32 v26, v26, v34
    v_cvt_pk_bf16_f32 v104, v34, v35
    v_mfma_f32_16x16x32_bf16 v[76:79], a[228:231], a[4:7], v[76:79]
    ds_read_b128 a[240:243], v4 offset:49408
    v_add_f32 v26, v26, v35
    v_mfma_f32_16x16x32_bf16 v[80:83], a[228:231], a[36:39], v[80:83]
    v_exp_f32 v30, v70
    v_mfma_f32_16x16x32_bf16 v[84:87], a[228:231], a[68:71], v[84:87]
    v_exp_f32 v31, v71
    v_mfma_f32_16x16x32_bf16 v[88:91], a[228:231], a[100:103], v[88:91]
    s_waitcnt lgkmcnt(2)
    v_add_f32 v26, v26, v30
    v_cvt_pk_bf16_f32 v105, v30, v31
    v_mfma_f32_16x16x32_bf16 v[76:79], a[232:235], a[8:11], v[76:79]
    ds_read_b128 a[244:247], v5 offset:49408
    v_add_f32 v26, v26, v31
    v_mfma_f32_16x16x32_bf16 v[80:83], a[232:235], a[40:43], v[80:83]
    v_exp_f32 v32, v72
    v_mfma_f32_16x16x32_bf16 v[84:87], a[232:235], a[72:75], v[84:87]
    v_exp_f32 v33, v73
    v_mfma_f32_16x16x32_bf16 v[88:91], a[232:235], a[104:107], v[88:91]
    s_waitcnt lgkmcnt(2)
    v_add_f32 v27, v27, v32
    v_cvt_pk_bf16_f32 v108, v32, v33
    v_mfma_f32_16x16x32_bf16 v[76:79], a[236:239], a[12:15], v[76:79]
    ds_read_b128 a[248:251], v6 offset:49408
    v_add_f32 v27, v27, v33
    v_mfma_f32_16x16x32_bf16 v[80:83], a[236:239], a[44:47], v[80:83]
    v_exp_f32 v34, v74
    v_mfma_f32_16x16x32_bf16 v[84:87], a[236:239], a[76:79], v[84:87]
    v_exp_f32 v35, v75
    v_mfma_f32_16x16x32_bf16 v[88:91], a[236:239], a[108:111], v[88:91]
    s_waitcnt lgkmcnt(2)
    v_add_f32 v27, v27, v34
    v_cvt_pk_bf16_f32 v109, v34, v35
    v_mfma_f32_16x16x32_bf16 v[76:79], a[240:243], a[16:19], v[76:79]
    ds_read_b128 a[252:255], v7 offset:49408
    v_add_f32 v27, v27, v35
    v_mfma_f32_16x16x32_bf16 v[80:83], a[240:243], a[48:51], v[80:83]
    ds_write2st64_b64 v1, v[104:105], v[108:109] offset0:2 offset1:3
    v_mfma_f32_16x16x32_bf16 v[84:87], a[240:243], a[80:83], v[84:87]
    v_mfma_f32_16x16x32_bf16 v[88:91], a[240:243], a[112:115], v[88:91]
    s_waitcnt lgkmcnt(3)
    v_mfma_f32_16x16x32_bf16 v[76:79], a[244:247], a[20:23], v[76:79]
    v_mfma_f32_16x16x32_bf16 v[80:83], a[244:247], a[52:55], v[80:83]
    s_waitcnt lgkmcnt(1)
    s_waitcnt lgkmcnt(0)
    s_waitcnt vmcnt(4)
    s_barrier
    v_mfma_f32_16x16x32_bf16 v[84:87], a[244:247], a[84:87], v[84:87]
    ds_read_b64 v[98:99], v2 offset:0
    ds_read_b64 v[102:103], v2 offset:512
    v_mfma_f32_16x16x32_bf16 v[88:91], a[244:247], a[116:119], v[88:91]
    ds_read_b64 v[106:107], v2 offset:1024
    ds_read_b64 v[110:111], v2 offset:1536
    v_mfma_f32_16x16x32_bf16 v[76:79], a[248:251], a[24:27], v[76:79]
    ds_read_b64_tr_b16 a[224:225], v8 offset:32768
    ds_read_b64_tr_b16 a[226:227], v16 offset:32768
    v_mfma_f32_16x16x32_bf16 v[80:83], a[248:251], a[56:59], v[80:83]
    ds_read_b64_tr_b16 a[228:229], v9 offset:32768
    ds_read_b64_tr_b16 a[230:231], v17 offset:32768
    v_mfma_f32_16x16x32_bf16 v[84:87], a[248:251], a[88:91], v[84:87]
    s_add_u32 m0, s29, 81920
    s_mov_b32 s34, 114688
    buffer_load_dwordx4 v29, s[20:23], s34 offen offset:0 nt lds
    v_mfma_f32_16x16x32_bf16 v[88:91], a[248:251], a[120:123], v[88:91]
    ds_read_b64_tr_b16 a[232:233], v10 offset:32768
    ds_read_b64_tr_b16 a[234:235], v18 offset:32768
    v_mfma_f32_16x16x32_bf16 v[76:79], a[252:255], a[28:31], v[76:79]
    v_mfma_f32_16x16x32_bf16 v[80:83], a[252:255], a[60:63], v[80:83]
    v_mfma_f32_16x16x32_bf16 v[84:87], a[252:255], a[92:95], v[84:87]
    v_mfma_f32_16x16x32_bf16 v[88:91], a[252:255], a[124:127], v[88:91]
    s_cbranch_vccnz L_rare20
L_back20:
    s_waitcnt lgkmcnt(4)
    v_mfma_f32_16x16x32_bf16 v[128:131], a[224:227], v[96:99], v[128:131]
    ds_read_b64_tr_b16 a[236:237], v11 offset:32768
    ds_read_b64_tr_b16 a[238:239], v19 offset:32768
    v_mfma_f32_16x16x32_bf16 v[160:163], a[224:227], v[100:103], v[160:163]
    s_mov_b32 s34, 120832
    buffer_load_dwordx4 v29, s[20:23], s34 offen offset:1024 nt lds
    v_mfma_f32_16x16x32_bf16 v[192:195], a[224:227], v[104:107], v[192:195]
    v_mfma_f32_16x16x32_bf16 v[224:227], a[224:227], v[108:111], v[224:227]
    s_waitcnt lgkmcnt(4)
    v_mfma_f32_16x16x32_bf16 v[132:135], a[228:231], v[96:99], v[132:135]
    ds_read_b64_tr_b16 a[240:241], v12 offset:32768
    ds_read_b64_tr_b16 a[242:243], v20 offset:32768
    v_mfma_f32_16x16x32_bf16 v[164:167], a[228:231], v[100:103], v[164:167]
    v_exp_f32 v30, v76
    v_mfma_f32_16x16x32_bf16 v[196:199], a[228:231], v[104:107], v[196:199]
    v_exp_f32 v31, v77
    v_mfma_f32_16x16x32_bf16 v[228:231], a[228:231], v[108:111], v[228:231]
    s_waitcnt lgkmcnt(4)
    v_add_f32 v24, v24, v30
    v_cvt_pk_bf16_f32 v112, v30, v31
    v_mfma_f32_16x16x32_bf16 v[136:139], a[232:235], v[96:99], v[136:139]
    s_mov_b32 s34, 126976
    buffer_load_dwordx4 v29, s[20:23], s34 offen offset:2048 nt lds
    v_add_f32 v24, v24, v31
    v_mfma_f32_16x16x32_bf16 v[168:171], a[232:235], v[100:103], v[168:171]
    ds_read_b64_tr_b16 a[244:245], v13 offset:32768
    ds_read_b64_tr_b16 a[246:247], v21 offset:32768
    v_mfma_f32_16x16x32_bf16 v[200:203], a[232:235], v[104:107], v[200:203]
    v_exp_f32 v32, v78
    v_mfma_f32_16x16x32_bf16 v[232:235], a[232:235], v[108:111], v[232:235]
    s_waitcnt lgkmcnt(4)
    v_exp_f32 v33, v79
    v_mfma_f32_16x16x32_bf16 v[140:143], a[236:239], v[96:99], v[140:143]
    ds_read_b64_tr_b16 a[248:249], v14 offset:32768
    ds_read_b64_tr_b16 a[250:251], v22 offset:32768
    v_mfma_f32_16x16x32_bf16 v[172:175], a[236:239], v[100:103], v[172:175]
    v_add_f32 v24, v24, v32
    v_cvt_pk_bf16_f32 v113, v32, v33
    v_mfma_f32_16x16x32_bf16 v[204:207], a[236:239], v[104:107], v[204:207]
    v_add_f32 v24, v24, v33
    v_mfma_f32_16x16x32_bf16 v[236:239], a[236:239], v[108:111], v[236:239]
    s_waitcnt lgkmcnt(4)
    s_mov_b32 s34, 133120
    buffer_load_dwordx4 v29, s[20:23], s34 offen offset:3072 nt lds
    v_mfma_f32_16x16x32_bf16 v[144:147], a[240:243], v[96:99], v[144:147]
    ds_read_b64_tr_b16 a[252:253], v15 offset:32768
    ds_read_b64_tr_b16 a[254:255], v23 offset:32768
    v_mfma_f32_16x16x32_bf16 v[176:179], a[240:243], v[100:103], v[176:179]
    v_exp_f32 v34, v80
    v_mfma_f32_16x16x32_bf16 v[208:211], a[240:243], v[104:107], v[208:211]
    v_exp_f32 v35, v81
    v_mfma_f32_16x16x32_bf16 v[240:243], a[240:243], v[108:111], v[240:243]
    s_waitcnt lgkmcnt(4)
    v_add_f32 v25, v25, v34
    v_cvt_pk_bf16_f32 v116, v34, v35
    v_mfma_f32_16x16x32_bf16 v[148:151], a[244:247], v[96:99], v[148:151]
    ds_read_b64_tr_b16 a[224:225], v8 offset:49152
    ds_read_b64_tr_b16 a[226:227], v16 offset:49152
    v_mfma_f32_16x16x32_bf16 v[180:183], a[244:247], v[100:103], v[180:183]
    v_add_f32 v25, v25, v35
    v_mfma_f32_16x16x32_bf16 v[212:215], a[244:247], v[104:107], v[212:215]
    s_lshr_b32 s99, s3, 4
    s_and_b32 s99, s99, 7
    s_lshl_b32 s99, s99, 2
    v_mfma_f32_16x16x32_bf16 v[244:247], a[244:247], v[108:111], v[244:247]
    s_waitcnt lgkmcnt(4)
    v_exp_f32 v30, v82
    v_mfma_f32_16x16x32_bf16 v[152:155], a[248:251], v[96:99], v[152:155]
    s_add_u32 s99, s99, s28
    s_mul_i32 s99, s99, 7168
    v_subrev_u32 v0, 151552, v3
    v_mfma_f32_16x16x32_bf16 v[184:187], a[248:251], v[100:103], v[184:187]
    ds_read_b64_tr_b16 a[228:229], v9 offset:49152
    ds_read_b64_tr_b16 a[230:231], v17 offset:49152
    v_mfma_f32_16x16x32_bf16 v[216:219], a[248:251], v[104:107], v[216:219]
    v_lshlrev_b32 v0, 5, v0
    v_mfma_f32_16x16x32_bf16 v[248:251], a[248:251], v[108:111], v[248:251]
    s_waitcnt lgkmcnt(4)
    v_exp_f32 v31, v83
    v_mfma_f32_16x16x32_bf16 v[156:159], a[252:255], v[96:99], v[156:159]
    s_mov_b32 exec_hi, 0x00ffffff
    buffer_load_dword a200, v0, s[20:23], s99 offen
    s_mov_b32 exec_hi, -1
    v_mfma_f32_16x16x32_bf16 v[188:191], a[252:255], v[100:103], v[188:191]
    ds_read_b64_tr_b16 a[232:233], v10 offset:49152
    ds_read_b64_tr_b16 a[234:235], v18 offset:49152
    v_mfma_f32_16x16x32_bf16 v[220:223], a[252:255], v[104:107], v[220:223]
    v_add_f32 v25, v25, v30
    v_cvt_pk_bf16_f32 v117, v30, v31
    v_mfma_f32_16x16x32_bf16 v[252:255], a[252:255], v[108:111], v[252:255]
    v_add_f32 v25, v25, v31
    ds_write2st64_b64 v1, v[112:113], v[116:117] offset0:5 offset1:6
    v_exp_f32 v32, v84
    v_exp_f32 v33, v85
    v_add_f32 v26, v26, v32
    v_cvt_pk_bf16_f32 v120, v32, v33
    v_add_f32 v26, v26, v33
    v_exp_f32 v34, v86
    v_exp_f32 v35, v87
    v_add_f32 v26, v26, v34
    v_cvt_pk_bf16_f32 v121, v34, v35
    v_add_f32 v26, v26, v35
    v_exp_f32 v30, v88
    v_exp_f32 v31, v89
    v_add_f32 v27, v27, v30
    v_cvt_pk_bf16_f32 v124, v30, v31
    v_add_f32 v27, v27, v31
    v_exp_f32 v32, v90
    v_exp_f32 v33, v91
    v_add_f32 v27, v27, v32
    v_cvt_pk_bf16_f32 v125, v32, v33
    v_add_f32 v27, v27, v33
    ds_write2st64_b64 v1, v[120:121], v[124:125] offset0:7 offset1:8
    s_cbranch_vccnz L_rare21
L_back21:
    s_waitcnt lgkmcnt(0)
    s_barrier
    ds_read_b64 v[114:115], v2 offset:2560
    ds_read_b64 v[118:119], v2 offset:3072
    ds_read_b64 v[122:123], v2 offset:3584
    ds_read_b64 v[126:127], v2 offset:4096
    s_waitcnt lgkmcnt(3)
    v_mfma_f32_16x16x32_bf16 v[128:131], a[224:227], v[112:115], v[128:131]
    s_waitcnt lgkmcnt(2)
    ds_read_b64_tr_b16 a[236:237], v11 offset:49152
    ds_read_b64_tr_b16 a[238:239], v19 offset:49152
    v_mfma_f32_16x16x32_bf16 v[160:163], a[224:227], v[116:119], v[160:163]
    s_waitcnt lgkmcnt(3)
    v_mfma_f32_16x16x32_bf16 v[192:195], a[224:227], v[120:123], v[192:195]
    s_waitcnt lgkmcnt(2)
    v_mbcnt_lo_u32_b32 v0, -1, 0
    v_mbcnt_hi_u32_b32 v0, -1, v0
    v_mfma_f32_16x16x32_bf16 v[224:227], a[224:227], v[124:127], v[224:227]
    s_nop 0
    v_lshrrev_b32 v3, 2, v0
    v_lshlrev_b32 v3, 7, v3
    v_mfma_f32_16x16x32_bf16 v[132:135], a[228:231], v[112:115], v[132:135]
    ds_read_b64_tr_b16 a[240:241], v12 offset:49152
    ds_read_b64_tr_b16 a[242:243], v20 offset:49152
    v_mfma_f32_16x16x32_bf16 v[164:167], a[228:231], v[116:119], v[164:167]
    v_and_b32 v30, 3, v0
    v_lshl_add_u32 v3, v30, 3, v3
    v_mfma_f32_16x16x32_bf16 v[196:199], a[228:231], v[120:123], v[196:199]
    s_lshl_b32 s99, s31, 1
    s_xor_b32 s99, s99, s30
    v_bfe_u32 v30, v0, 3, 2
    v_mfma_f32_16x16x32_bf16 v[228:231], a[228:231], v[124:127], v[228:231]
    v_xor_b32 v30, s99, v30
    v_mfma_f32_16x16x32_bf16 v[136:139], a[232:235], v[112:115], v[136:139]
    ds_read_b64_tr_b16 a[244:245], v13 offset:49152
    ds_read_b64_tr_b16 a[246:247], v21 offset:49152
    v_mfma_f32_16x16x32_bf16 v[168:171], a[232:235], v[116:119], v[168:171]
    v_lshl_add_u32 v30, v30, 5, v3
    v_xor_b32 v31, 32, v30
    v_mfma_f32_16x16x32_bf16 v[200:203], a[232:235], v[120:123], v[200:203]
    s_lshl_b32 s98, s30, 1
    s_xor_b32 s98, s98, 0
    s_lshl_b32 s98, s98, 12
    v_mfma_f32_16x16x32_bf16 v[232:235], a[232:235], v[124:127], v[232:235]
    s_waitcnt lgkmcnt(4)
    v_mfma_f32_16x16x32_bf16 v[140:143], a[236:239], v[112:115], v[140:143]
    s_lshl_b32 s99, s31, 14
    s_add_u32 s99, s99, s98
    s_add_u32 s99, s99, 65536
    v_mfma_f32_16x16x32_bf16 v[172:175], a[236:239], v[116:119], v[172:175]
    ds_read_b64_tr_b16 a[248:249], v14 offset:49152
    ds_read_b64_tr_b16 a[250:251], v22 offset:49152
    v_mfma_f32_16x16x32_bf16 v[204:207], a[236:239], v[120:123], v[204:207]
    v_add_u32 v40, s99, v30
    v_xor_b32 v48, 0x4000, v40
    v_mfma_f32_16x16x32_bf16 v[236:239], a[236:239], v[124:127], v[236:239]
    s_waitcnt lgkmcnt(4)
    v_add_u32 v41, s99, v31
    v_xor_b32 v49, 0x4000, v41
    v_mfma_f32_16x16x32_bf16 v[144:147], a[240:243], v[112:115], v[144:147]
    s_lshl_b32 s98, s30, 1
    s_xor_b32 s98, s98, 1
    s_lshl_b32 s98, s98, 12
    v_mfma_f32_16x16x32_bf16 v[176:179], a[240:243], v[116:119], v[176:179]
    s_lshl_b32 s99, s31, 14
    s_add_u32 s99, s99, s98
    s_add_u32 s99, s99, 65536
    v_mfma_f32_16x16x32_bf16 v[208:211], a[240:243], v[120:123], v[208:211]
    ds_read_b64_tr_b16 a[252:253], v15 offset:49152
    ds_read_b64_tr_b16 a[254:255], v23 offset:49152
    v_mfma_f32_16x16x32_bf16 v[240:243], a[240:243], v[124:127], v[240:243]
    s_waitcnt lgkmcnt(4)
    v_add_u32 v42, s99, v30
    v_xor_b32 v50, 0x4000, v42
    v_mfma_f32_16x16x32_bf16 v[148:151], a[244:247], v[112:115], v[148:151]
    v_add_u32 v43, s99, v31
    v_xor_b32 v51, 0x4000, v43
    v_mfma_f32_16x16x32_bf16 v[180:183], a[244:247], v[116:119], v[180:183]
    s_lshl_b32 s98, s30, 1
    s_xor_b32 s98, s98, 2
    s_lshl_b32 s98, s98, 12
    v_mfma_f32_16x16x32_bf16 v[212:215], a[244:247], v[120:123], v[212:215]
    s_lshl_b32 s99, s31, 14
    s_add_u32 s99, s99, s98
    s_add_u32 s99, s99, 65536
    v_mfma_f32_16x16x32_bf16 v[244:247], a[244:247], v[124:127], v[244:247]
    s_waitcnt lgkmcnt(2)
    v_add_u32 v44, s99, v30
    v_xor_b32 v52, 0x4000, v44
    v_mfma_f32_16x16x32_bf16 v[152:155], a[248:251], v[112:115], v[152:155]
    v_add_u32 v45, s99, v31
    v_xor_b32 v53, 0x4000, v45
    v_mfma_f32_16x16x32_bf16 v[184:187], a[248:251], v[116:119], v[184:187]
    s_lshl_b32 s98, s30, 1
    s_xor_b32 s98, s98, 3
    s_lshl_b32 s98, s98, 12
    v_mfma_f32_16x16x32_bf16 v[216:219], a[248:251], v[120:123], v[216:219]
    s_lshl_b32 s99, s31, 14
    s_add_u32 s99, s99, s98
    s_add_u32 s99, s99, 65536
    v_mfma_f32_16x16x32_bf16 v[248:251], a[248:251], v[124:127], v[248:251]
    s_waitcnt lgkmcnt(0)
    v_add_u32 v46, s99, v30
    v_xor_b32 v54, 0x4000, v46
    v_mfma_f32_16x16x32_bf16 v[156:159], a[252:255], v[112:115], v[156:159]
    v_add_u32 v47, s99, v31
    v_xor_b32 v55, 0x4000, v47
    v_mfma_f32_16x16x32_bf16 v[188:191], a[252:255], v[116:119], v[188:191]
    v_mov_b32 v30, v24
    v_mov_b32 v31, v24
    v_mfma_f32_16x16x32_bf16 v[220:223], a[252:255], v[120:123], v[220:223]
    s_nop 0
    v_permlane32_swap_b32 v30, v31
    v_mfma_f32_16x16x32_bf16 v[252:255], a[252:255], v[124:127], v[252:255]
    v_add_f32 v30, v30, v31
    v_mov_b32 v31, v30
    s_nop 0
    s_nop 0
    v_permlane16_swap_b32 v30, v31
    v_add_f32 v24, v30, v31
    v_mov_b32 v30, v25
    v_mov_b32 v31, v25
    s_nop 0
    s_nop 0
    v_permlane32_swap_b32 v30, v31
    v_add_f32 v30, v30, v31
    v_mov_b32 v31, v30
    s_nop 0
    s_nop 0
    v_permlane16_swap_b32 v30, v31
    v_add_f32 v25, v30, v31
    v_mov_b32 v30, v26
    v_mov_b32 v31, v26
    s_nop 0
    s_nop 0
    v_permlane32_swap_b32 v30, v31
    v_add_f32 v30, v30, v31
    v_mov_b32 v31, v30
    s_nop 0
    s_nop 0
    v_permlane16_swap_b32 v30, v31
    v_add_f32 v26, v30, v31
    v_mov_b32 v30, v27
    v_mov_b32 v31, v27
    s_nop 0
    s_nop 0
    v_permlane32_swap_b32 v30, v31
    v_add_f32 v30, v30, v31
    v_mov_b32 v31, v30
    s_nop 0
    s_nop 0
    v_permlane16_swap_b32 v30, v31
    v_add_f32 v27, v30, v31
    v_mov_b32 v30, v28
    v_mov_b32 v31, v28
    s_nop 0
    s_nop 0
    v_permlane32_swap_b32 v30, v31
    v_add_f32 v30, v30, v31
    v_mov_b32 v31, v30
    s_nop 0
    s_nop 0
    v_permlane16_swap_b32 v30, v31
    v_add_f32 v28, v30, v31
    v_and_b32 v3, 15, v0
    v_lshlrev_b32 v3, 2, v3
    s_mul_i32 s99, s28, 320
    s_add_u32 s99, s99, 147456
    v_add_u32 v30, s99, v3
    ds_write_b32 v30, v24 offset:0
    ds_write_b32 v30, v25 offset:64
    ds_write_b32 v30, v26 offset:128
    ds_write_b32 v30, v27 offset:192
    ds_write_b32 v30, v28 offset:256
    v_lshlrev_b32 v0, 4, v0
    s_lshl_b32 s99, s30, 16
    s_lshl_b32 s98, s31, 12
    s_add_u32 s99, s99, s98
    s_lshl_b32 s98, s30, 11
    s_add_u32 s99, s99, s98
    s_add_u32 s99, s99, 32768
    v_add_u32 v6, s99, v0
    v_xor_b32 v7, 0x800, v6
    s_branch L_oproj
L_att1:
    ds_read_b128 a[224:227], v4 offset:0
    ds_read_b128 a[0:3], v221 offset:0
    ds_read_b128 a[32:35], v221 offset:8192
    ds_read_b128 a[64:67], v221 offset:16384
    ds_read_b128 a[96:99], v221 offset:24576
    ds_read_b128 a[128:131], v222 offset:0
    ds_read_b128 a[228:231], v5 offset:0
    ds_read_b128 a[4:7], v221 offset:1024
    ds_read_b128 a[36:39], v221 offset:9216
    ds_read_b128 a[68:71], v221 offset:17408
    ds_read_b128 a[100:103], v221 offset:25600
    ds_read_b128 a[132:135], v222 offset:1024
    s_waitcnt lgkmcnt(10)
    v_mfma_f32_16x16x32_bf16 v[60:63], a[224:227], a[0:3], 0
    s_waitcnt lgkmcnt(9)
    ds_read_b128 a[232:235], v6 offset:0
    ds_read_b128 a[8:11], v221 offset:2048
    v_mfma_f32_16x16x32_bf16 v[64:67], a[224:227], a[32:35], 0
    s_waitcnt lgkmcnt(10)
    ds_read_b128 a[40:43], v221 offset:10240
    ds_read_b128 a[72:75], v221 offset:18432
    v_mfma_f32_16x16x32_bf16 v[68:71], a[224:227], a[64:67], 0
    s_waitcnt lgkmcnt(11)
    ds_read_b128 a[104:107], v221 offset:26624
    ds_read_b128 a[136:139], v222 offset:2048
    v_mfma_f32_16x16x32_bf16 v[72:75], a[224:227], a[96:99], 0
    s_waitcnt lgkmcnt(10)
    v_mov_b32 v128, 0
    v_mov_b32 v129, 0
    v_mfma_f32_16x16x32_bf16 v[60:63], a[228:231], a[4:7], v[60:63]
    s_waitcnt lgkmcnt(9)
    ds_read_b128 a[236:239], v7 offset:0
    ds_read_b128 a[12:15], v221 offset:3072
    v_mfma_f32_16x16x32_bf16 v[64:67], a[228:231], a[36:39], v[64:67]
    s_waitcnt lgkmcnt(10)
    ds_read_b128 a[44:47], v221 offset:11264
    ds_read_b128 a[76:79], v221 offset:19456
    v_mfma_f32_16x16x32_bf16 v[68:71], a[228:231], a[68:71], v[68:71]
    s_waitcnt lgkmcnt(11)
    ds_read_b128 a[108:111], v221 offset:27648
    ds_read_b128 a[140:143], v222 offset:3072
    v_mfma_f32_16x16x32_bf16 v[72:75], a[228:231], a[100:103], v[72:75]
    s_waitcnt lgkmcnt(10)
    v_mov_b32 v130, 0
    v_mov_b32 v131, 0
    v_mfma_f32_16x16x32_bf16 v[60:63], a[232:235], a[8:11], v[60:63]
    s_waitcnt lgkmcnt(9)
    ds_read_b128 a[240:243], v4 offset:256
    ds_read_b128 a[16:19], v221 offset:4096
    v_mfma_f32_16x16x32_bf16 v[64:67], a[232:235], a[40:43], v[64:67]
    s_waitcnt lgkmcnt(10)
    ds_read_b128 a[48:51], v221 offset:12288
    ds_read_b128 a[80:83], v221 offset:20480
    v_mfma_f32_16x16x32_bf16 v[68:71], a[232:235], a[72:75], v[68:71]
    s_waitcnt lgkmcnt(11)
    ds_read_b128 a[112:115], v221 offset:28672
    ds_read_b128 a[144:147], v222 offset:4096
    v_mfma_f32_16x16x32_bf16 v[72:75], a[232:235], a[104:107], v[72:75]
    s_waitcnt lgkmcnt(10)
    v_mov_b32 v132, 0
    v_mov_b32 v133, 0
    v_mfma_f32_16x16x32_bf16 v[60:63], a[236:239], a[12:15], v[60:63]
    s_waitcnt lgkmcnt(9)
    ds_read_b128 a[244:247], v5 offset:256
    ds_read_b128 a[20:23], v221 offset:5120
    v_mfma_f32_16x16x32_bf16 v[64:67], a[236:239], a[44:47], v[64:67]
    s_waitcnt lgkmcnt(10)
    ds_read_b128 a[52:55], v221 offset:13312
    ds_read_b128 a[84:87], v221 offset:21504
    v_mfma_f32_16x16x32_bf16 v[68:71], a[236:239], a[76:79], v[68:71]
    s_waitcnt lgkmcnt(11)
    ds_read_b128 a[116:119], v221 offset:29696
    ds_read_b128 a[148:151], v222 offset:5120
    v_mfma_f32_16x16x32_bf16 v[72:75], a[236:239], a[108:111], v[72:75]
    s_waitcnt lgkmcnt(10)
    v_mov_b32 v134, 0
    v_mov_b32 v135, 0
    v_mfma_f32_16x16x32_bf16 v[60:63], a[240:243], a[16:19], v[60:63]
    s_waitcnt lgkmcnt(9)
    ds_read_b128 a[248:251], v6 offset:256
    ds_read_b128 a[24:27], v221 offset:6144
    v_mfma_f32_16x16x32_bf16 v[64:67], a[240:243], a[48:51], v[64:67]
    s_waitcnt lgkmcnt(10)
    ds_read_b128 a[56:59], v221 offset:14336
    ds_read_b128 a[88:91], v221 offset:22528
    v_mfma_f32_16x16x32_bf16 v[68:71], a[240:243], a[80:83], v[68:71]
    s_waitcnt lgkmcnt(11)
    ds_read_b128 a[120:123], v221 offset:30720
    ds_read_b128 a[152:155], v222 offset:6144
    v_mfma_f32_16x16x32_bf16 v[72:75], a[240:243], a[112:115], v[72:75]
    s_waitcnt lgkmcnt(10)
    v_mov_b32 v136, 0
    v_mov_b32 v137, 0
    v_mfma_f32_16x16x32_bf16 v[60:63], a[244:247], a[20:23], v[60:63]
    s_waitcnt lgkmcnt(9)
    ds_read_b128 a[252:255], v7 offset:256
    ds_read_b128 a[28:31], v221 offset:7168
    v_mfma_f32_16x16x32_bf16 v[64:67], a[244:247], a[52:55], v[64:67]
    s_waitcnt lgkmcnt(10)
    ds_read_b128 a[60:63], v221 offset:15360
    ds_read_b128 a[92:95], v221 offset:23552
    v_mfma_f32_16x16x32_bf16 v[68:71], a[244:247], a[84:87], v[68:71]
    s_waitcnt lgkmcnt(11)
    ds_read_b128 a[124:127], v221 offset:31744
    ds_read_b128 a[156:159], v222 offset:7168
    v_mfma_f32_16x16x32_bf16 v[72:75], a[244:247], a[116:119], v[72:75]
    s_waitcnt lgkmcnt(10)
    v_mov_b32 v138, 0
    v_mov_b32 v139, 0
    v_mfma_f32_16x16x32_bf16 v[60:63], a[248:251], a[24:27], v[60:63]
    s_waitcnt lgkmcnt(9)
    v_mov_b32 v140, 0
    v_mov_b32 v141, 0
    v_mfma_f32_16x16x32_bf16 v[64:67], a[248:251], a[56:59], v[64:67]
    s_waitcnt lgkmcnt(8)
    v_mov_b32 v142, 0
    v_mov_b32 v143, 0
    v_mfma_f32_16x16x32_bf16 v[68:71], a[248:251], a[88:91], v[68:71]
    s_waitcnt lgkmcnt(7)
    v_mov_b32 v144, 0
    v_mov_b32 v145, 0
    v_mfma_f32_16x16x32_bf16 v[72:75], a[248:251], a[120:123], v[72:75]
    s_waitcnt lgkmcnt(4)
    v_mov_b32 v146, 0
    v_mov_b32 v147, 0
    v_mfma_f32_16x16x32_bf16 v[60:63], a[252:255], a[28:31], v[60:63]
    s_waitcnt lgkmcnt(3)
    v_mov_b32 v148, 0
    v_mov_b32 v149, 0
    v_mfma_f32_16x16x32_bf16 v[64:67], a[252:255], a[60:63], v[64:67]
    s_waitcnt lgkmcnt(2)
    v_mov_b32 v150, 0
    v_mov_b32 v151, 0
    v_mfma_f32_16x16x32_bf16 v[68:71], a[252:255], a[92:95], v[68:71]
    s_waitcnt lgkmcnt(1)
    v_mov_b32 v152, 0
    v_mov_b32 v153, 0
    v_mfma_f32_16x16x32_bf16 v[72:75], a[252:255], a[124:127], v[72:75]
    v_mov_b32 v154, 0
    v_mov_b32 v155, 0
    v_mov_b32 v156, 0
    v_mov_b32 v157, 0
    v_mov_b32 v158, 0
    v_mov_b32 v159, 0
    v_mov_b32 v160, 0
    v_mov_b32 v161, 0
    v_mov_b32 v162, 0
    v_mov_b32 v163, 0
    v_mov_b32 v164, 0
    v_mov_b32 v165, 0
    v_mov_b32 v166, 0
    v_mov_b32 v167, 0
    v_mov_b32 v168, 0
    v_mov_b32 v169, 0
    v_mov_b32 v170, 0
    v_mov_b32 v171, 0
    v_mov_b32 v200, 0
    v_mov_b32 v201, 0
    v_mov_b32 v202, 0
    v_mov_b32 v203, 0
    v_mov_b32 v204, 0
    v_mov_b32 v205, 0
    v_mov_b32 v206, 0
    v_mov_b32 v207, 0
    v_mov_b32 v208, 0
    v_mov_b32 v209, 0
    v_mov_b32 v210, 0
    v_mov_b32 v211, 0
    v_mov_b32 v212, 0
    v_mov_b32 v213, 0
    v_mov_b32 v214, 0
    v_mov_b32 v215, 0
    v_mov_b32 v216, 0
    v_mov_b32 v217, 0
    v_mov_b32 v218, 0
    v_mov_b32 v219, 0
    v_mov_b32 v220, 0
    v_mov_b32 v223, 0
    v_mov_b32 v224, 0
    v_mov_b32 v225, 0
    v_mov_b32 v221, 0
    v_mov_b32 v222, 0
    v_max3_f32 v96, v60, v61, v62
    v_max_f32 v96, v96, v63
    v_max3_f32 v97, v64, v65, v66
    v_max_f32 v97, v97, v67
    v_max3_f32 v98, v68, v69, v70
    v_max_f32 v98, v98, v71
    v_max3_f32 v99, v72, v73, v74
    v_max_f32 v99, v99, v75
    v_mov_b32 v104, v96
    v_mov_b32 v105, v97
    v_mov_b32 v106, v98
    v_mov_b32 v107, v99
    v_permlane32_swap_b32 v96, v104
    v_permlane32_swap_b32 v97, v105
    v_permlane32_swap_b32 v98, v106
    v_permlane32_swap_b32 v99, v107
    v_max_f32 v96, v96, v104
    v_max_f32 v97, v97, v105
    v_max_f32 v98, v98, v106
    v_max_f32 v99, v99, v107
    v_mov_b32 v104, v96
    v_mov_b32 v105, v97
    v_mov_b32 v106, v98
    v_mov_b32 v107, v99
    v_permlane16_swap_b32 v96, v104
    v_permlane16_swap_b32 v97, v105
    v_permlane16_swap_b32 v98, v106
    v_permlane16_swap_b32 v99, v107
    v_max_f32 v96, v96, v104
    v_max_f32 v97, v97, v105
    v_max_f32 v98, v98, v106
    v_max_f32 v99, v99, v107
    s_mul_i32 s99, s28, 1280
    v_add_u32 v101, s99, v3
    ds_write_b32 v101, v96 offset:4096
    ds_write_b32 v101, v97 offset:4352
    ds_write_b32 v101, v98 offset:4608
    ds_write_b32 v101, v99 offset:4864
    s_xor_b32 s99, s28, 1
    s_mul_i32 s99, s99, 1280
    v_add_u32 v101, s99, v3
    s_waitcnt lgkmcnt(0)
    s_barrier
    ds_read_b32 v104, v101 offset:4096
    ds_read_b32 v105, v101 offset:4352
    ds_read_b32 v106, v101 offset:4608
    ds_read_b32 v107, v101 offset:4864
    ds_read_b32 v108, v3 offset:5120
    ds_read_b32 v109, v3 offset:6400
    s_cmp_eq_u32 s39, 0
    s_cselect_b64 vcc, 0, -1
    s_add_u32 m0, s29, 81920
    s_nop 0
    buffer_load_dwordx4 v0, s[16:19], s33 offen offset:0 nt lds
    buffer_load_dwordx4 v0, s[16:19], s33 offen offset:1024 nt lds
    buffer_load_dwordx4 v0, s[16:19], s33 offen offset:2048 nt lds
    buffer_load_dwordx4 v0, s[16:19], s33 offen offset:3072 nt lds
    s_add_u32 s33, s33, 16384
    s_add_u32 m0, s29, 0
    s_nop 0
    buffer_load_dwordx4 v0, s[12:15], s32 offen offset:0 nt lds
    buffer_load_dwordx4 v0, s[12:15], s32 offen offset:1024 nt lds
    buffer_load_dwordx4 v0, s[12:15], s32 offen offset:2048 nt lds
    buffer_load_dwordx4 v0, s[12:15], s32 offen offset:3072 nt lds
    s_add_u32 s32, s32, 16384
    s_waitcnt lgkmcnt(5)
    v_max_f32 v96, v96, v104
    v_sub_f32 v40, 0, v96
    v_sub_f32 v41, 0, v96
    v_sub_f32 v42, 0, v96
    v_sub_f32 v43, 0, v96
    v_sub_f32 v60, v60, v96
    v_sub_f32 v61, v61, v96
    v_sub_f32 v62, v62, v96
    v_sub_f32 v63, v63, v96
    s_waitcnt lgkmcnt(4)
    v_max_f32 v97, v97, v105
    v_sub_f32 v44, 0, v97
    v_sub_f32 v45, 0, v97
    v_sub_f32 v46, 0, v97
    v_sub_f32 v47, 0, v97
    v_sub_f32 v64, v64, v97
    v_sub_f32 v65, v65, v97
    v_sub_f32 v66, v66, v97
    v_sub_f32 v67, v67, v97
    s_waitcnt lgkmcnt(3)
    v_max_f32 v98, v98, v106
    v_sub_f32 v48, 0, v98
    v_sub_f32 v49, 0, v98
    v_sub_f32 v50, 0, v98
    v_sub_f32 v51, 0, v98
    v_sub_f32 v68, v68, v98
    v_sub_f32 v69, v69, v98
    v_sub_f32 v70, v70, v98
    v_sub_f32 v71, v71, v98
    s_waitcnt lgkmcnt(2)
    v_max_f32 v99, v99, v107
    v_sub_f32 v52, 0, v99
    v_sub_f32 v53, 0, v99
    v_sub_f32 v54, 0, v99
    v_sub_f32 v55, 0, v99
    v_sub_f32 v72, v72, v99
    v_sub_f32 v73, v73, v99
    v_sub_f32 v74, v74, v99
    v_sub_f32 v75, v75, v99
    s_waitcnt lgkmcnt(0)
    v_max_f32 v100, v108, v109
    v_sub_f32 v56, 0, v100
    v_sub_f32 v57, 0, v100
    v_sub_f32 v58, 0, v100
    v_sub_f32 v59, 0, v100
    v_exp_f32 v30, v60
    v_exp_f32 v31, v61
    v_add_f32 v24, v24, v30
    v_cvt_pk_bf16_f32 v96, v30, v31
    v_add_f32 v24, v24, v31
    v_exp_f32 v32, v62
    v_exp_f32 v33, v63
    v_add_f32 v24, v24, v32
    v_cvt_pk_bf16_f32 v97, v32, v33
    v_add_f32 v24, v24, v33
    v_exp_f32 v34, v64
    v_exp_f32 v35, v65
    v_add_f32 v25, v25, v34
    v_cvt_pk_bf16_f32 v100, v34, v35
    v_add_f32 v25, v25, v35
    v_exp_f32 v30, v66
    v_exp_f32 v31, v67
    v_add_f32 v25, v25, v30
    v_cvt_pk_bf16_f32 v101, v30, v31
    v_add_f32 v25, v25, v31
    ds_write2st64_b64 v1, v[96:97], v[100:101] offset0:0 offset1:1
    s_mov_b32 s35, 0
    s_waitcnt lgkmcnt(0)
    ds_read_b128 a[224:227], v4 offset:16384
    ds_read_b128 a[228:231], v5 offset:16384
    ds_read_b128 a[232:235], v6 offset:16384
L_loop1:
    s_waitcnt lgkmcnt(2)
    v_mfma_f32_16x16x32_bf16 v[76:79], a[224:227], a[0:3], v[40:43]
    ds_read_b128 a[236:239], v7 offset:16384
    v_mfma_f32_16x16x32_bf16 v[80:83], a[224:227], a[32:35], v[44:47]
    s_add_u32 m0, s29, 98304
    s_waitcnt vmcnt(5)
    buffer_load_dwordx4 v0, s[16:19], s33 offen offset:0 nt lds
    v_mfma_f32_16x16x32_bf16 v[84:87], a[224:227], a[64:67], v[48:51]
    v_exp_f32 v30, v68
    v_mfma_f32_16x16x32_bf16 v[88:91], a[224:227], a[96:99], v[52:55]
    s_waitcnt lgkmcnt(2)
    v_exp_f32 v31, v69
    v_mfma_f32_16x16x32_bf16 v[76:79], a[228:231], a[4:7], v[76:79]
    ds_read_b128 a[240:243], v4 offset:16640
    v_add_f32 v26, v26, v30
    v_mfma_f32_16x16x32_bf16 v[80:83], a[228:231], a[36:39], v[80:83]
    s_waitcnt vmcnt(6)
    buffer_load_dwordx4 v0, s[16:19], s33 offen offset:1024 nt lds
    v_cvt_pk_bf16_f32 v104, v30, v31
    v_mfma_f32_16x16x32_bf16 v[84:87], a[228:231], a[68:71], v[84:87]
    v_add_f32 v26, v26, v31
    v_mfma_f32_16x16x32_bf16 v[88:91], a[228:231], a[100:103], v[88:91]
    s_waitcnt lgkmcnt(2)
    v_exp_f32 v32, v70
    v_mfma_f32_16x16x32_bf16 v[76:79], a[232:235], a[8:11], v[76:79]
    ds_read_b128 a[244:247], v5 offset:16640
    v_mfma_f32_16x16x32_bf16 v[80:83], a[232:235], a[40:43], v[80:83]
    s_waitcnt vmcnt(5)
    buffer_load_dwordx4 v0, s[16:19], s33 offen offset:2048 nt lds
    v_mfma_f32_16x16x32_bf16 v[84:87], a[232:235], a[72:75], v[84:87]
    v_exp_f32 v33, v71
    v_mfma_f32_16x16x32_bf16 v[88:91], a[232:235], a[104:107], v[88:91]
    s_waitcnt lgkmcnt(2)
    v_add_f32 v26, v26, v32
    v_cvt_pk_bf16_f32 v105, v32, v33
    v_mfma_f32_16x16x32_bf16 v[76:79], a[236:239], a[12:15], v[76:79]
    ds_read_b128 a[248:251], v6 offset:16640
    v_add_f32 v26, v26, v33
    v_mfma_f32_16x16x32_bf16 v[80:83], a[236:239], a[44:47], v[80:83]
    s_waitcnt vmcnt(6)
    buffer_load_dwordx4 v0, s[16:19], s33 offen offset:3072 nt lds
    v_mfma_f32_16x16x32_bf16 v[84:87], a[236:239], a[76:79], v[84:87]
    v_exp_f32 v34, v72
    v_mfma_f32_16x16x32_bf16 v[88:91], a[236:239], a[108:111], v[88:91]
    s_waitcnt lgkmcnt(2)
    v_exp_f32 v35, v73
    v_mfma_f32_16x16x32_bf16 v[76:79], a[240:243], a[16:19], v[76:79]
    ds_read_b128 a[252:255], v7 offset:16640
    v_add_f32 v27, v27, v34
    v_mfma_f32_16x16x32_bf16 v[80:83], a[240:243], a[48:51], v[80:83]
    s_add_u32 s33, s33, 16384
    v_cvt_pk_bf16_f32 v108, v34, v35
    v_add_f32 v27, v27, v35
    v_mfma_f32_16x16x32_bf16 v[84:87], a[240:243], a[80:83], v[84:87]
    v_exp_f32 v30, v74
    v_mfma_f32_16x16x32_bf16 v[88:91], a[240:243], a[112:115], v[88:91]
    s_waitcnt lgkmcnt(2)
    v_exp_f32 v31, v75
    v_mfma_f32_16x16x32_bf16 v[76:79], a[244:247], a[20:23], v[76:79]
    v_add_f32 v27, v27, v30
    v_cvt_pk_bf16_f32 v109, v30, v31
    v_add_f32 v27, v27, v31
    ds_write2st64_b64 v1, v[104:105], v[108:109] offset0:2 offset1:3
    v_mfma_f32_16x16x32_bf16 v[80:83], a[244:247], a[52:55], v[80:83]
    s_waitcnt lgkmcnt(1)
    s_waitcnt lgkmcnt(0)
    s_waitcnt vmcnt(16)
    s_barrier
    v_mfma_f32_16x16x32_bf16 v[84:87], a[244:247], a[84:87], v[84:87]
    ds_read_b64 v[98:99], v2 offset:0
    ds_read_b64 v[102:103], v2 offset:512
    v_mfma_f32_16x16x32_bf16 v[88:91], a[244:247], a[116:119], v[88:91]
    ds_read_b64 v[106:107], v2 offset:1024
    ds_read_b64 v[110:111], v2 offset:1536
    v_mfma_f32_16x16x32_bf16 v[76:79], a[248:251], a[24:27], v[76:79]
    ds_read_b64_tr_b16 a[224:225], v8 offset:0
    ds_read_b64_tr_b16 a[226:227], v16 offset:0
    v_mfma_f32_16x16x32_bf16 v[80:83], a[248:251], a[56:59], v[80:83]
    ds_read_b64_tr_b16 a[228:229], v9 offset:0
    ds_read_b64_tr_b16 a[230:231], v17 offset:0
    v_mfma_f32_16x16x32_bf16 v[84:87], a[248:251], a[88:91], v[84:87]
    s_add_u32 m0, s29, 16384
    s_waitcnt vmcnt(5)
    buffer_load_dwordx4 v0, s[12:15], s32 offen offset:0 nt lds
    v_mfma_f32_16x16x32_bf16 v[88:91], a[248:251], a[120:123], v[88:91]
    ds_read_b64_tr_b16 a[232:233], v10 offset:0
    ds_read_b64_tr_b16 a[234:235], v18 offset:0
    v_mfma_f32_16x16x32_bf16 v[76:79], a[252:255], a[28:31], v[76:79]
    v_mfma_f32_16x16x32_bf16 v[80:83], a[252:255], a[60:63], v[80:83]
    v_mfma_f32_16x16x32_bf16 v[84:87], a[252:255], a[92:95], v[84:87]
    v_mfma_f32_16x16x32_bf16 v[88:91], a[252:255], a[124:127], v[88:91]
    s_cbranch_vccnz L_rare22
L_back22:
    s_waitcnt lgkmcnt(4)
    v_mfma_f32_16x16x32_bf16 v[128:131], a[224:227], v[96:99], v[128:131]
    ds_read_b64_tr_b16 a[236:237], v11 offset:0
    ds_read_b64_tr_b16 a[238:239], v19 offset:0
    v_mfma_f32_16x16x32_bf16 v[160:163], a[224:227], v[100:103], v[160:163]
    v_mfma_f32_16x16x32_bf16 v[192:195], a[224:227], v[104:107], v[192:195]
    v_mfma_f32_16x16x32_bf16 v[224:227], a[224:227], v[108:111], v[224:227]
    s_waitcnt lgkmcnt(4)
    s_waitcnt vmcnt(6)
    buffer_load_dwordx4 v0, s[12:15], s32 offen offset:1024 nt lds
    v_mfma_f32_16x16x32_bf16 v[132:135], a[228:231], v[96:99], v[132:135]
    ds_read_b64_tr_b16 a[240:241], v12 offset:0
    ds_read_b64_tr_b16 a[242:243], v20 offset:0
    v_mfma_f32_16x16x32_bf16 v[164:167], a[228:231], v[100:103], v[164:167]
    v_exp_f32 v32, v76
    v_mfma_f32_16x16x32_bf16 v[196:199], a[228:231], v[104:107], v[196:199]
    v_exp_f32 v33, v77
    v_mfma_f32_16x16x32_bf16 v[228:231], a[228:231], v[108:111], v[228:231]
    s_waitcnt lgkmcnt(4)
    v_add_f32 v24, v24, v32
    v_cvt_pk_bf16_f32 v112, v32, v33
    v_mfma_f32_16x16x32_bf16 v[136:139], a[232:235], v[96:99], v[136:139]
    ds_read_b64_tr_b16 a[244:245], v13 offset:0
    ds_read_b64_tr_b16 a[246:247], v21 offset:0
    v_mfma_f32_16x16x32_bf16 v[168:171], a[232:235], v[100:103], v[168:171]
    v_add_f32 v24, v24, v33
    v_mfma_f32_16x16x32_bf16 v[200:203], a[232:235], v[104:107], v[200:203]
    v_exp_f32 v34, v78
    v_mfma_f32_16x16x32_bf16 v[232:235], a[232:235], v[108:111], v[232:235]
    s_waitcnt lgkmcnt(4)
    v_exp_f32 v35, v79
    v_mfma_f32_16x16x32_bf16 v[140:143], a[236:239], v[96:99], v[140:143]
    s_waitcnt vmcnt(5)
    buffer_load_dwordx4 v0, s[12:15], s32 offen offset:2048 nt lds
    v_add_f32 v24, v24, v34
    v_mfma_f32_16x16x32_bf16 v[172:175], a[236:239], v[100:103], v[172:175]
    ds_read_b64_tr_b16 a[248:249], v14 offset:0
    ds_read_b64_tr_b16 a[250:251], v22 offset:0
    v_mfma_f32_16x16x32_bf16 v[204:207], a[236:239], v[104:107], v[204:207]
    v_cvt_pk_bf16_f32 v113, v34, v35
    v_add_f32 v24, v24, v35
    v_mfma_f32_16x16x32_bf16 v[236:239], a[236:239], v[108:111], v[236:239]
    s_waitcnt lgkmcnt(4)
    v_exp_f32 v30, v80
    v_mfma_f32_16x16x32_bf16 v[144:147], a[240:243], v[96:99], v[144:147]
    ds_read_b64_tr_b16 a[252:253], v15 offset:0
    ds_read_b64_tr_b16 a[254:255], v23 offset:0
    v_mfma_f32_16x16x32_bf16 v[176:179], a[240:243], v[100:103], v[176:179]
    v_exp_f32 v31, v81
    v_mfma_f32_16x16x32_bf16 v[208:211], a[240:243], v[104:107], v[208:211]
    v_add_f32 v25, v25, v30
    v_cvt_pk_bf16_f32 v116, v30, v31
    v_mfma_f32_16x16x32_bf16 v[240:243], a[240:243], v[108:111], v[240:243]
    s_waitcnt lgkmcnt(4)
    v_add_f32 v25, v25, v31
    v_mfma_f32_16x16x32_bf16 v[148:151], a[244:247], v[96:99], v[148:151]
    ds_read_b128 a[224:227], v4 offset:32768
    v_mfma_f32_16x16x32_bf16 v[180:183], a[244:247], v[100:103], v[180:183]
    s_waitcnt vmcnt(6)
    buffer_load_dwordx4 v0, s[12:15], s32 offen offset:3072 nt lds
    v_mfma_f32_16x16x32_bf16 v[212:215], a[244:247], v[104:107], v[212:215]
    v_exp_f32 v32, v82
    v_mfma_f32_16x16x32_bf16 v[244:247], a[244:247], v[108:111], v[244:247]
    s_waitcnt lgkmcnt(3)
    v_exp_f32 v33, v83
    v_mfma_f32_16x16x32_bf16 v[152:155], a[248:251], v[96:99], v[152:155]
    ds_read_b128 a[228:231], v5 offset:32768
    v_add_f32 v25, v25, v32
    v_mfma_f32_16x16x32_bf16 v[184:187], a[248:251], v[100:103], v[184:187]
    v_cvt_pk_bf16_f32 v117, v32, v33
    v_add_f32 v25, v25, v33
    v_mfma_f32_16x16x32_bf16 v[216:219], a[248:251], v[104:107], v[216:219]
    ds_write2st64_b64 v1, v[112:113], v[116:117] offset0:5 offset1:6
    v_mfma_f32_16x16x32_bf16 v[248:251], a[248:251], v[108:111], v[248:251]
    s_waitcnt lgkmcnt(3)
    v_mfma_f32_16x16x32_bf16 v[156:159], a[252:255], v[96:99], v[156:159]
    ds_read_b128 a[232:235], v6 offset:32768
    v_mfma_f32_16x16x32_bf16 v[188:191], a[252:255], v[100:103], v[188:191]
    v_mfma_f32_16x16x32_bf16 v[220:223], a[252:255], v[104:107], v[220:223]
    s_add_u32 s32, s32, 16384
    v_mfma_f32_16x16x32_bf16 v[252:255], a[252:255], v[108:111], v[252:255]
    s_cbranch_vccnz L_rare23
L_back23:
    s_waitcnt lgkmcnt(3)
    v_mfma_f32_16x16x32_bf16 v[60:63], a[224:227], a[0:3], v[40:43]
    ds_read_b128 a[236:239], v7 offset:32768
    v_mfma_f32_16x16x32_bf16 v[64:67], a[224:227], a[32:35], v[44:47]
    s_add_u32 m0, s29, 114688
    s_waitcnt vmcnt(5)
    buffer_load_dwordx4 v0, s[16:19], s33 offen offset:0 nt lds
    v_mfma_f32_16x16x32_bf16 v[68:71], a[224:227], a[64:67], v[48:51]
    v_exp_f32 v34, v84
    v_mfma_f32_16x16x32_bf16 v[72:75], a[224:227], a[96:99], v[52:55]
    v_exp_f32 v35, v85
    v_mfma_f32_16x16x32_bf16 v[92:95], a[224:227], a[128:131], v[56:59]
    s_waitcnt lgkmcnt(3)
    v_add_f32 v26, v26, v34
    v_cvt_pk_bf16_f32 v120, v34, v35
    v_mfma_f32_16x16x32_bf16 v[60:63], a[228:231], a[4:7], v[60:63]
    ds_read_b128 a[240:243], v4 offset:33024
    v_add_f32 v26, v26, v35
    v_mfma_f32_16x16x32_bf16 v[64:67], a[228:231], a[36:39], v[64:67]
    v_exp_f32 v30, v86
    v_mfma_f32_16x16x32_bf16 v[68:71], a[228:231], a[68:71], v[68:71]
    s_waitcnt vmcnt(6)
    buffer_load_dwordx4 v0, s[16:19], s33 offen offset:1024 nt lds
    v_mfma_f32_16x16x32_bf16 v[72:75], a[228:231], a[100:103], v[72:75]
    v_exp_f32 v31, v87
    v_mfma_f32_16x16x32_bf16 v[92:95], a[228:231], a[132:135], v[92:95]
    s_waitcnt lgkmcnt(2)
    v_add_f32 v26, v26, v30
    v_cvt_pk_bf16_f32 v121, v30, v31
    v_mfma_f32_16x16x32_bf16 v[60:63], a[232:235], a[8:11], v[60:63]
    ds_read_b128 a[244:247], v5 offset:33024
    v_add_f32 v26, v26, v31
    v_mfma_f32_16x16x32_bf16 v[64:67], a[232:235], a[40:43], v[64:67]
    v_exp_f32 v32, v88
    v_mfma_f32_16x16x32_bf16 v[68:71], a[232:235], a[72:75], v[68:71]
    v_exp_f32 v33, v89
    v_mfma_f32_16x16x32_bf16 v[72:75], a[232:235], a[104:107], v[72:75]
    s_waitcnt vmcnt(5)
    buffer_load_dwordx4 v0, s[16:19], s33 offen offset:2048 nt lds
    v_add_f32 v27, v27, v32
    v_mfma_f32_16x16x32_bf16 v[92:95], a[232:235], a[136:139], v[92:95]
    s_waitcnt lgkmcnt(2)
    v_cvt_pk_bf16_f32 v124, v32, v33
    v_add_f32 v27, v27, v33
    v_mfma_f32_16x16x32_bf16 v[60:63], a[236:239], a[12:15], v[60:63]
    ds_read_b128 a[248:251], v6 offset:33024
    v_mfma_f32_16x16x32_bf16 v[64:67], a[236:239], a[44:47], v[64:67]
    v_exp_f32 v34, v90
    v_mfma_f32_16x16x32_bf16 v[68:71], a[236:239], a[76:79], v[68:71]
    v_exp_f32 v35, v91
    v_mfma_f32_16x16x32_bf16 v[72:75], a[236:239], a[108:111], v[72:75]
    v_add_f32 v27, v27, v34
    v_cvt_pk_bf16_f32 v125, v34, v35
    v_mfma_f32_16x16x32_bf16 v[92:95], a[236:239], a[140:143], v[92:95]
    s_waitcnt lgkmcnt(2)
    s_waitcnt vmcnt(6)
    buffer_load_dwordx4 v0, s[16:19], s33 offen offset:3072 nt lds
    v_mfma_f32_16x16x32_bf16 v[60:63], a[240:243], a[16:19], v[60:63]
    ds_read_b128 a[252:255], v7 offset:33024
    v_add_f32 v27, v27, v35
    v_mfma_f32_16x16x32_bf16 v[64:67], a[240:243], a[48:51], v[64:67]
    ds_write2st64_b64 v1, v[120:121], v[124:125] offset0:7 offset1:8
    v_mfma_f32_16x16x32_bf16 v[68:71], a[240:243], a[80:83], v[68:71]
    v_mfma_f32_16x16x32_bf16 v[72:75], a[240:243], a[112:115], v[72:75]
    v_mfma_f32_16x16x32_bf16 v[92:95], a[240:243], a[144:147], v[92:95]
    s_waitcnt lgkmcnt(3)
    v_mfma_f32_16x16x32_bf16 v[60:63], a[244:247], a[20:23], v[60:63]
    s_add_u32 s33, s33, 16384
    v_mfma_f32_16x16x32_bf16 v[64:67], a[244:247], a[52:55], v[64:67]
    v_mfma_f32_16x16x32_bf16 v[68:71], a[244:247], a[84:87], v[68:71]
    v_mfma_f32_16x16x32_bf16 v[72:75], a[244:247], a[116:119], v[72:75]
    v_mfma_f32_16x16x32_bf16 v[92:95], a[244:247], a[148:151], v[92:95]
    s_waitcnt lgkmcnt(1)
    s_waitcnt lgkmcnt(0)
    s_waitcnt vmcnt(16)
    s_barrier
    v_mfma_f32_16x16x32_bf16 v[60:63], a[248:251], a[24:27], v[60:63]
    ds_read_b64 v[114:115], v2 offset:2560
    ds_read_b64 v[118:119], v2 offset:3072
    v_mfma_f32_16x16x32_bf16 v[64:67], a[248:251], a[56:59], v[64:67]
    ds_read_b64 v[122:123], v2 offset:3584
    ds_read_b64 v[126:127], v2 offset:4096
    v_mfma_f32_16x16x32_bf16 v[68:71], a[248:251], a[88:91], v[68:71]
    ds_read_b64_tr_b16 a[224:225], v8 offset:16384
    ds_read_b64_tr_b16 a[226:227], v16 offset:16384
    v_mfma_f32_16x16x32_bf16 v[72:75], a[248:251], a[120:123], v[72:75]
    ds_read_b64_tr_b16 a[228:229], v9 offset:16384
    ds_read_b64_tr_b16 a[230:231], v17 offset:16384
    v_mfma_f32_16x16x32_bf16 v[92:95], a[248:251], a[152:155], v[92:95]
    s_add_u32 m0, s29, 32768
    s_waitcnt vmcnt(5)
    buffer_load_dwordx4 v0, s[12:15], s32 offen offset:0 nt lds
    v_mfma_f32_16x16x32_bf16 v[60:63], a[252:255], a[28:31], v[60:63]
    ds_read_b64_tr_b16 a[232:233], v10 offset:16384
    ds_read_b64_tr_b16 a[234:235], v18 offset:16384
    v_mfma_f32_16x16x32_bf16 v[64:67], a[252:255], a[60:63], v[64:67]
    v_mfma_f32_16x16x32_bf16 v[68:71], a[252:255], a[92:95], v[68:71]
    v_mfma_f32_16x16x32_bf16 v[72:75], a[252:255], a[124:127], v[72:75]
    v_mfma_f32_16x16x32_bf16 v[92:95], a[252:255], a[156:159], v[92:95]
    s_cbranch_vccnz L_rare24
L_back24:
    s_waitcnt lgkmcnt(4)
    v_mfma_f32_16x16x32_bf16 v[128:131], a[224:227], v[112:115], v[128:131]
    ds_read_b64_tr_b16 a[236:237], v11 offset:16384
    ds_read_b64_tr_b16 a[238:239], v19 offset:16384
    v_mfma_f32_16x16x32_bf16 v[160:163], a[224:227], v[116:119], v[160:163]
    v_mfma_f32_16x16x32_bf16 v[192:195], a[224:227], v[120:123], v[192:195]
    v_mfma_f32_16x16x32_bf16 v[224:227], a[224:227], v[124:127], v[224:227]
    s_waitcnt lgkmcnt(4)
    s_waitcnt vmcnt(6)
    buffer_load_dwordx4 v0, s[12:15], s32 offen offset:1024 nt lds
    v_mfma_f32_16x16x32_bf16 v[132:135], a[228:231], v[112:115], v[132:135]
    ds_read_b64_tr_b16 a[240:241], v12 offset:16384
    ds_read_b64_tr_b16 a[242:243], v20 offset:16384
    v_mfma_f32_16x16x32_bf16 v[164:167], a[228:231], v[116:119], v[164:167]
    v_exp_f32 v30, v92
    v_mfma_f32_16x16x32_bf16 v[196:199], a[228:231], v[120:123], v[196:199]
    v_exp_f32 v31, v93
    v_mfma_f32_16x16x32_bf16 v[228:231], a[228:231], v[124:127], v[228:231]
    s_waitcnt lgkmcnt(4)
    v_add_f32 v28, v28, v30
    v_cvt_pk_bf16_f32 v36, v30, v31
    v_mfma_f32_16x16x32_bf16 v[136:139], a[232:235], v[112:115], v[136:139]
    ds_read_b64_tr_b16 a[244:245], v13 offset:16384
    ds_read_b64_tr_b16 a[246:247], v21 offset:16384
    v_mfma_f32_16x16x32_bf16 v[168:171], a[232:235], v[116:119], v[168:171]
    v_add_f32 v28, v28, v31
    v_mfma_f32_16x16x32_bf16 v[200:203], a[232:235], v[120:123], v[200:203]
    v_exp_f32 v32, v94
    v_mfma_f32_16x16x32_bf16 v[232:235], a[232:235], v[124:127], v[232:235]
    s_waitcnt lgkmcnt(4)
    v_exp_f32 v33, v95
    v_mfma_f32_16x16x32_bf16 v[140:143], a[236:239], v[112:115], v[140:143]
    s_waitcnt vmcnt(5)
    buffer_load_dwordx4 v0, s[12:15], s32 offen offset:2048 nt lds
    v_add_f32 v28, v28, v32
    v_mfma_f32_16x16x32_bf16 v[172:175], a[236:239], v[116:119], v[172:175]
    ds_read_b64_tr_b16 a[248:249], v14 offset:16384
    ds_read_b64_tr_b16 a[250:251], v22 offset:16384
    v_mfma_f32_16x16x32_bf16 v[204:207], a[236:239], v[120:123], v[204:207]
    v_cvt_pk_bf16_f32 v37, v32, v33
    v_add_f32 v28, v28, v33
    v_mfma_f32_16x16x32_bf16 v[236:239], a[236:239], v[124:127], v[236:239]
    s_waitcnt lgkmcnt(4)
    ds_write_b64 v1, v[36:37] offset:2048
    v_mfma_f32_16x16x32_bf16 v[144:147], a[240:243], v[112:115], v[144:147]
    ds_read_b64_tr_b16 a[252:253], v15 offset:16384
    ds_read_b64_tr_b16 a[254:255], v23 offset:16384
    v_mfma_f32_16x16x32_bf16 v[176:179], a[240:243], v[116:119], v[176:179]
    v_exp_f32 v34, v60
    v_mfma_f32_16x16x32_bf16 v[208:211], a[240:243], v[120:123], v[208:211]
    v_exp_f32 v35, v61
    v_mfma_f32_16x16x32_bf16 v[240:243], a[240:243], v[124:127], v[240:243]
    s_waitcnt lgkmcnt(5)
    v_add_f32 v24, v24, v34
    v_cvt_pk_bf16_f32 v96, v34, v35
    v_mfma_f32_16x16x32_bf16 v[148:151], a[244:247], v[112:115], v[148:151]
    ds_read_b128 a[224:227], v4 offset:49152
    v_add_f32 v24, v24, v35
    v_mfma_f32_16x16x32_bf16 v[180:183], a[244:247], v[116:119], v[180:183]
    s_waitcnt vmcnt(6)
    buffer_load_dwordx4 v0, s[12:15], s32 offen offset:3072 nt lds
    v_mfma_f32_16x16x32_bf16 v[212:215], a[244:247], v[120:123], v[212:215]
    v_exp_f32 v30, v62
    v_mfma_f32_16x16x32_bf16 v[244:247], a[244:247], v[124:127], v[244:247]
    s_waitcnt lgkmcnt(4)
    v_exp_f32 v31, v63
    v_mfma_f32_16x16x32_bf16 v[152:155], a[248:251], v[112:115], v[152:155]
    ds_read_b128 a[228:231], v5 offset:49152
    v_add_f32 v24, v24, v30
    v_mfma_f32_16x16x32_bf16 v[184:187], a[248:251], v[116:119], v[184:187]
    v_cvt_pk_bf16_f32 v97, v30, v31
    v_add_f32 v24, v24, v31
    v_mfma_f32_16x16x32_bf16 v[216:219], a[248:251], v[120:123], v[216:219]
    v_mfma_f32_16x16x32_bf16 v[248:251], a[248:251], v[124:127], v[248:251]
    s_waitcnt lgkmcnt(2)
    v_mfma_f32_16x16x32_bf16 v[156:159], a[252:255], v[112:115], v[156:159]
    ds_read_b128 a[232:235], v6 offset:49152
    v_mfma_f32_16x16x32_bf16 v[188:191], a[252:255], v[116:119], v[188:191]
    v_mfma_f32_16x16x32_bf16 v[220:223], a[252:255], v[120:123], v[220:223]
    s_add_u32 s32, s32, 16384
    v_mfma_f32_16x16x32_bf16 v[252:255], a[252:255], v[124:127], v[252:255]
    s_cbranch_vccnz L_rare25
L_back25:
    s_waitcnt lgkmcnt(2)
    v_mfma_f32_16x16x32_bf16 v[76:79], a[224:227], a[0:3], v[40:43]
    ds_read_b128 a[236:239], v7 offset:49152
    v_mfma_f32_16x16x32_bf16 v[80:83], a[224:227], a[32:35], v[44:47]
    s_add_u32 m0, s29, 65536
    s_waitcnt vmcnt(5)
    buffer_load_dwordx4 v0, s[16:19], s33 offen offset:0 nt lds
    v_mfma_f32_16x16x32_bf16 v[84:87], a[224:227], a[64:67], v[48:51]
    v_exp_f32 v32, v64
    v_mfma_f32_16x16x32_bf16 v[88:91], a[224:227], a[96:99], v[52:55]
    v_exp_f32 v33, v65
    v_mfma_f32_16x16x32_bf16 v[92:95], a[224:227], a[128:131], v[56:59]
    s_waitcnt lgkmcnt(2)
    v_add_f32 v25, v25, v32
    v_cvt_pk_bf16_f32 v100, v32, v33
    v_mfma_f32_16x16x32_bf16 v[76:79], a[228:231], a[4:7], v[76:79]
    ds_read_b128 a[240:243], v4 offset:49408
    v_add_f32 v25, v25, v33
    v_mfma_f32_16x16x32_bf16 v[80:83], a[228:231], a[36:39], v[80:83]
    v_exp_f32 v34, v66
    v_mfma_f32_16x16x32_bf16 v[84:87], a[228:231], a[68:71], v[84:87]
    s_waitcnt vmcnt(6)
    buffer_load_dwordx4 v0, s[16:19], s33 offen offset:1024 nt lds
    v_mfma_f32_16x16x32_bf16 v[88:91], a[228:231], a[100:103], v[88:91]
    v_exp_f32 v35, v67
    v_mfma_f32_16x16x32_bf16 v[92:95], a[228:231], a[132:135], v[92:95]
    s_waitcnt lgkmcnt(2)
    v_add_f32 v25, v25, v34
    v_cvt_pk_bf16_f32 v101, v34, v35
    v_mfma_f32_16x16x32_bf16 v[76:79], a[232:235], a[8:11], v[76:79]
    ds_read_b128 a[244:247], v5 offset:49408
    v_add_f32 v25, v25, v35
    v_mfma_f32_16x16x32_bf16 v[80:83], a[232:235], a[40:43], v[80:83]
    ds_write2st64_b64 v1, v[96:97], v[100:101] offset0:0 offset1:1
    v_mfma_f32_16x16x32_bf16 v[84:87], a[232:235], a[72:75], v[84:87]
    v_exp_f32 v30, v68
    v_mfma_f32_16x16x32_bf16 v[88:91], a[232:235], a[104:107], v[88:91]
    s_waitcnt vmcnt(5)
    buffer_load_dwordx4 v0, s[16:19], s33 offen offset:2048 nt lds
    v_mfma_f32_16x16x32_bf16 v[92:95], a[232:235], a[136:139], v[92:95]
    s_waitcnt lgkmcnt(3)
    v_exp_f32 v31, v69
    v_mfma_f32_16x16x32_bf16 v[76:79], a[236:239], a[12:15], v[76:79]
    ds_read_b128 a[248:251], v6 offset:49408
    v_add_f32 v26, v26, v30
    v_mfma_f32_16x16x32_bf16 v[80:83], a[236:239], a[44:47], v[80:83]
    v_cvt_pk_bf16_f32 v104, v30, v31
    v_add_f32 v26, v26, v31
    v_mfma_f32_16x16x32_bf16 v[84:87], a[236:239], a[76:79], v[84:87]
    v_exp_f32 v32, v70
    v_mfma_f32_16x16x32_bf16 v[88:91], a[236:239], a[108:111], v[88:91]
    v_exp_f32 v33, v71
    v_mfma_f32_16x16x32_bf16 v[92:95], a[236:239], a[140:143], v[92:95]
    s_waitcnt lgkmcnt(3)
    s_waitcnt vmcnt(6)
    buffer_load_dwordx4 v0, s[16:19], s33 offen offset:3072 nt lds
    v_mfma_f32_16x16x32_bf16 v[76:79], a[240:243], a[16:19], v[76:79]
    ds_read_b128 a[252:255], v7 offset:49408
    v_add_f32 v26, v26, v32
    v_mfma_f32_16x16x32_bf16 v[80:83], a[240:243], a[48:51], v[80:83]
    v_cvt_pk_bf16_f32 v105, v32, v33
    v_add_f32 v26, v26, v33
    v_mfma_f32_16x16x32_bf16 v[84:87], a[240:243], a[80:83], v[84:87]
    v_exp_f32 v34, v72
    v_mfma_f32_16x16x32_bf16 v[88:91], a[240:243], a[112:115], v[88:91]
    v_exp_f32 v35, v73
    v_mfma_f32_16x16x32_bf16 v[92:95], a[240:243], a[144:147], v[92:95]
    s_waitcnt lgkmcnt(3)
    v_add_f32 v27, v27, v34
    v_cvt_pk_bf16_f32 v108, v34, v35
    v_mfma_f32_16x16x32_bf16 v[76:79], a[244:247], a[20:23], v[76:79]
    s_add_u32 s33, s33, 16384
    v_add_f32 v27, v27, v35
    v_mfma_f32_16x16x32_bf16 v[80:83], a[244:247], a[52:55], v[80:83]
    v_exp_f32 v30, v74
    v_mfma_f32_16x16x32_bf16 v[84:87], a[244:247], a[84:87], v[84:87]
    v_exp_f32 v31, v75
    v_mfma_f32_16x16x32_bf16 v[88:91], a[244:247], a[116:119], v[88:91]
    v_add_f32 v27, v27, v30
    v_cvt_pk_bf16_f32 v109, v30, v31
    v_add_f32 v27, v27, v31
    ds_write2st64_b64 v1, v[104:105], v[108:109] offset0:2 offset1:3
    v_mfma_f32_16x16x32_bf16 v[92:95], a[244:247], a[148:151], v[92:95]
    s_waitcnt lgkmcnt(1)
    s_waitcnt lgkmcnt(0)
    s_waitcnt vmcnt(16)
    s_barrier
    v_mfma_f32_16x16x32_bf16 v[76:79], a[248:251], a[24:27], v[76:79]
    ds_read_b64 v[98:99], v2 offset:0
    ds_read_b64 v[102:103], v2 offset:512
    v_mfma_f32_16x16x32_bf16 v[80:83], a[248:251], a[56:59], v[80:83]
    ds_read_b64 v[106:107], v2 offset:1024
    ds_read_b64 v[110:111], v2 offset:1536
    v_mfma_f32_16x16x32_bf16 v[84:87], a[248:251], a[88:91], v[84:87]
    ds_read_b64 v[38:39], v2 offset:2048
    v_mfma_f32_16x16x32_bf16 v[88:91], a[248:251], a[120:123], v[88:91]
    ds_read_b64_tr_b16 a[224:225], v8 offset:32768
    ds_read_b64_tr_b16 a[226:227], v16 offset:32768
    v_mfma_f32_16x16x32_bf16 v[92:95], a[248:251], a[152:155], v[92:95]
    ds_read_b64_tr_b16 a[228:229], v9 offset:32768
    ds_read_b64_tr_b16 a[230:231], v17 offset:32768
    v_mfma_f32_16x16x32_bf16 v[76:79], a[252:255], a[28:31], v[76:79]
    ds_read_b64_tr_b16 a[232:233], v10 offset:32768
    ds_read_b64_tr_b16 a[234:235], v18 offset:32768
    v_mfma_f32_16x16x32_bf16 v[80:83], a[252:255], a[60:63], v[80:83]
    s_add_u32 m0, s29, 49152
    s_waitcnt vmcnt(5)
    buffer_load_dwordx4 v0, s[12:15], s32 offen offset:0 nt lds
    v_mfma_f32_16x16x32_bf16 v[84:87], a[252:255], a[92:95], v[84:87]
    v_mfma_f32_16x16x32_bf16 v[88:91], a[252:255], a[124:127], v[88:91]
    v_mfma_f32_16x16x32_bf16 v[92:95], a[252:255], a[156:159], v[92:95]
    s_cbranch_vccnz L_rare26
L_back26:
    s_waitcnt lgkmcnt(4)
    v_mfma_f32_16x16x32_bf16 v[128:131], a[224:227], v[96:99], v[128:131]
    ds_read_b64_tr_b16 a[236:237], v11 offset:32768
    ds_read_b64_tr_b16 a[238:239], v19 offset:32768
    v_mfma_f32_16x16x32_bf16 v[160:163], a[224:227], v[100:103], v[160:163]
    v_mfma_f32_16x16x32_bf16 v[192:195], a[224:227], v[104:107], v[192:195]
    v_mfma_f32_16x16x32_bf16 v[224:227], a[224:227], v[108:111], v[224:227]
    v_mfma_f32_16x16x32_bf16 a[160:163], a[224:227], v[36:39], a[160:163]
    s_waitcnt lgkmcnt(4)
    v_mfma_f32_16x16x32_bf16 v[132:135], a[228:231], v[96:99], v[132:135]
    s_waitcnt vmcnt(6)
    buffer_load_dwordx4 v0, s[12:15], s32 offen offset:1024 nt lds
    v_mfma_f32_16x16x32_bf16 v[164:167], a[228:231], v[100:103], v[164:167]
    ds_read_b64_tr_b16 a[240:241], v12 offset:32768
    ds_read_b64_tr_b16 a[242:243], v20 offset:32768
    v_mfma_f32_16x16x32_bf16 v[196:199], a[228:231], v[104:107], v[196:199]
    v_exp_f32 v32, v76
    v_mfma_f32_16x16x32_bf16 v[228:231], a[228:231], v[108:111], v[228:231]
    v_exp_f32 v33, v77
    v_mfma_f32_16x16x32_bf16 a[164:167], a[228:231], v[36:39], a[164:167]
    s_waitcnt lgkmcnt(4)
    v_add_f32 v24, v24, v32
    v_cvt_pk_bf16_f32 v112, v32, v33
    v_mfma_f32_16x16x32_bf16 v[136:139], a[232:235], v[96:99], v[136:139]
    ds_read_b64_tr_b16 a[244:245], v13 offset:32768
    ds_read_b64_tr_b16 a[246:247], v21 offset:32768
    v_mfma_f32_16x16x32_bf16 v[168:171], a[232:235], v[100:103], v[168:171]
    v_add_f32 v24, v24, v33
    v_mfma_f32_16x16x32_bf16 v[200:203], a[232:235], v[104:107], v[200:203]
    v_exp_f32 v34, v78
    v_mfma_f32_16x16x32_bf16 v[232:235], a[232:235], v[108:111], v[232:235]
    v_exp_f32 v35, v79
    v_mfma_f32_16x16x32_bf16 a[168:171], a[232:235], v[36:39], a[168:171]
    s_waitcnt lgkmcnt(4)
    v_add_f32 v24, v24, v34
    v_cvt_pk_bf16_f32 v113, v34, v35
    v_mfma_f32_16x16x32_bf16 v[140:143], a[236:239], v[96:99], v[140:143]
    ds_read_b64_tr_b16 a[248:249], v14 offset:32768
    ds_read_b64_tr_b16 a[250:251], v22 offset:32768
    v_mfma_f32_16x16x32_bf16 v[172:175], a[236:239], v[100:103], v[172:175]
    s_waitcnt vmcnt(5)
    buffer_load_dwordx4 v0, s[12:15], s32 offen offset:2048 nt lds
    v_add_f32 v24, v24, v35
    v_mfma_f32_16x16x32_bf16 v[204:207], a[236:239], v[104:107], v[204:207]
    v_exp_f32 v30, v80
    v_mfma_f32_16x16x32_bf16 v[236:239], a[236:239], v[108:111], v[236:239]
    v_exp_f32 v31, v81
    v_mfma_f32_16x16x32_bf16 a[172:175], a[236:239], v[36:39], a[172:175]
    s_waitcnt lgkmcnt(4)
    v_add_f32 v25, v25, v30
    v_cvt_pk_bf16_f32 v116, v30, v31
    v_mfma_f32_16x16x32_bf16 v[144:147], a[240:243], v[96:99], v[144:147]
    ds_read_b64_tr_b16 a[252:253], v15 offset:32768
    ds_read_b64_tr_b16 a[254:255], v23 offset:32768
    v_mfma_f32_16x16x32_bf16 v[176:179], a[240:243], v[100:103], v[176:179]
    v_add_f32 v25, v25, v31
    v_mfma_f32_16x16x32_bf16 v[208:211], a[240:243], v[104:107], v[208:211]
    v_exp_f32 v32, v82
    v_mfma_f32_16x16x32_bf16 v[240:243], a[240:243], v[108:111], v[240:243]
    v_exp_f32 v33, v83
    v_mfma_f32_16x16x32_bf16 a[176:179], a[240:243], v[36:39], a[176:179]
    s_waitcnt lgkmcnt(4)
    v_add_f32 v25, v25, v32
    v_cvt_pk_bf16_f32 v117, v32, v33
    v_mfma_f32_16x16x32_bf16 v[148:151], a[244:247], v[96:99], v[148:151]
    ds_read_b128 a[224:227], v4 offset:0
    v_add_f32 v25, v25, v33
    v_mfma_f32_16x16x32_bf16 v[180:183], a[244:247], v[100:103], v[180:183]
    ds_write2st64_b64 v1, v[112:113], v[116:117] offset0:5 offset1:6
    v_mfma_f32_16x16x32_bf16 v[212:215], a[244:247], v[104:107], v[212:215]
    s_waitcnt vmcnt(6)
    buffer_load_dwordx4 v0, s[12:15], s32 offen offset:3072 nt lds
    v_mfma_f32_16x16x32_bf16 v[244:247], a[244:247], v[108:111], v[244:247]
    v_exp_f32 v34, v84
    v_mfma_f32_16x16x32_bf16 a[180:183], a[244:247], v[36:39], a[180:183]
    s_waitcnt lgkmcnt(4)
    v_exp_f32 v35, v85
    v_mfma_f32_16x16x32_bf16 v[152:155], a[248:251], v[96:99], v[152:155]
    ds_read_b128 a[228:231], v5 offset:0
    v_add_f32 v26, v26, v34
    v_mfma_f32_16x16x32_bf16 v[184:187], a[248:251], v[100:103], v[184:187]
    v_cvt_pk_bf16_f32 v120, v34, v35
    v_add_f32 v26, v26, v35
    v_mfma_f32_16x16x32_bf16 v[216:219], a[248:251], v[104:107], v[216:219]
    v_exp_f32 v30, v86
    v_mfma_f32_16x16x32_bf16 v[248:251], a[248:251], v[108:111], v[248:251]
    v_exp_f32 v31, v87
    v_mfma_f32_16x16x32_bf16 a[184:187], a[248:251], v[36:39], a[184:187]
    s_waitcnt lgkmcnt(3)
    v_add_f32 v26, v26, v30
    v_cvt_pk_bf16_f32 v121, v30, v31
    v_mfma_f32_16x16x32_bf16 v[156:159], a[252:255], v[96:99], v[156:159]
    ds_read_b128 a[232:235], v6 offset:0
    v_add_f32 v26, v26, v31
    v_mfma_f32_16x16x32_bf16 v[188:191], a[252:255], v[100:103], v[188:191]
    v_mfma_f32_16x16x32_bf16 v[220:223], a[252:255], v[104:107], v[220:223]
    v_mfma_f32_16x16x32_bf16 v[252:255], a[252:255], v[108:111], v[252:255]
    s_add_u32 s32, s32, 16384
    v_mfma_f32_16x16x32_bf16 a[188:191], a[252:255], v[36:39], a[188:191]
    s_cbranch_vccnz L_rare27
L_back27:
    s_waitcnt lgkmcnt(3)
    v_mfma_f32_16x16x32_bf16 v[60:63], a[224:227], a[0:3], v[40:43]
    ds_read_b128 a[236:239], v7 offset:0
    v_mfma_f32_16x16x32_bf16 v[64:67], a[224:227], a[32:35], v[44:47]
    s_add_u32 m0, s29, 81920
    s_waitcnt vmcnt(5)
    buffer_load_dwordx4 v0, s[16:19], s33 offen offset:0 nt lds
    v_mfma_f32_16x16x32_bf16 v[68:71], a[224:227], a[64:67], v[48:51]
    v_exp_f32 v32, v88
    v_mfma_f32_16x16x32_bf16 v[72:75], a[224:227], a[96:99], v[52:55]
    s_waitcnt lgkmcnt(2)
    v_exp_f32 v33, v89
    v_mfma_f32_16x16x32_bf16 v[60:63], a[228:231], a[4:7], v[60:63]
    ds_read_b128 a[240:243], v4 offset:256
    v_add_f32 v27, v27, v32
    v_mfma_f32_16x16x32_bf16 v[64:67], a[228:231], a[36:39], v[64:67]
    s_waitcnt vmcnt(6)
    buffer_load_dwordx4 v0, s[16:19], s33 offen offset:1024 nt lds
    v_cvt_pk_bf16_f32 v124, v32, v33
    v_mfma_f32_16x16x32_bf16 v[68:71], a[228:231], a[68:71], v[68:71]
    v_add_f32 v27, v27, v33
    v_mfma_f32_16x16x32_bf16 v[72:75], a[228:231], a[100:103], v[72:75]
    s_waitcnt lgkmcnt(2)
    v_exp_f32 v34, v90
    v_mfma_f32_16x16x32_bf16 v[60:63], a[232:235], a[8:11], v[60:63]
    ds_read_b128 a[244:247], v5 offset:256
    v_mfma_f32_16x16x32_bf16 v[64:67], a[232:235], a[40:43], v[64:67]
    s_waitcnt vmcnt(5)
    buffer_load_dwordx4 v0, s[16:19], s33 offen offset:2048 nt lds
    v_mfma_f32_16x16x32_bf16 v[68:71], a[232:235], a[72:75], v[68:71]
    v_exp_f32 v35, v91
    v_mfma_f32_16x16x32_bf16 v[72:75], a[232:235], a[104:107], v[72:75]
    s_waitcnt lgkmcnt(2)
    v_add_f32 v27, v27, v34
    v_cvt_pk_bf16_f32 v125, v34, v35
    v_mfma_f32_16x16x32_bf16 v[60:63], a[236:239], a[12:15], v[60:63]
    ds_read_b128 a[248:251], v6 offset:256
    v_add_f32 v27, v27, v35
    v_mfma_f32_16x16x32_bf16 v[64:67], a[236:239], a[44:47], v[64:67]
    s_waitcnt vmcnt(6)
    buffer_load_dwordx4 v0, s[16:19], s33 offen offset:3072 nt lds
    v_mfma_f32_16x16x32_bf16 v[68:71], a[236:239], a[76:79], v[68:71]
    ds_write2st64_b64 v1, v[120:121], v[124:125] offset0:7 offset1:8
    v_mfma_f32_16x16x32_bf16 v[72:75], a[236:239], a[108:111], v[72:75]
    s_waitcnt lgkmcnt(3)
    v_exp_f32 v30, v92
    v_mfma_f32_16x16x32_bf16 v[60:63], a[240:243], a[16:19], v[60:63]
    ds_read_b128 a[252:255], v7 offset:256
    v_mfma_f32_16x16x32_bf16 v[64:67], a[240:243], a[48:51], v[64:67]
    s_add_u32 s33, s33, 16384
    v_exp_f32 v31, v93
    v_mfma_f32_16x16x32_bf16 v[68:71], a[240:243], a[80:83], v[68:71]
    v_add_f32 v28, v28, v30
    v_cvt_pk_bf16_f32 v36, v30, v31
    v_mfma_f32_16x16x32_bf16 v[72:75], a[240:243], a[112:115], v[72:75]
    s_waitcnt lgkmcnt(3)
    v_add_f32 v28, v28, v31
    v_mfma_f32_16x16x32_bf16 v[60:63], a[244:247], a[20:23], v[60:63]
    v_exp_f32 v32, v94
    v_exp_f32 v33, v95
    v_add_f32 v28, v28, v32
    v_cvt_pk_bf16_f32 v37, v32, v33
    v_add_f32 v28, v28, v33
    ds_write_b64 v1, v[36:37] offset:4608
    v_mfma_f32_16x16x32_bf16 v[64:67], a[244:247], a[52:55], v[64:67]
    s_waitcnt lgkmcnt(1)
    s_waitcnt lgkmcnt(0)
    s_waitcnt vmcnt(16)
    s_barrier
    v_mfma_f32_16x16x32_bf16 v[68:71], a[244:247], a[84:87], v[68:71]
    ds_read_b64 v[114:115], v2 offset:2560
    ds_read_b64 v[118:119], v2 offset:3072
    v_mfma_f32_16x16x32_bf16 v[72:75], a[244:247], a[116:119], v[72:75]
    ds_read_b64 v[122:123], v2 offset:3584
    ds_read_b64 v[126:127], v2 offset:4096
    v_mfma_f32_16x16x32_bf16 v[60:63], a[248:251], a[24:27], v[60:63]
    ds_read_b64 v[38:39], v2 offset:4608
    v_mfma_f32_16x16x32_bf16 v[64:67], a[248:251], a[56:59], v[64:67]
    ds_read_b64_tr_b16 a[224:225], v8 offset:49152
    ds_read_b64_tr_b16 a[226:227], v16 offset:49152
    v_mfma_f32_16x16x32_bf16 v[68:71], a[248:251], a[88:91], v[68:71]
    ds_read_b64_tr_b16 a[228:229], v9 offset:49152
    ds_read_b64_tr_b16 a[230:231], v17 offset:49152
    v_mfma_f32_16x16x32_bf16 v[72:75], a[248:251], a[120:123], v[72:75]
    ds_read_b64_tr_b16 a[232:233], v10 offset:49152
    ds_read_b64_tr_b16 a[234:235], v18 offset:49152
    v_mfma_f32_16x16x32_bf16 v[60:63], a[252:255], a[28:31], v[60:63]
    s_add_u32 m0, s29, 0
    s_waitcnt vmcnt(5)
    buffer_load_dwordx4 v0, s[12:15], s32 offen offset:0 nt lds
    v_mfma_f32_16x16x32_bf16 v[64:67], a[252:255], a[60:63], v[64:67]
    v_mfma_f32_16x16x32_bf16 v[68:71], a[252:255], a[92:95], v[68:71]
    v_mfma_f32_16x16x32_bf16 v[72:75], a[252:255], a[124:127], v[72:75]
    s_cbranch_vccnz L_rare28
L_back28:
    s_waitcnt lgkmcnt(4)
    v_mfma_f32_16x16x32_bf16 v[128:131], a[224:227], v[112:115], v[128:131]
    ds_read_b64_tr_b16 a[236:237], v11 offset:49152
    ds_read_b64_tr_b16 a[238:239], v19 offset:49152
    v_mfma_f32_16x16x32_bf16 v[160:163], a[224:227], v[116:119], v[160:163]
    v_mfma_f32_16x16x32_bf16 v[192:195], a[224:227], v[120:123], v[192:195]
    v_mfma_f32_16x16x32_bf16 v[224:227], a[224:227], v[124:127], v[224:227]
    v_mfma_f32_16x16x32_bf16 a[160:163], a[224:227], v[36:39], a[160:163]
    s_waitcnt lgkmcnt(4)
    v_mfma_f32_16x16x32_bf16 v[132:135], a[228:231], v[112:115], v[132:135]
    s_waitcnt vmcnt(6)
    buffer_load_dwordx4 v0, s[12:15], s32 offen offset:1024 nt lds
    v_mfma_f32_16x16x32_bf16 v[164:167], a[228:231], v[116:119], v[164:167]
    ds_read_b64_tr_b16 a[240:241], v12 offset:49152
    ds_read_b64_tr_b16 a[242:243], v20 offset:49152
    v_mfma_f32_16x16x32_bf16 v[196:199], a[228:231], v[120:123], v[196:199]
    v_exp_f32 v34, v60
    v_mfma_f32_16x16x32_bf16 v[228:231], a[228:231], v[124:127], v[228:231]
    v_exp_f32 v35, v61
    v_mfma_f32_16x16x32_bf16 a[164:167], a[228:231], v[36:39], a[164:167]
    s_waitcnt lgkmcnt(4)
    v_add_f32 v24, v24, v34
    v_cvt_pk_bf16_f32 v96, v34, v35
    v_mfma_f32_16x16x32_bf16 v[136:139], a[232:235], v[112:115], v[136:139]
    ds_read_b64_tr_b16 a[244:245], v13 offset:49152
    ds_read_b64_tr_b16 a[246:247], v21 offset:49152
    v_mfma_f32_16x16x32_bf16 v[168:171], a[232:235], v[116:119], v[168:171]
    v_add_f32 v24, v24, v35
    v_mfma_f32_16x16x32_bf16 v[200:203], a[232:235], v[120:123], v[200:203]
    v_exp_f32 v30, v62
    v_mfma_f32_16x16x32_bf16 v[232:235], a[232:235], v[124:127], v[232:235]
    v_exp_f32 v31, v63
    v_mfma_f32_16x16x32_bf16 a[168:171], a[232:235], v[36:39], a[168:171]
    s_waitcnt lgkmcnt(4)
    v_add_f32 v24, v24, v30
    v_cvt_pk_bf16_f32 v97, v30, v31
    v_mfma_f32_16x16x32_bf16 v[140:143], a[236:239], v[112:115], v[140:143]
    ds_read_b64_tr_b16 a[248:249], v14 offset:49152
    ds_read_b64_tr_b16 a[250:251], v22 offset:49152
    v_mfma_f32_16x16x32_bf16 v[172:175], a[236:239], v[116:119], v[172:175]
    s_waitcnt vmcnt(5)
    buffer_load_dwordx4 v0, s[12:15], s32 offen offset:2048 nt lds
    v_add_f32 v24, v24, v31
    v_mfma_f32_16x16x32_bf16 v[204:207], a[236:239], v[120:123], v[204:207]
    v_exp_f32 v32, v64
    v_mfma_f32_16x16x32_bf16 v[236:239], a[236:239], v[124:127], v[236:239]
    v_exp_f32 v33, v65
    v_mfma_f32_16x16x32_bf16 a[172:175], a[236:239], v[36:39], a[172:175]
    s_waitcnt lgkmcnt(4)
    v_add_f32 v25, v25, v32
    v_cvt_pk_bf16_f32 v100, v32, v33
    v_mfma_f32_16x16x32_bf16 v[144:147], a[240:243], v[112:115], v[144:147]
    ds_read_b64_tr_b16 a[252:253], v15 offset:49152
    ds_read_b64_tr_b16 a[254:255], v23 offset:49152
    v_mfma_f32_16x16x32_bf16 v[176:179], a[240:243], v[116:119], v[176:179]
    v_add_f32 v25, v25, v33
    v_mfma_f32_16x16x32_bf16 v[208:211], a[240:243], v[120:123], v[208:211]
    v_exp_f32 v34, v66
    v_mfma_f32_16x16x32_bf16 v[240:243], a[240:243], v[124:127], v[240:243]
    v_exp_f32 v35, v67
    v_mfma_f32_16x16x32_bf16 a[176:179], a[240:243], v[36:39], a[176:179]
    s_waitcnt lgkmcnt(4)
    v_add_f32 v25, v25, v34
    v_cvt_pk_bf16_f32 v101, v34, v35
    v_mfma_f32_16x16x32_bf16 v[148:151], a[244:247], v[112:115], v[148:151]
    ds_read_b128 a[224:227], v4 offset:16384
    v_add_f32 v25, v25, v35
    v_mfma_f32_16x16x32_bf16 v[180:183], a[244:247], v[116:119], v[180:183]
    ds_write2st64_b64 v1, v[96:97], v[100:101] offset0:0 offset1:1
    v_mfma_f32_16x16x32_bf16 v[212:215], a[244:247], v[120:123], v[212:215]
    s_waitcnt vmcnt(6)
    buffer_load_dwordx4 v0, s[12:15], s32 offen offset:3072 nt lds
    v_mfma_f32_16x16x32_bf16 v[244:247], a[244:247], v[124:127], v[244:247]
    v_mfma_f32_16x16x32_bf16 a[180:183], a[244:247], v[36:39], a[180:183]
    s_waitcnt lgkmcnt(4)
    v_mfma_f32_16x16x32_bf16 v[152:155], a[248:251], v[112:115], v[152:155]
    ds_read_b128 a[228:231], v5 offset:16384
    v_mfma_f32_16x16x32_bf16 v[184:187], a[248:251], v[116:119], v[184:187]
    v_mfma_f32_16x16x32_bf16 v[216:219], a[248:251], v[120:123], v[216:219]
    v_mfma_f32_16x16x32_bf16 v[248:251], a[248:251], v[124:127], v[248:251]
    v_mfma_f32_16x16x32_bf16 a[184:187], a[248:251], v[36:39], a[184:187]
    s_waitcnt lgkmcnt(3)
    v_mfma_f32_16x16x32_bf16 v[156:159], a[252:255], v[112:115], v[156:159]
    ds_read_b128 a[232:235], v6 offset:16384
    v_mfma_f32_16x16x32_bf16 v[188:191], a[252:255], v[116:119], v[188:191]
    v_mfma_f32_16x16x32_bf16 v[220:223], a[252:255], v[120:123], v[220:223]
    v_mfma_f32_16x16x32_bf16 v[252:255], a[252:255], v[124:127], v[252:255]
    s_add_u32 s32, s32, 16384
    v_mfma_f32_16x16x32_bf16 a[188:191], a[252:255], v[36:39], a[188:191]
    s_cbranch_vccnz L_rare29
L_back29:
    s_waitcnt lgkmcnt(2)
    s_add_u32 s35, s35, 1
    s_cmp_lt_u32 s35, 6
    s_cbranch_scc1 L_loop1
    v_mfma_f32_16x16x32_bf16 v[76:79], a[224:227], a[0:3], v[40:43]
    ds_read_b128 a[236:239], v7 offset:16384
    v_mfma_f32_16x16x32_bf16 v[80:83], a[224:227], a[32:35], v[44:47]
    s_add_u32 m0, s29, 98304
    s_waitcnt vmcnt(5)
    buffer_load_dwordx4 v0, s[16:19], s33 offen offset:0 nt lds
    v_mfma_f32_16x16x32_bf16 v[84:87], a[224:227], a[64:67], v[48:51]
    v_exp_f32 v30, v68
    v_mfma_f32_16x16x32_bf16 v[88:91], a[224:227], a[96:99], v[52:55]
    s_waitcnt lgkmcnt(2)
    v_exp_f32 v31, v69
    v_mfma_f32_16x16x32_bf16 v[76:79], a[228:231], a[4:7], v[76:79]
    ds_read_b128 a[240:243], v4 offset:16640
    v_add_f32 v26, v26, v30
    v_mfma_f32_16x16x32_bf16 v[80:83], a[228:231], a[36:39], v[80:83]
    s_waitcnt vmcnt(6)
    buffer_load_dwordx4 v0, s[16:19], s33 offen offset:1024 nt lds
    v_cvt_pk_bf16_f32 v104, v30, v31
    v_mfma_f32_16x16x32_bf16 v[84:87], a[228:231], a[68:71], v[84:87]
    v_add_f32 v26, v26, v31
    v_mfma_f32_16x16x32_bf16 v[88:91], a[228:231], a[100:103], v[88:91]
    s_waitcnt lgkmcnt(2)
    v_exp_f32 v32, v70
    v_mfma_f32_16x16x32_bf16 v[76:79], a[232:235], a[8:11], v[76:79]
    ds_read_b128 a[244:247], v5 offset:16640
    v_mfma_f32_16x16x32_bf16 v[80:83], a[232:235], a[40:43], v[80:83]
    s_waitcnt vmcnt(5)
    buffer_load_dwordx4 v0, s[16:19], s33 offen offset:2048 nt lds
    v_mfma_f32_16x16x32_bf16 v[84:87], a[232:235], a[72:75], v[84:87]
    v_exp_f32 v33, v71
    v_mfma_f32_16x16x32_bf16 v[88:91], a[232:235], a[104:107], v[88:91]
    s_waitcnt lgkmcnt(2)
    v_add_f32 v26, v26, v32
    v_cvt_pk_bf16_f32 v105, v32, v33
    v_mfma_f32_16x16x32_bf16 v[76:79], a[236:239], a[12:15], v[76:79]
    ds_read_b128 a[248:251], v6 offset:16640
    v_add_f32 v26, v26, v33
    v_mfma_f32_16x16x32_bf16 v[80:83], a[236:239], a[44:47], v[80:83]
    s_waitcnt vmcnt(6)
    buffer_load_dwordx4 v0, s[16:19], s33 offen offset:3072 nt lds
    v_mfma_f32_16x16x32_bf16 v[84:87], a[236:239], a[76:79], v[84:87]
    v_exp_f32 v34, v72
    v_mfma_f32_16x16x32_bf16 v[88:91], a[236:239], a[108:111], v[88:91]
    s_waitcnt lgkmcnt(2)
    v_exp_f32 v35, v73
    v_mfma_f32_16x16x32_bf16 v[76:79], a[240:243], a[16:19], v[76:79]
    ds_read_b128 a[252:255], v7 offset:16640
    v_add_f32 v27, v27, v34
    v_mfma_f32_16x16x32_bf16 v[80:83], a[240:243], a[48:51], v[80:83]
    s_add_u32 s33, s33, 16384
    v_cvt_pk_bf16_f32 v108, v34, v35
    v_add_f32 v27, v27, v35
    v_mfma_f32_16x16x32_bf16 v[84:87], a[240:243], a[80:83], v[84:87]
    v_exp_f32 v30, v74
    v_mfma_f32_16x16x32_bf16 v[88:91], a[240:243], a[112:115], v[88:91]
    s_waitcnt lgkmcnt(2)
    v_exp_f32 v31, v75
    v_mfma_f32_16x16x32_bf16 v[76:79], a[244:247], a[20:23], v[76:79]
    v_add_f32 v27, v27, v30
    v_cvt_pk_bf16_f32 v109, v30, v31
    v_add_f32 v27, v27, v31
    ds_write2st64_b64 v1, v[104:105], v[108:109] offset0:2 offset1:3
    v_mfma_f32_16x16x32_bf16 v[80:83], a[244:247], a[52:55], v[80:83]
    s_waitcnt lgkmcnt(1)
    s_waitcnt lgkmcnt(0)
    s_waitcnt vmcnt(16)
    s_barrier
    v_mfma_f32_16x16x32_bf16 v[84:87], a[244:247], a[84:87], v[84:87]
    ds_read_b64 v[98:99], v2 offset:0
    ds_read_b64 v[102:103], v2 offset:512
    v_mfma_f32_16x16x32_bf16 v[88:91], a[244:247], a[116:119], v[88:91]
    ds_read_b64 v[106:107], v2 offset:1024
    ds_read_b64 v[110:111], v2 offset:1536
    v_mfma_f32_16x16x32_bf16 v[76:79], a[248:251], a[24:27], v[76:79]
    ds_read_b64_tr_b16 a[224:225], v8 offset:0
    ds_read_b64_tr_b16 a[226:227], v16 offset:0
    v_mfma_f32_16x16x32_bf16 v[80:83], a[248:251], a[56:59], v[80:83]
    ds_read_b64_tr_b16 a[228:229], v9 offset:0
    ds_read_b64_tr_b16 a[230:231], v17 offset:0
    v_mfma_f32_16x16x32_bf16 v[84:87], a[248:251], a[88:91], v[84:87]
    s_add_u32 m0, s29, 16384
    s_waitcnt vmcnt(5)
    buffer_load_dwordx4 v0, s[12:15], s32 offen offset:0 nt lds
    v_mfma_f32_16x16x32_bf16 v[88:91], a[248:251], a[120:123], v[88:91]
    ds_read_b64_tr_b16 a[232:233], v10 offset:0
    ds_read_b64_tr_b16 a[234:235], v18 offset:0
    v_mfma_f32_16x16x32_bf16 v[76:79], a[252:255], a[28:31], v[76:79]
    v_mfma_f32_16x16x32_bf16 v[80:83], a[252:255], a[60:63], v[80:83]
    v_mfma_f32_16x16x32_bf16 v[84:87], a[252:255], a[92:95], v[84:87]
    v_mfma_f32_16x16x32_bf16 v[88:91], a[252:255], a[124:127], v[88:91]
    s_cbranch_vccnz L_rare30
L_back30:
    s_waitcnt lgkmcnt(4)
    v_mfma_f32_16x16x32_bf16 v[128:131], a[224:227], v[96:99], v[128:131]
    ds_read_b64_tr_b16 a[236:237], v11 offset:0
    ds_read_b64_tr_b16 a[238:239], v19 offset:0
    v_mfma_f32_16x16x32_bf16 v[160:163], a[224:227], v[100:103], v[160:163]
    v_mfma_f32_16x16x32_bf16 v[192:195], a[224:227], v[104:107], v[192:195]
    v_mfma_f32_16x16x32_bf16 v[224:227], a[224:227], v[108:111], v[224:227]
    s_waitcnt lgkmcnt(4)
    s_waitcnt vmcnt(6)
    buffer_load_dwordx4 v0, s[12:15], s32 offen offset:1024 nt lds
    v_mfma_f32_16x16x32_bf16 v[132:135], a[228:231], v[96:99], v[132:135]
    ds_read_b64_tr_b16 a[240:241], v12 offset:0
    ds_read_b64_tr_b16 a[242:243], v20 offset:0
    v_mfma_f32_16x16x32_bf16 v[164:167], a[228:231], v[100:103], v[164:167]
    v_exp_f32 v32, v76
    v_mfma_f32_16x16x32_bf16 v[196:199], a[228:231], v[104:107], v[196:199]
    v_exp_f32 v33, v77
    v_mfma_f32_16x16x32_bf16 v[228:231], a[228:231], v[108:111], v[228:231]
    s_waitcnt lgkmcnt(4)
    v_add_f32 v24, v24, v32
    v_cvt_pk_bf16_f32 v112, v32, v33
    v_mfma_f32_16x16x32_bf16 v[136:139], a[232:235], v[96:99], v[136:139]
    ds_read_b64_tr_b16 a[244:245], v13 offset:0
    ds_read_b64_tr_b16 a[246:247], v21 offset:0
    v_mfma_f32_16x16x32_bf16 v[168:171], a[232:235], v[100:103], v[168:171]
    v_add_f32 v24, v24, v33
    v_mfma_f32_16x16x32_bf16 v[200:203], a[232:235], v[104:107], v[200:203]
    v_exp_f32 v34, v78
    v_mfma_f32_16x16x32_bf16 v[232:235], a[232:235], v[108:111], v[232:235]
    s_waitcnt lgkmcnt(4)
    v_exp_f32 v35, v79
    v_mfma_f32_16x16x32_bf16 v[140:143], a[236:239], v[96:99], v[140:143]
    s_waitcnt vmcnt(5)
    buffer_load_dwordx4 v0, s[12:15], s32 offen offset:2048 nt lds
    v_add_f32 v24, v24, v34
    v_mfma_f32_16x16x32_bf16 v[172:175], a[236:239], v[100:103], v[172:175]
    ds_read_b64_tr_b16 a[248:249], v14 offset:0
    ds_read_b64_tr_b16 a[250:251], v22 offset:0
    v_mfma_f32_16x16x32_bf16 v[204:207], a[236:239], v[104:107], v[204:207]
    v_cvt_pk_bf16_f32 v113, v34, v35
    v_add_f32 v24, v24, v35
    v_mfma_f32_16x16x32_bf16 v[236:239], a[236:239], v[108:111], v[236:239]
    s_waitcnt lgkmcnt(4)
    v_exp_f32 v30, v80
    v_mfma_f32_16x16x32_bf16 v[144:147], a[240:243], v[96:99], v[144:147]
    ds_read_b64_tr_b16 a[252:253], v15 offset:0
    ds_read_b64_tr_b16 a[254:255], v23 offset:0
    v_mfma_f32_16x16x32_bf16 v[176:179], a[240:243], v[100:103], v[176:179]
    v_exp_f32 v31, v81
    v_mfma_f32_16x16x32_bf16 v[208:211], a[240:243], v[104:107], v[208:211]
    v_add_f32 v25, v25, v30
    v_cvt_pk_bf16_f32 v116, v30, v31
    v_mfma_f32_16x16x32_bf16 v[240:243], a[240:243], v[108:111], v[240:243]
    s_waitcnt lgkmcnt(4)
    v_add_f32 v25, v25, v31
    v_mfma_f32_16x16x32_bf16 v[148:151], a[244:247], v[96:99], v[148:151]
    ds_read_b128 a[224:227], v4 offset:32768
    v_mfma_f32_16x16x32_bf16 v[180:183], a[244:247], v[100:103], v[180:183]
    s_waitcnt vmcnt(6)
    buffer_load_dwordx4 v0, s[12:15], s32 offen offset:3072 nt lds
    v_mfma_f32_16x16x32_bf16 v[212:215], a[244:247], v[104:107], v[212:215]
    v_exp_f32 v32, v82
    v_mfma_f32_16x16x32_bf16 v[244:247], a[244:247], v[108:111], v[244:247]
    s_waitcnt lgkmcnt(3)
    v_exp_f32 v33, v83
    v_mfma_f32_16x16x32_bf16 v[152:155], a[248:251], v[96:99], v[152:155]
    ds_read_b128 a[228:231], v5 offset:32768
    v_add_f32 v25, v25, v32
    v_mfma_f32_16x16x32_bf16 v[184:187], a[248:251], v[100:103], v[184:187]
    v_cvt_pk_bf16_f32 v117, v32, v33
    v_add_f32 v25, v25, v33
    v_mfma_f32_16x16x32_bf16 v[216:219], a[248:251], v[104:107], v[216:219]
    ds_write2st64_b64 v1, v[112:113], v[116:117] offset0:5 offset1:6
    v_mfma_f32_16x16x32_bf16 v[248:251], a[248:251], v[108:111], v[248:251]
    s_waitcnt lgkmcnt(3)
    v_mfma_f32_16x16x32_bf16 v[156:159], a[252:255], v[96:99], v[156:159]
    ds_read_b128 a[232:235], v6 offset:32768
    v_mfma_f32_16x16x32_bf16 v[188:191], a[252:255], v[100:103], v[188:191]
    v_mfma_f32_16x16x32_bf16 v[220:223], a[252:255], v[104:107], v[220:223]
    s_add_u32 s32, s32, 16384
    v_mfma_f32_16x16x32_bf16 v[252:255], a[252:255], v[108:111], v[252:255]
    s_cbranch_vccnz L_rare31
L_back31:
    s_waitcnt lgkmcnt(3)
    v_mfma_f32_16x16x32_bf16 v[60:63], a[224:227], a[0:3], v[40:43]
    ds_read_b128 a[236:239], v7 offset:32768
    v_mfma_f32_16x16x32_bf16 v[64:67], a[224:227], a[32:35], v[44:47]
    s_add_u32 m0, s29, 114688
    s_waitcnt vmcnt(5)
    buffer_load_dwordx4 v0, s[16:19], s33 offen offset:0 nt lds
    v_mfma_f32_16x16x32_bf16 v[68:71], a[224:227], a[64:67], v[48:51]
    v_exp_f32 v34, v84
    v_mfma_f32_16x16x32_bf16 v[72:75], a[224:227], a[96:99], v[52:55]
    v_exp_f32 v35, v85
    v_mfma_f32_16x16x32_bf16 v[92:95], a[224:227], a[128:131], v[56:59]
    s_waitcnt lgkmcnt(3)
    v_add_f32 v26, v26, v34
    v_cvt_pk_bf16_f32 v120, v34, v35
    v_mfma_f32_16x16x32_bf16 v[60:63], a[228:231], a[4:7], v[60:63]
    ds_read_b128 a[240:243], v4 offset:33024
    v_add_f32 v26, v26, v35
    v_mfma_f32_16x16x32_bf16 v[64:67], a[228:231], a[36:39], v[64:67]
    v_exp_f32 v30, v86
    v_mfma_f32_16x16x32_bf16 v[68:71], a[228:231], a[68:71], v[68:71]
    s_waitcnt vmcnt(6)
    buffer_load_dwordx4 v0, s[16:19], s33 offen offset:1024 nt lds
    v_mfma_f32_16x16x32_bf16 v[72:75], a[228:231], a[100:103], v[72:75]
    v_exp_f32 v31, v87
    v_mfma_f32_16x16x32_bf16 v[92:95], a[228:231], a[132:135], v[92:95]
    s_waitcnt lgkmcnt(2)
    v_add_f32 v26, v26, v30
    v_cvt_pk_bf16_f32 v121, v30, v31
    v_mfma_f32_16x16x32_bf16 v[60:63], a[232:235], a[8:11], v[60:63]
    ds_read_b128 a[244:247], v5 offset:33024
    v_add_f32 v26, v26, v31
    v_mfma_f32_16x16x32_bf16 v[64:67], a[232:235], a[40:43], v[64:67]
    v_exp_f32 v32, v88
    v_mfma_f32_16x16x32_bf16 v[68:71], a[232:235], a[72:75], v[68:71]
    v_exp_f32 v33, v89
    v_mfma_f32_16x16x32_bf16 v[72:75], a[232:235], a[104:107], v[72:75]
    s_waitcnt vmcnt(5)
    buffer_load_dwordx4 v0, s[16:19], s33 offen offset:2048 nt lds
    v_add_f32 v27, v27, v32
    v_mfma_f32_16x16x32_bf16 v[92:95], a[232:235], a[136:139], v[92:95]
    s_waitcnt lgkmcnt(2)
    v_cvt_pk_bf16_f32 v124, v32, v33
    v_add_f32 v27, v27, v33
    v_mfma_f32_16x16x32_bf16 v[60:63], a[236:239], a[12:15], v[60:63]
    ds_read_b128 a[248:251], v6 offset:33024
    v_mfma_f32_16x16x32_bf16 v[64:67], a[236:239], a[44:47], v[64:67]
    v_exp_f32 v34, v90
    v_mfma_f32_16x16x32_bf16 v[68:71], a[236:239], a[76:79], v[68:71]
    v_exp_f32 v35, v91
    v_mfma_f32_16x16x32_bf16 v[72:75], a[236:239], a[108:111], v[72:75]
    v_add_f32 v27, v27, v34
    v_cvt_pk_bf16_f32 v125, v34, v35
    v_mfma_f32_16x16x32_bf16 v[92:95], a[236:239], a[140:143], v[92:95]
    s_waitcnt lgkmcnt(2)
    s_waitcnt vmcnt(6)
    buffer_load_dwordx4 v0, s[16:19], s33 offen offset:3072 nt lds
    v_mfma_f32_16x16x32_bf16 v[60:63], a[240:243], a[16:19], v[60:63]
    ds_read_b128 a[252:255], v7 offset:33024
    v_add_f32 v27, v27, v35
    v_mfma_f32_16x16x32_bf16 v[64:67], a[240:243], a[48:51], v[64:67]
    ds_write2st64_b64 v1, v[120:121], v[124:125] offset0:7 offset1:8
    v_mfma_f32_16x16x32_bf16 v[68:71], a[240:243], a[80:83], v[68:71]
    v_mfma_f32_16x16x32_bf16 v[72:75], a[240:243], a[112:115], v[72:75]
    v_mfma_f32_16x16x32_bf16 v[92:95], a[240:243], a[144:147], v[92:95]
    s_waitcnt lgkmcnt(3)
    v_mfma_f32_16x16x32_bf16 v[60:63], a[244:247], a[20:23], v[60:63]
    s_add_u32 s33, s33, 16384
    v_mfma_f32_16x16x32_bf16 v[64:67], a[244:247], a[52:55], v[64:67]
    v_mfma_f32_16x16x32_bf16 v[68:71], a[244:247], a[84:87], v[68:71]
    v_mfma_f32_16x16x32_bf16 v[72:75], a[244:247], a[116:119], v[72:75]
    v_mfma_f32_16x16x32_bf16 v[92:95], a[244:247], a[148:151], v[92:95]
    s_waitcnt lgkmcnt(1)
    s_waitcnt lgkmcnt(0)
    s_waitcnt vmcnt(16)
    s_barrier
    v_mfma_f32_16x16x32_bf16 v[60:63], a[248:251], a[24:27], v[60:63]
    ds_read_b64 v[114:115], v2 offset:2560
    ds_read_b64 v[118:119], v2 offset:3072
    v_mfma_f32_16x16x32_bf16 v[64:67], a[248:251], a[56:59], v[64:67]
    ds_read_b64 v[122:123], v2 offset:3584
    ds_read_b64 v[126:127], v2 offset:4096
    v_mfma_f32_16x16x32_bf16 v[68:71], a[248:251], a[88:91], v[68:71]
    ds_read_b64_tr_b16 a[224:225], v8 offset:16384
    ds_read_b64_tr_b16 a[226:227], v16 offset:16384
    v_mfma_f32_16x16x32_bf16 v[72:75], a[248:251], a[120:123], v[72:75]
    ds_read_b64_tr_b16 a[228:229], v9 offset:16384
    ds_read_b64_tr_b16 a[230:231], v17 offset:16384
    v_mfma_f32_16x16x32_bf16 v[92:95], a[248:251], a[152:155], v[92:95]
    s_add_u32 m0, s29, 32768
    s_waitcnt vmcnt(5)
    buffer_load_dwordx4 v0, s[12:15], s32 offen offset:0 nt lds
    v_mfma_f32_16x16x32_bf16 v[60:63], a[252:255], a[28:31], v[60:63]
    ds_read_b64_tr_b16 a[232:233], v10 offset:16384
    ds_read_b64_tr_b16 a[234:235], v18 offset:16384
    v_mfma_f32_16x16x32_bf16 v[64:67], a[252:255], a[60:63], v[64:67]
    v_mfma_f32_16x16x32_bf16 v[68:71], a[252:255], a[92:95], v[68:71]
    v_mfma_f32_16x16x32_bf16 v[72:75], a[252:255], a[124:127], v[72:75]
    v_mfma_f32_16x16x32_bf16 v[92:95], a[252:255], a[156:159], v[92:95]
    s_cbranch_vccnz L_rare32
L_back32:
    s_waitcnt lgkmcnt(4)
    v_mfma_f32_16x16x32_bf16 v[128:131], a[224:227], v[112:115], v[128:131]
    ds_read_b64_tr_b16 a[236:237], v11 offset:16384
    ds_read_b64_tr_b16 a[238:239], v19 offset:16384
    v_mfma_f32_16x16x32_bf16 v[160:163], a[224:227], v[116:119], v[160:163]
    v_mfma_f32_16x16x32_bf16 v[192:195], a[224:227], v[120:123], v[192:195]
    v_mfma_f32_16x16x32_bf16 v[224:227], a[224:227], v[124:127], v[224:227]
    s_waitcnt lgkmcnt(4)
    s_waitcnt vmcnt(6)
    buffer_load_dwordx4 v0, s[12:15], s32 offen offset:1024 nt lds
    v_mfma_f32_16x16x32_bf16 v[132:135], a[228:231], v[112:115], v[132:135]
    ds_read_b64_tr_b16 a[240:241], v12 offset:16384
    ds_read_b64_tr_b16 a[242:243], v20 offset:16384
    v_mfma_f32_16x16x32_bf16 v[164:167], a[228:231], v[116:119], v[164:167]
    v_exp_f32 v30, v92
    v_mfma_f32_16x16x32_bf16 v[196:199], a[228:231], v[120:123], v[196:199]
    v_exp_f32 v31, v93
    v_mfma_f32_16x16x32_bf16 v[228:231], a[228:231], v[124:127], v[228:231]
    s_waitcnt lgkmcnt(4)
    v_add_f32 v28, v28, v30
    v_cvt_pk_bf16_f32 v36, v30, v31
    v_mfma_f32_16x16x32_bf16 v[136:139], a[232:235], v[112:115], v[136:139]
    ds_read_b64_tr_b16 a[244:245], v13 offset:16384
    ds_read_b64_tr_b16 a[246:247], v21 offset:16384
    v_mfma_f32_16x16x32_bf16 v[168:171], a[232:235], v[116:119], v[168:171]
    v_add_f32 v28, v28, v31
    v_mfma_f32_16x16x32_bf16 v[200:203], a[232:235], v[120:123], v[200:203]
    v_exp_f32 v32, v94
    v_mfma_f32_16x16x32_bf16 v[232:235], a[232:235], v[124:127], v[232:235]
    s_waitcnt lgkmcnt(4)
    v_exp_f32 v33, v95
    v_mfma_f32_16x16x32_bf16 v[140:143], a[236:239], v[112:115], v[140:143]
    s_waitcnt vmcnt(5)
    buffer_load_dwordx4 v0, s[12:15], s32 offen offset:2048 nt lds
    v_add_f32 v28, v28, v32
    v_mfma_f32_16x16x32_bf16 v[172:175], a[236:239], v[116:119], v[172:175]
    ds_read_b64_tr_b16 a[248:249], v14 offset:16384
    ds_read_b64_tr_b16 a[250:251], v22 offset:16384
    v_mfma_f32_16x16x32_bf16 v[204:207], a[236:239], v[120:123], v[204:207]
    v_cvt_pk_bf16_f32 v37, v32, v33
    v_add_f32 v28, v28, v33
    v_mfma_f32_16x16x32_bf16 v[236:239], a[236:239], v[124:127], v[236:239]
    s_waitcnt lgkmcnt(4)
    ds_write_b64 v1, v[36:37] offset:2048
    v_mfma_f32_16x16x32_bf16 v[144:147], a[240:243], v[112:115], v[144:147]
    ds_read_b64_tr_b16 a[252:253], v15 offset:16384
    ds_read_b64_tr_b16 a[254:255], v23 offset:16384
    v_mfma_f32_16x16x32_bf16 v[176:179], a[240:243], v[116:119], v[176:179]
    v_exp_f32 v34, v60
    v_mfma_f32_16x16x32_bf16 v[208:211], a[240:243], v[120:123], v[208:211]
    v_exp_f32 v35, v61
    v_mfma_f32_16x16x32_bf16 v[240:243], a[240:243], v[124:127], v[240:243]
    s_waitcnt lgkmcnt(5)
    v_add_f32 v24, v24, v34
    v_cvt_pk_bf16_f32 v96, v34, v35
    v_mfma_f32_16x16x32_bf16 v[148:151], a[244:247], v[112:115], v[148:151]
    ds_read_b128 a[224:227], v4 offset:49152
    v_add_f32 v24, v24, v35
    v_mfma_f32_16x16x32_bf16 v[180:183], a[244:247], v[116:119], v[180:183]
    s_waitcnt vmcnt(6)
    buffer_load_dwordx4 v0, s[12:15], s32 offen offset:3072 nt lds
    v_mfma_f32_16x16x32_bf16 v[212:215], a[244:247], v[120:123], v[212:215]
    v_exp_f32 v30, v62
    v_mfma_f32_16x16x32_bf16 v[244:247], a[244:247], v[124:127], v[244:247]
    s_waitcnt lgkmcnt(4)
    v_exp_f32 v31, v63
    v_mfma_f32_16x16x32_bf16 v[152:155], a[248:251], v[112:115], v[152:155]
    ds_read_b128 a[228:231], v5 offset:49152
    v_add_f32 v24, v24, v30
    v_mfma_f32_16x16x32_bf16 v[184:187], a[248:251], v[116:119], v[184:187]
    v_cvt_pk_bf16_f32 v97, v30, v31
    v_add_f32 v24, v24, v31
    v_mfma_f32_16x16x32_bf16 v[216:219], a[248:251], v[120:123], v[216:219]
    v_mfma_f32_16x16x32_bf16 v[248:251], a[248:251], v[124:127], v[248:251]
    s_waitcnt lgkmcnt(2)
    v_mfma_f32_16x16x32_bf16 v[156:159], a[252:255], v[112:115], v[156:159]
    ds_read_b128 a[232:235], v6 offset:49152
    v_mfma_f32_16x16x32_bf16 v[188:191], a[252:255], v[116:119], v[188:191]
    v_mfma_f32_16x16x32_bf16 v[220:223], a[252:255], v[120:123], v[220:223]
    s_add_u32 s32, s32, 16384
    v_mfma_f32_16x16x32_bf16 v[252:255], a[252:255], v[124:127], v[252:255]
    s_cbranch_vccnz L_rare33
L_back33:
    s_waitcnt lgkmcnt(2)
    v_mfma_f32_16x16x32_bf16 v[76:79], a[224:227], a[0:3], v[40:43]
    ds_read_b128 a[236:239], v7 offset:49152
    v_mfma_f32_16x16x32_bf16 v[80:83], a[224:227], a[32:35], v[44:47]
    s_add_u32 m0, s29, 65536
    s_waitcnt vmcnt(5)
    buffer_load_dwordx4 v0, s[16:19], s33 offen offset:0 nt lds
    v_mfma_f32_16x16x32_bf16 v[84:87], a[224:227], a[64:67], v[48:51]
    v_exp_f32 v32, v64
    v_mfma_f32_16x16x32_bf16 v[88:91], a[224:227], a[96:99], v[52:55]
    v_exp_f32 v33, v65
    v_mfma_f32_16x16x32_bf16 v[92:95], a[224:227], a[128:131], v[56:59]
    s_waitcnt lgkmcnt(2)
    v_add_f32 v25, v25, v32
    v_cvt_pk_bf16_f32 v100, v32, v33
    v_mfma_f32_16x16x32_bf16 v[76:79], a[228:231], a[4:7], v[76:79]
    ds_read_b128 a[240:243], v4 offset:49408
    v_add_f32 v25, v25, v33
    v_mfma_f32_16x16x32_bf16 v[80:83], a[228:231], a[36:39], v[80:83]
    v_exp_f32 v34, v66
    v_mfma_f32_16x16x32_bf16 v[84:87], a[228:231], a[68:71], v[84:87]
    s_waitcnt vmcnt(6)
    buffer_load_dwordx4 v0, s[16:19], s33 offen offset:1024 nt lds
    v_mfma_f32_16x16x32_bf16 v[88:91], a[228:231], a[100:103], v[88:91]
    v_exp_f32 v35, v67
    v_mfma_f32_16x16x32_bf16 v[92:95], a[228:231], a[132:135], v[92:95]
    s_waitcnt lgkmcnt(2)
    v_add_f32 v25, v25, v34
    v_cvt_pk_bf16_f32 v101, v34, v35
    v_mfma_f32_16x16x32_bf16 v[76:79], a[232:235], a[8:11], v[76:79]
    ds_read_b128 a[244:247], v5 offset:49408
    v_add_f32 v25, v25, v35
    v_mfma_f32_16x16x32_bf16 v[80:83], a[232:235], a[40:43], v[80:83]
    ds_write2st64_b64 v1, v[96:97], v[100:101] offset0:0 offset1:1
    v_mfma_f32_16x16x32_bf16 v[84:87], a[232:235], a[72:75], v[84:87]
    v_exp_f32 v30, v68
    v_mfma_f32_16x16x32_bf16 v[88:91], a[232:235], a[104:107], v[88:91]
    s_waitcnt vmcnt(5)
    buffer_load_dwordx4 v0, s[16:19], s33 offen offset:2048 nt lds
    v_mfma_f32_16x16x32_bf16 v[92:95], a[232:235], a[136:139], v[92:95]
    s_waitcnt lgkmcnt(3)
    v_exp_f32 v31, v69
    v_mfma_f32_16x16x32_bf16 v[76:79], a[236:239], a[12:15], v[76:79]
    ds_read_b128 a[248:251], v6 offset:49408
    v_add_f32 v26, v26, v30
    v_mfma_f32_16x16x32_bf16 v[80:83], a[236:239], a[44:47], v[80:83]
    v_cvt_pk_bf16_f32 v104, v30, v31
    v_add_f32 v26, v26, v31
    v_mfma_f32_16x16x32_bf16 v[84:87], a[236:239], a[76:79], v[84:87]
    v_exp_f32 v32, v70
    v_mfma_f32_16x16x32_bf16 v[88:91], a[236:239], a[108:111], v[88:91]
    v_exp_f32 v33, v71
    v_mfma_f32_16x16x32_bf16 v[92:95], a[236:239], a[140:143], v[92:95]
    s_waitcnt lgkmcnt(3)
    s_waitcnt vmcnt(6)
    buffer_load_dwordx4 v0, s[16:19], s33 offen offset:3072 nt lds
    v_mfma_f32_16x16x32_bf16 v[76:79], a[240:243], a[16:19], v[76:79]
    ds_read_b128 a[252:255], v7 offset:49408
    v_add_f32 v26, v26, v32
    v_mfma_f32_16x16x32_bf16 v[80:83], a[240:243], a[48:51], v[80:83]
    v_cvt_pk_bf16_f32 v105, v32, v33
    v_add_f32 v26, v26, v33
    v_mfma_f32_16x16x32_bf16 v[84:87], a[240:243], a[80:83], v[84:87]
    v_exp_f32 v34, v72
    v_mfma_f32_16x16x32_bf16 v[88:91], a[240:243], a[112:115], v[88:91]
    v_exp_f32 v35, v73
    v_mfma_f32_16x16x32_bf16 v[92:95], a[240:243], a[144:147], v[92:95]
    s_waitcnt lgkmcnt(3)
    v_add_f32 v27, v27, v34
    v_cvt_pk_bf16_f32 v108, v34, v35
    v_mfma_f32_16x16x32_bf16 v[76:79], a[244:247], a[20:23], v[76:79]
    s_add_u32 s33, s33, 16384
    v_add_f32 v27, v27, v35
    v_mfma_f32_16x16x32_bf16 v[80:83], a[244:247], a[52:55], v[80:83]
    v_exp_f32 v30, v74
    v_mfma_f32_16x16x32_bf16 v[84:87], a[244:247], a[84:87], v[84:87]
    v_exp_f32 v31, v75
    v_mfma_f32_16x16x32_bf16 v[88:91], a[244:247], a[116:119], v[88:91]
    v_add_f32 v27, v27, v30
    v_cvt_pk_bf16_f32 v109, v30, v31
    v_add_f32 v27, v27, v31
    ds_write2st64_b64 v1, v[104:105], v[108:109] offset0:2 offset1:3
    v_mfma_f32_16x16x32_bf16 v[92:95], a[244:247], a[148:151], v[92:95]
    s_waitcnt lgkmcnt(1)
    s_waitcnt lgkmcnt(0)
    s_barrier
    v_mfma_f32_16x16x32_bf16 v[76:79], a[248:251], a[24:27], v[76:79]
    ds_read_b64 v[98:99], v2 offset:0
    ds_read_b64 v[102:103], v2 offset:512
    v_mfma_f32_16x16x32_bf16 v[80:83], a[248:251], a[56:59], v[80:83]
    ds_read_b64 v[106:107], v2 offset:1024
    ds_read_b64 v[110:111], v2 offset:1536
    v_mfma_f32_16x16x32_bf16 v[84:87], a[248:251], a[88:91], v[84:87]
    ds_read_b64 v[38:39], v2 offset:2048
    v_mfma_f32_16x16x32_bf16 v[88:91], a[248:251], a[120:123], v[88:91]
    ds_read_b64_tr_b16 a[224:225], v8 offset:32768
    ds_read_b64_tr_b16 a[226:227], v16 offset:32768
    v_mfma_f32_16x16x32_bf16 v[92:95], a[248:251], a[152:155], v[92:95]
    ds_read_b64_tr_b16 a[228:229], v9 offset:32768
    ds_read_b64_tr_b16 a[230:231], v17 offset:32768
    v_mfma_f32_16x16x32_bf16 v[76:79], a[252:255], a[28:31], v[76:79]
    ds_read_b64_tr_b16 a[232:233], v10 offset:32768
    ds_read_b64_tr_b16 a[234:235], v18 offset:32768
    v_mfma_f32_16x16x32_bf16 v[80:83], a[252:255], a[60:63], v[80:83]
    s_add_u32 m0, s29, 49152
    s_waitcnt vmcnt(5)
    buffer_load_dwordx4 v0, s[12:15], s32 offen offset:0 nt lds
    v_mfma_f32_16x16x32_bf16 v[84:87], a[252:255], a[92:95], v[84:87]
    v_mfma_f32_16x16x32_bf16 v[88:91], a[252:255], a[124:127], v[88:91]
    v_mfma_f32_16x16x32_bf16 v[92:95], a[252:255], a[156:159], v[92:95]
    s_cbranch_vccnz L_rare34
L_back34:
    s_waitcnt lgkmcnt(4)
    v_mfma_f32_16x16x32_bf16 v[128:131], a[224:227], v[96:99], v[128:131]
    ds_read_b64_tr_b16 a[236:237], v11 offset:32768
    ds_read_b64_tr_b16 a[238:239], v19 offset:32768
    v_mfma_f32_16x16x32_bf16 v[160:163], a[224:227], v[100:103], v[160:163]
    v_mfma_f32_16x16x32_bf16 v[192:195], a[224:227], v[104:107], v[192:195]
    v_mfma_f32_16x16x32_bf16 v[224:227], a[224:227], v[108:111], v[224:227]
    v_mfma_f32_16x16x32_bf16 a[160:163], a[224:227], v[36:39], a[160:163]
    s_waitcnt lgkmcnt(4)
    v_mfma_f32_16x16x32_bf16 v[132:135], a[228:231], v[96:99], v[132:135]
    s_waitcnt vmcnt(6)
    buffer_load_dwordx4 v0, s[12:15], s32 offen offset:1024 nt lds
    v_mfma_f32_16x16x32_bf16 v[164:167], a[228:231], v[100:103], v[164:167]
    ds_read_b64_tr_b16 a[240:241], v12 offset:32768
    ds_read_b64_tr_b16 a[242:243], v20 offset:32768
    v_mfma_f32_16x16x32_bf16 v[196:199], a[228:231], v[104:107], v[196:199]
    v_exp_f32 v32, v76
    v_mfma_f32_16x16x32_bf16 v[228:231], a[228:231], v[108:111], v[228:231]
    v_exp_f32 v33, v77
    v_mfma_f32_16x16x32_bf16 a[164:167], a[228:231], v[36:39], a[164:167]
    s_waitcnt lgkmcnt(4)
    v_add_f32 v24, v24, v32
    v_cvt_pk_bf16_f32 v112, v32, v33
    v_mfma_f32_16x16x32_bf16 v[136:139], a[232:235], v[96:99], v[136:139]
    ds_read_b64_tr_b16 a[244:245], v13 offset:32768
    ds_read_b64_tr_b16 a[246:247], v21 offset:32768
    v_mfma_f32_16x16x32_bf16 v[168:171], a[232:235], v[100:103], v[168:171]
    v_add_f32 v24, v24, v33
    v_mfma_f32_16x16x32_bf16 v[200:203], a[232:235], v[104:107], v[200:203]
    v_exp_f32 v34, v78
    v_mfma_f32_16x16x32_bf16 v[232:235], a[232:235], v[108:111], v[232:235]
    v_exp_f32 v35, v79
    v_mfma_f32_16x16x32_bf16 a[168:171], a[232:235], v[36:39], a[168:171]
    s_waitcnt lgkmcnt(4)
    v_add_f32 v24, v24, v34
    v_cvt_pk_bf16_f32 v113, v34, v35
    v_mfma_f32_16x16x32_bf16 v[140:143], a[236:239], v[96:99], v[140:143]
    ds_read_b64_tr_b16 a[248:249], v14 offset:32768
    ds_read_b64_tr_b16 a[250:251], v22 offset:32768
    v_mfma_f32_16x16x32_bf16 v[172:175], a[236:239], v[100:103], v[172:175]
    s_waitcnt vmcnt(5)
    buffer_load_dwordx4 v0, s[12:15], s32 offen offset:2048 nt lds
    v_add_f32 v24, v24, v35
    v_mfma_f32_16x16x32_bf16 v[204:207], a[236:239], v[104:107], v[204:207]
    v_exp_f32 v30, v80
    v_mfma_f32_16x16x32_bf16 v[236:239], a[236:239], v[108:111], v[236:239]
    v_exp_f32 v31, v81
    v_mfma_f32_16x16x32_bf16 a[172:175], a[236:239], v[36:39], a[172:175]
    s_waitcnt lgkmcnt(4)
    v_add_f32 v25, v25, v30
    v_cvt_pk_bf16_f32 v116, v30, v31
    v_mfma_f32_16x16x32_bf16 v[144:147], a[240:243], v[96:99], v[144:147]
    ds_read_b64_tr_b16 a[252:253], v15 offset:32768
    ds_read_b64_tr_b16 a[254:255], v23 offset:32768
    v_mfma_f32_16x16x32_bf16 v[176:179], a[240:243], v[100:103], v[176:179]
    v_add_f32 v25, v25, v31
    v_mfma_f32_16x16x32_bf16 v[208:211], a[240:243], v[104:107], v[208:211]
    v_exp_f32 v32, v82
    v_mfma_f32_16x16x32_bf16 v[240:243], a[240:243], v[108:111], v[240:243]
    v_exp_f32 v33, v83
    v_mfma_f32_16x16x32_bf16 a[176:179], a[240:243], v[36:39], a[176:179]
    s_waitcnt lgkmcnt(4)
    v_add_f32 v25, v25, v32
    v_cvt_pk_bf16_f32 v117, v32, v33
    v_mfma_f32_16x16x32_bf16 v[148:151], a[244:247], v[96:99], v[148:151]
    ds_read_b128 a[224:227], v4 offset:0
    v_add_f32 v25, v25, v33
    v_mfma_f32_16x16x32_bf16 v[180:183], a[244:247], v[100:103], v[180:183]
    ds_write2st64_b64 v1, v[112:113], v[116:117] offset0:5 offset1:6
    v_mfma_f32_16x16x32_bf16 v[212:215], a[244:247], v[104:107], v[212:215]
    s_waitcnt vmcnt(6)
    buffer_load_dwordx4 v0, s[12:15], s32 offen offset:3072 nt lds
    v_mfma_f32_16x16x32_bf16 v[244:247], a[244:247], v[108:111], v[244:247]
    v_exp_f32 v34, v84
    v_mfma_f32_16x16x32_bf16 a[180:183], a[244:247], v[36:39], a[180:183]
    s_waitcnt lgkmcnt(4)
    v_exp_f32 v35, v85
    v_mfma_f32_16x16x32_bf16 v[152:155], a[248:251], v[96:99], v[152:155]
    ds_read_b128 a[228:231], v5 offset:0
    v_add_f32 v26, v26, v34
    v_mfma_f32_16x16x32_bf16 v[184:187], a[248:251], v[100:103], v[184:187]
    v_cvt_pk_bf16_f32 v120, v34, v35
    v_add_f32 v26, v26, v35
    v_mfma_f32_16x16x32_bf16 v[216:219], a[248:251], v[104:107], v[216:219]
    v_exp_f32 v30, v86
    v_mfma_f32_16x16x32_bf16 v[248:251], a[248:251], v[108:111], v[248:251]
    v_exp_f32 v31, v87
    v_mfma_f32_16x16x32_bf16 a[184:187], a[248:251], v[36:39], a[184:187]
    s_waitcnt lgkmcnt(3)
    v_add_f32 v26, v26, v30
    v_cvt_pk_bf16_f32 v121, v30, v31
    v_mfma_f32_16x16x32_bf16 v[156:159], a[252:255], v[96:99], v[156:159]
    ds_read_b128 a[232:235], v6 offset:0
    v_add_f32 v26, v26, v31
    v_mfma_f32_16x16x32_bf16 v[188:191], a[252:255], v[100:103], v[188:191]
    v_mfma_f32_16x16x32_bf16 v[220:223], a[252:255], v[104:107], v[220:223]
    v_mfma_f32_16x16x32_bf16 v[252:255], a[252:255], v[108:111], v[252:255]
    s_add_u32 s32, s32, 16384
    v_mfma_f32_16x16x32_bf16 a[188:191], a[252:255], v[36:39], a[188:191]
    s_cbranch_vccnz L_rare35
L_back35:
    v_mbcnt_lo_u32_b32 v30, -1, 0
    v_mbcnt_hi_u32_b32 v30, -1, v30
    v_lshrrev_b32 v29, 4, v30
    v_lshlrev_b32 v29, 1, v29
    v_xor_b32 v29, v29, v30
    v_and_b32 v29, 7, v29
    v_lshlrev_b32 v29, 4, v29
    v_lshrrev_b32 v30, 3, v30
    v_mul_u32_u24 v30, 896, v30
    v_add_u32 v29, v29, v30
    s_mul_i32 s99, s28, 28672
    v_add_u32 v29, s99, v29
    s_waitcnt lgkmcnt(3)
    v_mfma_f32_16x16x32_bf16 v[60:63], a[224:227], a[0:3], v[40:43]
    ds_read_b128 a[236:239], v7 offset:0
    v_mfma_f32_16x16x32_bf16 v[64:67], a[224:227], a[32:35], v[44:47]
    s_add_u32 m0, s29, 81920
    s_waitcnt vmcnt(5)
    buffer_load_dwordx4 v0, s[16:19], s33 offen offset:0 nt lds
    v_mfma_f32_16x16x32_bf16 v[68:71], a[224:227], a[64:67], v[48:51]
    v_exp_f32 v32, v88
    v_mfma_f32_16x16x32_bf16 v[72:75], a[224:227], a[96:99], v[52:55]
    s_waitcnt lgkmcnt(2)
    v_exp_f32 v33, v89
    v_mfma_f32_16x16x32_bf16 v[60:63], a[228:231], a[4:7], v[60:63]
    ds_read_b128 a[240:243], v4 offset:256
    v_add_f32 v27, v27, v32
    v_mfma_f32_16x16x32_bf16 v[64:67], a[228:231], a[36:39], v[64:67]
    s_waitcnt vmcnt(6)
    buffer_load_dwordx4 v0, s[16:19], s33 offen offset:1024 nt lds
    v_cvt_pk_bf16_f32 v124, v32, v33
    v_mfma_f32_16x16x32_bf16 v[68:71], a[228:231], a[68:71], v[68:71]
    v_add_f32 v27, v27, v33
    v_mfma_f32_16x16x32_bf16 v[72:75], a[228:231], a[100:103], v[72:75]
    s_waitcnt lgkmcnt(2)
    v_exp_f32 v34, v90
    v_mfma_f32_16x16x32_bf16 v[60:63], a[232:235], a[8:11], v[60:63]
    ds_read_b128 a[244:247], v5 offset:256
    v_mfma_f32_16x16x32_bf16 v[64:67], a[232:235], a[40:43], v[64:67]
    s_waitcnt vmcnt(5)
    buffer_load_dwordx4 v0, s[16:19], s33 offen offset:2048 nt lds
    v_mfma_f32_16x16x32_bf16 v[68:71], a[232:235], a[72:75], v[68:71]
    v_exp_f32 v35, v91
    v_mfma_f32_16x16x32_bf16 v[72:75], a[232:235], a[104:107], v[72:75]
    s_waitcnt lgkmcnt(2)
    v_add_f32 v27, v27, v34
    v_cvt_pk_bf16_f32 v125, v34, v35
    v_mfma_f32_16x16x32_bf16 v[60:63], a[236:239], a[12:15], v[60:63]
    ds_read_b128 a[248:251], v6 offset:256
    v_add_f32 v27, v27, v35
    v_mfma_f32_16x16x32_bf16 v[64:67], a[236:239], a[44:47], v[64:67]
    s_waitcnt vmcnt(6)
    buffer_load_dwordx4 v0, s[16:19], s33 offen offset:3072 nt lds
    v_mfma_f32_16x16x32_bf16 v[68:71], a[236:239], a[76:79], v[68:71]
    ds_write2st64_b64 v1, v[120:121], v[124:125] offset0:7 offset1:8
    v_mfma_f32_16x16x32_bf16 v[72:75], a[236:239], a[108:111], v[72:75]
    s_waitcnt lgkmcnt(3)
    v_exp_f32 v30, v92
    v_mfma_f32_16x16x32_bf16 v[60:63], a[240:243], a[16:19], v[60:63]
    ds_read_b128 a[252:255], v7 offset:256
    v_mfma_f32_16x16x32_bf16 v[64:67], a[240:243], a[48:51], v[64:67]
    s_add_u32 s33, s33, 16384
    v_exp_f32 v31, v93
    v_mfma_f32_16x16x32_bf16 v[68:71], a[240:243], a[80:83], v[68:71]
    v_add_f32 v28, v28, v30
    v_cvt_pk_bf16_f32 v36, v30, v31
    v_mfma_f32_16x16x32_bf16 v[72:75], a[240:243], a[112:115], v[72:75]
    s_waitcnt lgkmcnt(3)
    v_add_f32 v28, v28, v31
    v_mfma_f32_16x16x32_bf16 v[60:63], a[244:247], a[20:23], v[60:63]
    v_exp_f32 v32, v94
    v_exp_f32 v33, v95
    v_add_f32 v28, v28, v32
    v_cvt_pk_bf16_f32 v37, v32, v33
    v_add_f32 v28, v28, v33
    ds_write_b64 v1, v[36:37] offset:4608
    v_mfma_f32_16x16x32_bf16 v[64:67], a[244:247], a[52:55], v[64:67]
    s_waitcnt lgkmcnt(1)
    s_waitcnt lgkmcnt(0)
    s_barrier
    v_mfma_f32_16x16x32_bf16 v[68:71], a[244:247], a[84:87], v[68:71]
    ds_read_b64 v[114:115], v2 offset:2560
    ds_read_b64 v[118:119], v2 offset:3072
    v_mfma_f32_16x16x32_bf16 v[72:75], a[244:247], a[116:119], v[72:75]
    ds_read_b64 v[122:123], v2 offset:3584
    ds_read_b64 v[126:127], v2 offset:4096
    v_mfma_f32_16x16x32_bf16 v[60:63], a[248:251], a[24:27], v[60:63]
    ds_read_b64 v[38:39], v2 offset:4608
    v_mfma_f32_16x16x32_bf16 v[64:67], a[248:251], a[56:59], v[64:67]
    ds_read_b64_tr_b16 a[224:225], v8 offset:49152
    ds_read_b64_tr_b16 a[226:227], v16 offset:49152
    v_mfma_f32_16x16x32_bf16 v[68:71], a[248:251], a[88:91], v[68:71]
    ds_read_b64_tr_b16 a[228:229], v9 offset:49152
    ds_read_b64_tr_b16 a[230:231], v17 offset:49152
    v_mfma_f32_16x16x32_bf16 v[72:75], a[248:251], a[120:123], v[72:75]
    ds_read_b64_tr_b16 a[232:233], v10 offset:49152
    ds_read_b64_tr_b16 a[234:235], v18 offset:49152
    v_mfma_f32_16x16x32_bf16 v[60:63], a[252:255], a[28:31], v[60:63]
    s_add_u32 m0, s29, 0
    s_mov_b32 s34, 128
    buffer_load_dwordx4 v29, s[20:23], s34 offen offset:0 nt lds
    v_mfma_f32_16x16x32_bf16 v[64:67], a[252:255], a[60:63], v[64:67]
    v_mfma_f32_16x16x32_bf16 v[68:71], a[252:255], a[92:95], v[68:71]
    v_mfma_f32_16x16x32_bf16 v[72:75], a[252:255], a[124:127], v[72:75]
    s_cbranch_vccnz L_rare36
L_back36:
    s_waitcnt lgkmcnt(4)
    v_mfma_f32_16x16x32_bf16 v[128:131], a[224:227], v[112:115], v[128:131]
    ds_read_b64_tr_b16 a[236:237], v11 offset:49152
    ds_read_b64_tr_b16 a[238:239], v19 offset:49152
    v_mfma_f32_16x16x32_bf16 v[160:163], a[224:227], v[116:119], v[160:163]
    v_mfma_f32_16x16x32_bf16 v[192:195], a[224:227], v[120:123], v[192:195]
    v_mfma_f32_16x16x32_bf16 v[224:227], a[224:227], v[124:127], v[224:227]
    v_mfma_f32_16x16x32_bf16 a[160:163], a[224:227], v[36:39], a[160:163]
    s_waitcnt lgkmcnt(4)
    v_mfma_f32_16x16x32_bf16 v[132:135], a[228:231], v[112:115], v[132:135]
    s_mov_b32 s34, 6272
    buffer_load_dwordx4 v29, s[20:23], s34 offen offset:1024 nt lds
    v_mfma_f32_16x16x32_bf16 v[164:167], a[228:231], v[116:119], v[164:167]
    ds_read_b64_tr_b16 a[240:241], v12 offset:49152
    ds_read_b64_tr_b16 a[242:243], v20 offset:49152
    v_mfma_f32_16x16x32_bf16 v[196:199], a[228:231], v[120:123], v[196:199]
    v_exp_f32 v34, v60
    v_mfma_f32_16x16x32_bf16 v[228:231], a[228:231], v[124:127], v[228:231]
    v_exp_f32 v35, v61
    v_mfma_f32_16x16x32_bf16 a[164:167], a[228:231], v[36:39], a[164:167]
    s_waitcnt lgkmcnt(4)
    v_add_f32 v24, v24, v34
    v_cvt_pk_bf16_f32 v96, v34, v35
    v_mfma_f32_16x16x32_bf16 v[136:139], a[232:235], v[112:115], v[136:139]
    ds_read_b64_tr_b16 a[244:245], v13 offset:49152
    ds_read_b64_tr_b16 a[246:247], v21 offset:49152
    v_mfma_f32_16x16x32_bf16 v[168:171], a[232:235], v[116:119], v[168:171]
    v_add_f32 v24, v24, v35
    v_mfma_f32_16x16x32_bf16 v[200:203], a[232:235], v[120:123], v[200:203]
    v_exp_f32 v30, v62
    v_mfma_f32_16x16x32_bf16 v[232:235], a[232:235], v[124:127], v[232:235]
    v_exp_f32 v31, v63
    v_mfma_f32_16x16x32_bf16 a[168:171], a[232:235], v[36:39], a[168:171]
    s_waitcnt lgkmcnt(4)
    v_add_f32 v24, v24, v30
    v_cvt_pk_bf16_f32 v97, v30, v31
    v_mfma_f32_16x16x32_bf16 v[140:143], a[236:239], v[112:115], v[140:143]
    ds_read_b64_tr_b16 a[248:249], v14 offset:49152
    ds_read_b64_tr_b16 a[250:251], v22 offset:49152
    v_mfma_f32_16x16x32_bf16 v[172:175], a[236:239], v[116:119], v[172:175]
    s_mov_b32 s34, 12416
    buffer_load_dwordx4 v29, s[20:23], s34 offen offset:2048 nt lds
    v_add_f32 v24, v24, v31
    v_mfma_f32_16x16x32_bf16 v[204:207], a[236:239], v[120:123], v[204:207]
    v_exp_f32 v32, v64
    v_mfma_f32_16x16x32_bf16 v[236:239], a[236:239], v[124:127], v[236:239]
    v_exp_f32 v33, v65
    v_mfma_f32_16x16x32_bf16 a[172:175], a[236:239], v[36:39], a[172:175]
    s_waitcnt lgkmcnt(4)
    v_add_f32 v25, v25, v32
    v_cvt_pk_bf16_f32 v100, v32, v33
    v_mfma_f32_16x16x32_bf16 v[144:147], a[240:243], v[112:115], v[144:147]
    ds_read_b64_tr_b16 a[252:253], v15 offset:49152
    ds_read_b64_tr_b16 a[254:255], v23 offset:49152
    v_mfma_f32_16x16x32_bf16 v[176:179], a[240:243], v[116:119], v[176:179]
    v_add_f32 v25, v25, v33
    v_mfma_f32_16x16x32_bf16 v[208:211], a[240:243], v[120:123], v[208:211]
    v_exp_f32 v34, v66
    v_mfma_f32_16x16x32_bf16 v[240:243], a[240:243], v[124:127], v[240:243]
    v_exp_f32 v35, v67
    v_mfma_f32_16x16x32_bf16 a[176:179], a[240:243], v[36:39], a[176:179]
    s_waitcnt lgkmcnt(4)
    v_add_f32 v25, v25, v34
    v_cvt_pk_bf16_f32 v101, v34, v35
    v_mfma_f32_16x16x32_bf16 v[148:151], a[244:247], v[112:115], v[148:151]
    ds_read_b128 a[224:227], v4 offset:16384
    v_add_f32 v25, v25, v35
    v_mfma_f32_16x16x32_bf16 v[180:183], a[244:247], v[116:119], v[180:183]
    ds_write2st64_b64 v1, v[96:97], v[100:101] offset0:0 offset1:1
    v_mfma_f32_16x16x32_bf16 v[212:215], a[244:247], v[120:123], v[212:215]
    s_mov_b32 s34, 18560
    buffer_load_dwordx4 v29, s[20:23], s34 offen offset:3072 nt lds
    v_mfma_f32_16x16x32_bf16 v[244:247], a[244:247], v[124:127], v[244:247]
    v_mfma_f32_16x16x32_bf16 a[180:183], a[244:247], v[36:39], a[180:183]
    s_waitcnt lgkmcnt(4)
    v_mfma_f32_16x16x32_bf16 v[152:155], a[248:251], v[112:115], v[152:155]
    ds_read_b128 a[228:231], v5 offset:16384
    v_mfma_f32_16x16x32_bf16 v[184:187], a[248:251], v[116:119], v[184:187]
    v_mfma_f32_16x16x32_bf16 v[216:219], a[248:251], v[120:123], v[216:219]
    v_mfma_f32_16x16x32_bf16 v[248:251], a[248:251], v[124:127], v[248:251]
    v_mfma_f32_16x16x32_bf16 a[184:187], a[248:251], v[36:39], a[184:187]
    s_waitcnt lgkmcnt(3)
    v_mfma_f32_16x16x32_bf16 v[156:159], a[252:255], v[112:115], v[156:159]
    ds_read_b128 a[232:235], v6 offset:16384
    v_mfma_f32_16x16x32_bf16 v[188:191], a[252:255], v[116:119], v[188:191]
    v_mfma_f32_16x16x32_bf16 v[220:223], a[252:255], v[120:123], v[220:223]
    v_mfma_f32_16x16x32_bf16 v[252:255], a[252:255], v[124:127], v[252:255]
    v_mfma_f32_16x16x32_bf16 a[188:191], a[252:255], v[36:39], a[188:191]
    s_cbranch_vccnz L_rare37
L_back37:
    s_waitcnt lgkmcnt(3)
    v_mfma_f32_16x16x32_bf16 v[76:79], a[224:227], a[0:3], v[40:43]
    ds_read_b128 a[236:239], v7 offset:16384
    v_mfma_f32_16x16x32_bf16 v[80:83], a[224:227], a[32:35], v[44:47]
    s_add_u32 m0, s29, 98304
    s_waitcnt vmcnt(5)
    buffer_load_dwordx4 v0, s[16:19], s33 offen offset:0 nt lds
    v_mfma_f32_16x16x32_bf16 v[84:87], a[224:227], a[64:67], v[48:51]
    v_exp_f32 v30, v68
    v_mfma_f32_16x16x32_bf16 v[88:91], a[224:227], a[96:99], v[52:55]
    s_waitcnt lgkmcnt(2)
    v_exp_f32 v31, v69
    v_mfma_f32_16x16x32_bf16 v[76:79], a[228:231], a[4:7], v[76:79]
    ds_read_b128 a[240:243], v4 offset:16640
    v_add_f32 v26, v26, v30
    v_mfma_f32_16x16x32_bf16 v[80:83], a[228:231], a[36:39], v[80:83]
    s_waitcnt vmcnt(6)
    buffer_load_dwordx4 v0, s[16:19], s33 offen offset:1024 nt lds
    v_cvt_pk_bf16_f32 v104, v30, v31
    v_mfma_f32_16x16x32_bf16 v[84:87], a[228:231], a[68:71], v[84:87]
    v_add_f32 v26, v26, v31
    v_mfma_f32_16x16x32_bf16 v[88:91], a[228:231], a[100:103], v[88:91]
    s_waitcnt lgkmcnt(2)
    v_exp_f32 v32, v70
    v_mfma_f32_16x16x32_bf16 v[76:79], a[232:235], a[8:11], v[76:79]
    ds_read_b128 a[244:247], v5 offset:16640
    v_mfma_f32_16x16x32_bf16 v[80:83], a[232:235], a[40:43], v[80:83]
    s_waitcnt vmcnt(5)
    buffer_load_dwordx4 v0, s[16:19], s33 offen offset:2048 nt lds
    v_mfma_f32_16x16x32_bf16 v[84:87], a[232:235], a[72:75], v[84:87]
    v_exp_f32 v33, v71
    v_mfma_f32_16x16x32_bf16 v[88:91], a[232:235], a[104:107], v[88:91]
    s_waitcnt lgkmcnt(2)
    v_add_f32 v26, v26, v32
    v_cvt_pk_bf16_f32 v105, v32, v33
    v_mfma_f32_16x16x32_bf16 v[76:79], a[236:239], a[12:15], v[76:79]
    ds_read_b128 a[248:251], v6 offset:16640
    v_add_f32 v26, v26, v33
    v_mfma_f32_16x16x32_bf16 v[80:83], a[236:239], a[44:47], v[80:83]
    s_waitcnt vmcnt(6)
    buffer_load_dwordx4 v0, s[16:19], s33 offen offset:3072 nt lds
    v_mfma_f32_16x16x32_bf16 v[84:87], a[236:239], a[76:79], v[84:87]
    v_exp_f32 v34, v72
    v_mfma_f32_16x16x32_bf16 v[88:91], a[236:239], a[108:111], v[88:91]
    s_waitcnt lgkmcnt(2)
    v_exp_f32 v35, v73
    v_mfma_f32_16x16x32_bf16 v[76:79], a[240:243], a[16:19], v[76:79]
    ds_read_b128 a[252:255], v7 offset:16640
    v_add_f32 v27, v27, v34
    v_mfma_f32_16x16x32_bf16 v[80:83], a[240:243], a[48:51], v[80:83]
    s_add_u32 s33, s33, 16384
    v_cvt_pk_bf16_f32 v108, v34, v35
    v_add_f32 v27, v27, v35
    v_mfma_f32_16x16x32_bf16 v[84:87], a[240:243], a[80:83], v[84:87]
    v_exp_f32 v30, v74
    v_mfma_f32_16x16x32_bf16 v[88:91], a[240:243], a[112:115], v[88:91]
    s_waitcnt lgkmcnt(2)
    v_exp_f32 v31, v75
    v_mfma_f32_16x16x32_bf16 v[76:79], a[244:247], a[20:23], v[76:79]
    v_add_f32 v27, v27, v30
    v_cvt_pk_bf16_f32 v109, v30, v31
    v_add_f32 v27, v27, v31
    ds_write2st64_b64 v1, v[104:105], v[108:109] offset0:2 offset1:3
    v_mfma_f32_16x16x32_bf16 v[80:83], a[244:247], a[52:55], v[80:83]
    s_waitcnt lgkmcnt(1)
    s_waitcnt lgkmcnt(0)
    s_barrier
    v_mfma_f32_16x16x32_bf16 v[84:87], a[244:247], a[84:87], v[84:87]
    ds_read_b64 v[98:99], v2 offset:0
    ds_read_b64 v[102:103], v2 offset:512
    v_mfma_f32_16x16x32_bf16 v[88:91], a[244:247], a[116:119], v[88:91]
    ds_read_b64 v[106:107], v2 offset:1024
    ds_read_b64 v[110:111], v2 offset:1536
    v_mfma_f32_16x16x32_bf16 v[76:79], a[248:251], a[24:27], v[76:79]
    ds_read_b64_tr_b16 a[224:225], v8 offset:0
    ds_read_b64_tr_b16 a[226:227], v16 offset:0
    v_mfma_f32_16x16x32_bf16 v[80:83], a[248:251], a[56:59], v[80:83]
    ds_read_b64_tr_b16 a[228:229], v9 offset:0
    ds_read_b64_tr_b16 a[230:231], v17 offset:0
    v_mfma_f32_16x16x32_bf16 v[84:87], a[248:251], a[88:91], v[84:87]
    s_add_u32 m0, s29, 16384
    s_mov_b32 s34, 114816
    buffer_load_dwordx4 v29, s[20:23], s34 offen offset:0 nt lds
    v_mfma_f32_16x16x32_bf16 v[88:91], a[248:251], a[120:123], v[88:91]
    ds_read_b64_tr_b16 a[232:233], v10 offset:0
    ds_read_b64_tr_b16 a[234:235], v18 offset:0
    v_mfma_f32_16x16x32_bf16 v[76:79], a[252:255], a[28:31], v[76:79]
    v_mfma_f32_16x16x32_bf16 v[80:83], a[252:255], a[60:63], v[80:83]
    v_mfma_f32_16x16x32_bf16 v[84:87], a[252:255], a[92:95], v[84:87]
    v_mfma_f32_16x16x32_bf16 v[88:91], a[252:255], a[124:127], v[88:91]
    s_cbranch_vccnz L_rare38
L_back38:
    s_waitcnt lgkmcnt(4)
    v_mfma_f32_16x16x32_bf16 v[128:131], a[224:227], v[96:99], v[128:131]
    ds_read_b64_tr_b16 a[236:237], v11 offset:0
    ds_read_b64_tr_b16 a[238:239], v19 offset:0
    v_mfma_f32_16x16x32_bf16 v[160:163], a[224:227], v[100:103], v[160:163]
    v_mfma_f32_16x16x32_bf16 v[192:195], a[224:227], v[104:107], v[192:195]
    v_mfma_f32_16x16x32_bf16 v[224:227], a[224:227], v[108:111], v[224:227]
    s_waitcnt lgkmcnt(4)
    s_mov_b32 s34, 120960
    buffer_load_dwordx4 v29, s[20:23], s34 offen offset:1024 nt lds
    v_mfma_f32_16x16x32_bf16 v[132:135], a[228:231], v[96:99], v[132:135]
    ds_read_b64_tr_b16 a[240:241], v12 offset:0
    ds_read_b64_tr_b16 a[242:243], v20 offset:0
    v_mfma_f32_16x16x32_bf16 v[164:167], a[228:231], v[100:103], v[164:167]
    v_exp_f32 v32, v76
    v_mfma_f32_16x16x32_bf16 v[196:199], a[228:231], v[104:107], v[196:199]
    v_exp_f32 v33, v77
    v_mfma_f32_16x16x32_bf16 v[228:231], a[228:231], v[108:111], v[228:231]
    s_waitcnt lgkmcnt(4)
    v_add_f32 v24, v24, v32
    v_cvt_pk_bf16_f32 v112, v32, v33
    v_mfma_f32_16x16x32_bf16 v[136:139], a[232:235], v[96:99], v[136:139]
    ds_read_b64_tr_b16 a[244:245], v13 offset:0
    ds_read_b64_tr_b16 a[246:247], v21 offset:0
    v_mfma_f32_16x16x32_bf16 v[168:171], a[232:235], v[100:103], v[168:171]
    v_add_f32 v24, v24, v33
    v_mfma_f32_16x16x32_bf16 v[200:203], a[232:235], v[104:107], v[200:203]
    v_exp_f32 v34, v78
    v_mfma_f32_16x16x32_bf16 v[232:235], a[232:235], v[108:111], v[232:235]
    s_waitcnt lgkmcnt(4)
    v_exp_f32 v35, v79
    v_mfma_f32_16x16x32_bf16 v[140:143], a[236:239], v[96:99], v[140:143]
    s_mov_b32 s34, 127104
    buffer_load_dwordx4 v29, s[20:23], s34 offen offset:2048 nt lds
    v_add_f32 v24, v24, v34
    v_mfma_f32_16x16x32_bf16 v[172:175], a[236:239], v[100:103], v[172:175]
    ds_read_b64_tr_b16 a[248:249], v14 offset:0
    ds_read_b64_tr_b16 a[250:251], v22 offset:0
    v_mfma_f32_16x16x32_bf16 v[204:207], a[236:239], v[104:107], v[204:207]
    v_cvt_pk_bf16_f32 v113, v34, v35
    v_add_f32 v24, v24, v35
    v_mfma_f32_16x16x32_bf16 v[236:239], a[236:239], v[108:111], v[236:239]
    s_waitcnt lgkmcnt(4)
    v_exp_f32 v30, v80
    v_mfma_f32_16x16x32_bf16 v[144:147], a[240:243], v[96:99], v[144:147]
    ds_read_b64_tr_b16 a[252:253], v15 offset:0
    ds_read_b64_tr_b16 a[254:255], v23 offset:0
    v_mfma_f32_16x16x32_bf16 v[176:179], a[240:243], v[100:103], v[176:179]
    v_exp_f32 v31, v81
    v_mfma_f32_16x16x32_bf16 v[208:211], a[240:243], v[104:107], v[208:211]
    v_add_f32 v25, v25, v30
    v_cvt_pk_bf16_f32 v116, v30, v31
    v_mfma_f32_16x16x32_bf16 v[240:243], a[240:243], v[108:111], v[240:243]
    s_waitcnt lgkmcnt(4)
    v_add_f32 v25, v25, v31
    v_mfma_f32_16x16x32_bf16 v[148:151], a[244:247], v[96:99], v[148:151]
    ds_read_b128 a[224:227], v4 offset:32768
    v_mfma_f32_16x16x32_bf16 v[180:183], a[244:247], v[100:103], v[180:183]
    s_mov_b32 s34, 133248
    buffer_load_dwordx4 v29, s[20:23], s34 offen offset:3072 nt lds
    v_mfma_f32_16x16x32_bf16 v[212:215], a[244:247], v[104:107], v[212:215]
    v_exp_f32 v32, v82
    v_mfma_f32_16x16x32_bf16 v[244:247], a[244:247], v[108:111], v[244:247]
    s_waitcnt lgkmcnt(3)
    v_exp_f32 v33, v83
    v_mfma_f32_16x16x32_bf16 v[152:155], a[248:251], v[96:99], v[152:155]
    ds_read_b128 a[228:231], v5 offset:32768
    v_add_f32 v25, v25, v32
    v_mfma_f32_16x16x32_bf16 v[184:187], a[248:251], v[100:103], v[184:187]
    v_cvt_pk_bf16_f32 v117, v32, v33
    v_add_f32 v25, v25, v33
    v_mfma_f32_16x16x32_bf16 v[216:219], a[248:251], v[104:107], v[216:219]
    ds_write2st64_b64 v1, v[112:113], v[116:117] offset0:5 offset1:6
    v_mfma_f32_16x16x32_bf16 v[248:251], a[248:251], v[108:111], v[248:251]
    s_waitcnt lgkmcnt(3)
    v_mfma_f32_16x16x32_bf16 v[156:159], a[252:255], v[96:99], v[156:159]
    ds_read_b128 a[232:235], v6 offset:32768
    v_mfma_f32_16x16x32_bf16 v[188:191], a[252:255], v[100:103], v[188:191]
    v_mfma_f32_16x16x32_bf16 v[220:223], a[252:255], v[104:107], v[220:223]
    v_mfma_f32_16x16x32_bf16 v[252:255], a[252:255], v[108:111], v[252:255]
    s_cbranch_vccnz L_rare39
L_back39:
    s_waitcnt lgkmcnt(3)
    v_mfma_f32_16x16x32_bf16 v[60:63], a[224:227], a[0:3], v[40:43]
    ds_read_b128 a[236:239], v7 offset:32768
    v_mfma_f32_16x16x32_bf16 v[64:67], a[224:227], a[32:35], v[44:47]
    s_add_u32 m0, s29, 114688
    s_waitcnt vmcnt(5)
    buffer_load_dwordx4 v0, s[16:19], s33 offen offset:0 nt lds
    v_mfma_f32_16x16x32_bf16 v[68:71], a[224:227], a[64:67], v[48:51]
    v_exp_f32 v34, v84
    v_mfma_f32_16x16x32_bf16 v[72:75], a[224:227], a[96:99], v[52:55]
    v_exp_f32 v35, v85
    v_mfma_f32_16x16x32_bf16 v[92:95], a[224:227], a[128:131], v[56:59]
    s_waitcnt lgkmcnt(3)
    v_add_f32 v26, v26, v34
    v_cvt_pk_bf16_f32 v120, v34, v35
    v_mfma_f32_16x16x32_bf16 v[60:63], a[228:231], a[4:7], v[60:63]
    ds_read_b128 a[240:243], v4 offset:33024
    v_add_f32 v26, v26, v35
    v_mfma_f32_16x16x32_bf16 v[64:67], a[228:231], a[36:39], v[64:67]
    v_exp_f32 v30, v86
    v_mfma_f32_16x16x32_bf16 v[68:71], a[228:231], a[68:71], v[68:71]
    s_waitcnt vmcnt(6)
    buffer_load_dwordx4 v0, s[16:19], s33 offen offset:1024 nt lds
    v_mfma_f32_16x16x32_bf16 v[72:75], a[228:231], a[100:103], v[72:75]
    v_exp_f32 v31, v87
    v_mfma_f32_16x16x32_bf16 v[92:95], a[228:231], a[132:135], v[92:95]
    s_waitcnt lgkmcnt(2)
    v_add_f32 v26, v26, v30
    v_cvt_pk_bf16_f32 v121, v30, v31
    v_mfma_f32_16x16x32_bf16 v[60:63], a[232:235], a[8:11], v[60:63]
    ds_read_b128 a[244:247], v5 offset:33024
    v_add_f32 v26, v26, v31
    v_mfma_f32_16x16x32_bf16 v[64:67], a[232:235], a[40:43], v[64:67]
    v_exp_f32 v32, v88
    v_mfma_f32_16x16x32_bf16 v[68:71], a[232:235], a[72:75], v[68:71]
    v_exp_f32 v33, v89
    v_mfma_f32_16x16x32_bf16 v[72:75], a[232:235], a[104:107], v[72:75]
    s_waitcnt vmcnt(5)
    buffer_load_dwordx4 v0, s[16:19], s33 offen offset:2048 nt lds
    v_add_f32 v27, v27, v32
    v_mfma_f32_16x16x32_bf16 v[92:95], a[232:235], a[136:139], v[92:95]
    s_waitcnt lgkmcnt(2)
    v_cvt_pk_bf16_f32 v124, v32, v33
    v_add_f32 v27, v27, v33
    v_mfma_f32_16x16x32_bf16 v[60:63], a[236:239], a[12:15], v[60:63]
    ds_read_b128 a[248:251], v6 offset:33024
    v_mfma_f32_16x16x32_bf16 v[64:67], a[236:239], a[44:47], v[64:67]
    v_exp_f32 v34, v90
    v_mfma_f32_16x16x32_bf16 v[68:71], a[236:239], a[76:79], v[68:71]
    v_exp_f32 v35, v91
    v_mfma_f32_16x16x32_bf16 v[72:75], a[236:239], a[108:111], v[72:75]
    v_add_f32 v27, v27, v34
    v_cvt_pk_bf16_f32 v125, v34, v35
    v_mfma_f32_16x16x32_bf16 v[92:95], a[236:239], a[140:143], v[92:95]
    s_waitcnt lgkmcnt(2)
    s_waitcnt vmcnt(6)
    buffer_load_dwordx4 v0, s[16:19], s33 offen offset:3072 nt lds
    v_mfma_f32_16x16x32_bf16 v[60:63], a[240:243], a[16:19], v[60:63]
    ds_read_b128 a[252:255], v7 offset:33024
    v_add_f32 v27, v27, v35
    v_mfma_f32_16x16x32_bf16 v[64:67], a[240:243], a[48:51], v[64:67]
    ds_write2st64_b64 v1, v[120:121], v[124:125] offset0:7 offset1:8
    v_mfma_f32_16x16x32_bf16 v[68:71], a[240:243], a[80:83], v[68:71]
    v_mfma_f32_16x16x32_bf16 v[72:75], a[240:243], a[112:115], v[72:75]
    v_mfma_f32_16x16x32_bf16 v[92:95], a[240:243], a[144:147], v[92:95]
    s_waitcnt lgkmcnt(3)
    v_mfma_f32_16x16x32_bf16 v[60:63], a[244:247], a[20:23], v[60:63]
    s_add_u32 s33, s33, 16384
    v_mfma_f32_16x16x32_bf16 v[64:67], a[244:247], a[52:55], v[64:67]
    v_mfma_f32_16x16x32_bf16 v[68:71], a[244:247], a[84:87], v[68:71]
    v_mfma_f32_16x16x32_bf16 v[72:75], a[244:247], a[116:119], v[72:75]
    v_mfma_f32_16x16x32_bf16 v[92:95], a[244:247], a[148:151], v[92:95]
    s_waitcnt lgkmcnt(1)
    s_waitcnt lgkmcnt(0)
    s_barrier
    v_mfma_f32_16x16x32_bf16 v[60:63], a[248:251], a[24:27], v[60:63]
    ds_read_b64 v[114:115], v2 offset:2560
    ds_read_b64 v[118:119], v2 offset:3072
    v_mfma_f32_16x16x32_bf16 v[64:67], a[248:251], a[56:59], v[64:67]
    ds_read_b64 v[122:123], v2 offset:3584
    ds_read_b64 v[126:127], v2 offset:4096
    v_mfma_f32_16x16x32_bf16 v[68:71], a[248:251], a[88:91], v[68:71]
    ds_read_b64_tr_b16 a[224:225], v8 offset:16384
    ds_read_b64_tr_b16 a[226:227], v16 offset:16384
    v_mfma_f32_16x16x32_bf16 v[72:75], a[248:251], a[120:123], v[72:75]
    ds_read_b64_tr_b16 a[228:229], v9 offset:16384
    ds_read_b64_tr_b16 a[230:231], v17 offset:16384
    v_mfma_f32_16x16x32_bf16 v[92:95], a[248:251], a[152:155], v[92:95]
    s_add_u32 m0, s29, 65536
    s_mov_b32 s34, 0
    buffer_load_dwordx4 v29, s[20:23], s34 offen offset:0 nt lds
    v_mfma_f32_16x16x32_bf16 v[60:63], a[252:255], a[28:31], v[60:63]
    ds_read_b64_tr_b16 a[232:233], v10 offset:16384
    ds_read_b64_tr_b16 a[234:235], v18 offset:16384
    v_mfma_f32_16x16x32_bf16 v[64:67], a[252:255], a[60:63], v[64:67]
    v_mfma_f32_16x16x32_bf16 v[68:71], a[252:255], a[92:95], v[68:71]
    v_mfma_f32_16x16x32_bf16 v[72:75], a[252:255], a[124:127], v[72:75]
    v_mfma_f32_16x16x32_bf16 v[92:95], a[252:255], a[156:159], v[92:95]
    s_cbranch_vccnz L_rare40
L_back40:
    s_waitcnt lgkmcnt(4)
    v_mfma_f32_16x16x32_bf16 v[128:131], a[224:227], v[112:115], v[128:131]
    ds_read_b64_tr_b16 a[236:237], v11 offset:16384
    ds_read_b64_tr_b16 a[238:239], v19 offset:16384
    v_mfma_f32_16x16x32_bf16 v[160:163], a[224:227], v[116:119], v[160:163]
    v_mfma_f32_16x16x32_bf16 v[192:195], a[224:227], v[120:123], v[192:195]
    v_mfma_f32_16x16x32_bf16 v[224:227], a[224:227], v[124:127], v[224:227]
    s_waitcnt lgkmcnt(4)
    s_mov_b32 s34, 6144
    buffer_load_dwordx4 v29, s[20:23], s34 offen offset:1024 nt lds
    v_mfma_f32_16x16x32_bf16 v[132:135], a[228:231], v[112:115], v[132:135]
    ds_read_b64_tr_b16 a[240:241], v12 offset:16384
    ds_read_b64_tr_b16 a[242:243], v20 offset:16384
    v_mfma_f32_16x16x32_bf16 v[164:167], a[228:231], v[116:119], v[164:167]
    v_exp_f32 v30, v92
    v_mfma_f32_16x16x32_bf16 v[196:199], a[228:231], v[120:123], v[196:199]
    v_exp_f32 v31, v93
    v_mfma_f32_16x16x32_bf16 v[228:231], a[228:231], v[124:127], v[228:231]
    s_waitcnt lgkmcnt(4)
    v_add_f32 v28, v28, v30
    v_cvt_pk_bf16_f32 v36, v30, v31
    v_mfma_f32_16x16x32_bf16 v[136:139], a[232:235], v[112:115], v[136:139]
    ds_read_b64_tr_b16 a[244:245], v13 offset:16384
    ds_read_b64_tr_b16 a[246:247], v21 offset:16384
    v_mfma_f32_16x16x32_bf16 v[168:171], a[232:235], v[116:119], v[168:171]
    v_add_f32 v28, v28, v31
    v_mfma_f32_16x16x32_bf16 v[200:203], a[232:235], v[120:123], v[200:203]
    v_exp_f32 v32, v94
    v_mfma_f32_16x16x32_bf16 v[232:235], a[232:235], v[124:127], v[232:235]
    s_waitcnt lgkmcnt(4)
    v_exp_f32 v33, v95
    v_mfma_f32_16x16x32_bf16 v[140:143], a[236:239], v[112:115], v[140:143]
    s_mov_b32 s34, 12288
    buffer_load_dwordx4 v29, s[20:23], s34 offen offset:2048 nt lds
    v_add_f32 v28, v28, v32
    v_mfma_f32_16x16x32_bf16 v[172:175], a[236:239], v[116:119], v[172:175]
    ds_read_b64_tr_b16 a[248:249], v14 offset:16384
    ds_read_b64_tr_b16 a[250:251], v22 offset:16384
    v_mfma_f32_16x16x32_bf16 v[204:207], a[236:239], v[120:123], v[204:207]
    v_cvt_pk_bf16_f32 v37, v32, v33
    v_add_f32 v28, v28, v33
    v_mfma_f32_16x16x32_bf16 v[236:239], a[236:239], v[124:127], v[236:239]
    s_waitcnt lgkmcnt(4)
    ds_write_b64 v1, v[36:37] offset:2048
    v_mfma_f32_16x16x32_bf16 v[144:147], a[240:243], v[112:115], v[144:147]
    ds_read_b64_tr_b16 a[252:253], v15 offset:16384
    ds_read_b64_tr_b16 a[254:255], v23 offset:16384
    v_mfma_f32_16x16x32_bf16 v[176:179], a[240:243], v[116:119], v[176:179]
    v_exp_f32 v34, v60
    v_mfma_f32_16x16x32_bf16 v[208:211], a[240:243], v[120:123], v[208:211]
    v_exp_f32 v35, v61
    v_mfma_f32_16x16x32_bf16 v[240:243], a[240:243], v[124:127], v[240:243]
    s_waitcnt lgkmcnt(5)
    v_add_f32 v24, v24, v34
    v_cvt_pk_bf16_f32 v96, v34, v35
    v_mfma_f32_16x16x32_bf16 v[148:151], a[244:247], v[112:115], v[148:151]
    ds_read_b128 a[224:227], v4 offset:49152
    v_add_f32 v24, v24, v35
    v_mfma_f32_16x16x32_bf16 v[180:183], a[244:247], v[116:119], v[180:183]
    s_mov_b32 s34, 18432
    buffer_load_dwordx4 v29, s[20:23], s34 offen offset:3072 nt lds
    v_mfma_f32_16x16x32_bf16 v[212:215], a[244:247], v[120:123], v[212:215]
    v_exp_f32 v30, v62
    v_mfma_f32_16x16x32_bf16 v[244:247], a[244:247], v[124:127], v[244:247]
    s_waitcnt lgkmcnt(4)
    v_exp_f32 v31, v63
    v_mfma_f32_16x16x32_bf16 v[152:155], a[248:251], v[112:115], v[152:155]
    ds_read_b128 a[228:231], v5 offset:49152
    v_add_f32 v24, v24, v30
    v_mfma_f32_16x16x32_bf16 v[184:187], a[248:251], v[116:119], v[184:187]
    v_cvt_pk_bf16_f32 v97, v30, v31
    v_add_f32 v24, v24, v31
    v_mfma_f32_16x16x32_bf16 v[216:219], a[248:251], v[120:123], v[216:219]
    v_mfma_f32_16x16x32_bf16 v[248:251], a[248:251], v[124:127], v[248:251]
    s_waitcnt lgkmcnt(2)
    v_mfma_f32_16x16x32_bf16 v[156:159], a[252:255], v[112:115], v[156:159]
    ds_read_b128 a[232:235], v6 offset:49152
    v_mfma_f32_16x16x32_bf16 v[188:191], a[252:255], v[116:119], v[188:191]
    v_mfma_f32_16x16x32_bf16 v[220:223], a[252:255], v[120:123], v[220:223]
    v_mfma_f32_16x16x32_bf16 v[252:255], a[252:255], v[124:127], v[252:255]
    s_cbranch_vccnz L_rare41
L_back41:
    s_waitcnt lgkmcnt(2)
    v_mfma_f32_16x16x32_bf16 v[76:79], a[224:227], a[0:3], v[40:43]
    ds_read_b128 a[236:239], v7 offset:49152
    v_mfma_f32_16x16x32_bf16 v[80:83], a[224:227], a[32:35], v[44:47]
    v_exp_f32 v32, v64
    v_mfma_f32_16x16x32_bf16 v[84:87], a[224:227], a[64:67], v[48:51]
    v_exp_f32 v33, v65
    v_mfma_f32_16x16x32_bf16 v[88:91], a[224:227], a[96:99], v[52:55]
    v_add_f32 v25, v25, v32
    v_cvt_pk_bf16_f32 v100, v32, v33
    v_mfma_f32_16x16x32_bf16 v[92:95], a[224:227], a[128:131], v[56:59]
    s_waitcnt lgkmcnt(2)
    v_add_f32 v25, v25, v33
    v_mfma_f32_16x16x32_bf16 v[76:79], a[228:231], a[4:7], v[76:79]
    ds_read_b128 a[240:243], v4 offset:49408
    v_mfma_f32_16x16x32_bf16 v[80:83], a[228:231], a[36:39], v[80:83]
    v_exp_f32 v34, v66
    v_mfma_f32_16x16x32_bf16 v[84:87], a[228:231], a[68:71], v[84:87]
    v_exp_f32 v35, v67
    v_mfma_f32_16x16x32_bf16 v[88:91], a[228:231], a[100:103], v[88:91]
    v_add_f32 v25, v25, v34
    v_cvt_pk_bf16_f32 v101, v34, v35
    v_mfma_f32_16x16x32_bf16 v[92:95], a[228:231], a[132:135], v[92:95]
    s_waitcnt lgkmcnt(2)
    v_add_f32 v25, v25, v35
    v_mfma_f32_16x16x32_bf16 v[76:79], a[232:235], a[8:11], v[76:79]
    ds_read_b128 a[244:247], v5 offset:49408
    v_mfma_f32_16x16x32_bf16 v[80:83], a[232:235], a[40:43], v[80:83]
    ds_write2st64_b64 v1, v[96:97], v[100:101] offset0:0 offset1:1
    v_mfma_f32_16x16x32_bf16 v[84:87], a[232:235], a[72:75], v[84:87]
    v_exp_f32 v30, v68
    v_mfma_f32_16x16x32_bf16 v[88:91], a[232:235], a[104:107], v[88:91]
    v_exp_f32 v31, v69
    v_mfma_f32_16x16x32_bf16 v[92:95], a[232:235], a[136:139], v[92:95]
    s_waitcnt lgkmcnt(3)
    v_add_f32 v26, v26, v30
    v_cvt_pk_bf16_f32 v104, v30, v31
    v_mfma_f32_16x16x32_bf16 v[76:79], a[236:239], a[12:15], v[76:79]
    ds_read_b128 a[248:251], v6 offset:49408
    v_add_f32 v26, v26, v31
    v_mfma_f32_16x16x32_bf16 v[80:83], a[236:239], a[44:47], v[80:83]
    v_exp_f32 v32, v70
    v_mfma_f32_16x16x32_bf16 v[84:87], a[236:239], a[76:79], v[84:87]
    v_exp_f32 v33, v71
    v_mfma_f32_16x16x32_bf16 v[88:91], a[236:239], a[108:111], v[88:91]
    v_add_f32 v26, v26, v32
    v_cvt_pk_bf16_f32 v105, v32, v33
    v_mfma_f32_16x16x32_bf16 v[92:95], a[236:239], a[140:143], v[92:95]
    s_waitcnt lgkmcnt(3)
    v_add_f32 v26, v26, v33
    v_mfma_f32_16x16x32_bf16 v[76:79], a[240:243], a[16:19], v[76:79]
    ds_read_b128 a[252:255], v7 offset:49408
    v_mfma_f32_16x16x32_bf16 v[80:83], a[240:243], a[48:51], v[80:83]
    v_exp_f32 v34, v72
    v_mfma_f32_16x16x32_bf16 v[84:87], a[240:243], a[80:83], v[84:87]
    v_exp_f32 v35, v73
    v_mfma_f32_16x16x32_bf16 v[88:91], a[240:243], a[112:115], v[88:91]
    v_add_f32 v27, v27, v34
    v_cvt_pk_bf16_f32 v108, v34, v35
    v_mfma_f32_16x16x32_bf16 v[92:95], a[240:243], a[144:147], v[92:95]
    s_waitcnt lgkmcnt(3)
    v_add_f32 v27, v27, v35
    v_mfma_f32_16x16x32_bf16 v[76:79], a[244:247], a[20:23], v[76:79]
    v_exp_f32 v30, v74
    v_mfma_f32_16x16x32_bf16 v[80:83], a[244:247], a[52:55], v[80:83]
    v_exp_f32 v31, v75
    v_mfma_f32_16x16x32_bf16 v[84:87], a[244:247], a[84:87], v[84:87]
    v_add_f32 v27, v27, v30
    v_cvt_pk_bf16_f32 v109, v30, v31
    v_mfma_f32_16x16x32_bf16 v[88:91], a[244:247], a[116:119], v[88:91]
    v_add_f32 v27, v27, v31
    ds_write2st64_b64 v1, v[104:105], v[108:109] offset0:2 offset1:3
    v_mfma_f32_16x16x32_bf16 v[92:95], a[244:247], a[148:151], v[92:95]
    s_waitcnt lgkmcnt(1)
    s_waitcnt lgkmcnt(0)
    s_waitcnt vmcnt(4)
    s_barrier
    v_mfma_f32_16x16x32_bf16 v[76:79], a[248:251], a[24:27], v[76:79]
    ds_read_b64 v[98:99], v2 offset:0
    ds_read_b64 v[102:103], v2 offset:512
    v_mfma_f32_16x16x32_bf16 v[80:83], a[248:251], a[56:59], v[80:83]
    ds_read_b64 v[106:107], v2 offset:1024
    ds_read_b64 v[110:111], v2 offset:1536
    v_mfma_f32_16x16x32_bf16 v[84:87], a[248:251], a[88:91], v[84:87]
    ds_read_b64 v[38:39], v2 offset:2048
    v_mfma_f32_16x16x32_bf16 v[88:91], a[248:251], a[120:123], v[88:91]
    ds_read_b64_tr_b16 a[224:225], v8 offset:32768
    ds_read_b64_tr_b16 a[226:227], v16 offset:32768
    v_mfma_f32_16x16x32_bf16 v[92:95], a[248:251], a[152:155], v[92:95]
    ds_read_b64_tr_b16 a[228:229], v9 offset:32768
    ds_read_b64_tr_b16 a[230:231], v17 offset:32768
    v_mfma_f32_16x16x32_bf16 v[76:79], a[252:255], a[28:31], v[76:79]
    ds_read_b64_tr_b16 a[232:233], v10 offset:32768
    ds_read_b64_tr_b16 a[234:235], v18 offset:32768
    v_mfma_f32_16x16x32_bf16 v[80:83], a[252:255], a[60:63], v[80:83]
    s_add_u32 m0, s29, 81920
    s_mov_b32 s34, 114688
    buffer_load_dwordx4 v29, s[20:23], s34 offen offset:0 nt lds
    v_mfma_f32_16x16x32_bf16 v[84:87], a[252:255], a[92:95], v[84:87]
    v_mfma_f32_16x16x32_bf16 v[88:91], a[252:255], a[124:127], v[88:91]
    v_mfma_f32_16x16x32_bf16 v[92:95], a[252:255], a[156:159], v[92:95]
    s_cbranch_vccnz L_rare42
L_back42:
    s_waitcnt lgkmcnt(4)
    v_mfma_f32_16x16x32_bf16 v[128:131], a[224:227], v[96:99], v[128:131]
    ds_read_b64_tr_b16 a[236:237], v11 offset:32768
    ds_read_b64_tr_b16 a[238:239], v19 offset:32768
    v_mfma_f32_16x16x32_bf16 v[160:163], a[224:227], v[100:103], v[160:163]
    v_mfma_f32_16x16x32_bf16 v[192:195], a[224:227], v[104:107], v[192:195]
    s_mov_b32 s34, 120832
    buffer_load_dwordx4 v29, s[20:23], s34 offen offset:1024 nt lds
    v_mfma_f32_16x16x32_bf16 v[224:227], a[224:227], v[108:111], v[224:227]
    v_mfma_f32_16x16x32_bf16 a[160:163], a[224:227], v[36:39], a[160:163]
    s_waitcnt lgkmcnt(4)
    v_mfma_f32_16x16x32_bf16 v[132:135], a[228:231], v[96:99], v[132:135]
    ds_read_b64_tr_b16 a[240:241], v12 offset:32768
    ds_read_b64_tr_b16 a[242:243], v20 offset:32768
    v_mfma_f32_16x16x32_bf16 v[164:167], a[228:231], v[100:103], v[164:167]
    v_exp_f32 v32, v76
    v_mfma_f32_16x16x32_bf16 v[196:199], a[228:231], v[104:107], v[196:199]
    v_exp_f32 v33, v77
    v_mfma_f32_16x16x32_bf16 v[228:231], a[228:231], v[108:111], v[228:231]
    v_add_f32 v24, v24, v32
    v_cvt_pk_bf16_f32 v112, v32, v33
    v_mfma_f32_16x16x32_bf16 a[164:167], a[228:231], v[36:39], a[164:167]
    s_waitcnt lgkmcnt(4)
    v_add_f32 v24, v24, v33
    v_mfma_f32_16x16x32_bf16 v[136:139], a[232:235], v[96:99], v[136:139]
    s_mov_b32 s34, 126976
    buffer_load_dwordx4 v29, s[20:23], s34 offen offset:2048 nt lds
    v_mfma_f32_16x16x32_bf16 v[168:171], a[232:235], v[100:103], v[168:171]
    ds_read_b64_tr_b16 a[244:245], v13 offset:32768
    ds_read_b64_tr_b16 a[246:247], v21 offset:32768
    v_mfma_f32_16x16x32_bf16 v[200:203], a[232:235], v[104:107], v[200:203]
    v_exp_f32 v34, v78
    v_mfma_f32_16x16x32_bf16 v[232:235], a[232:235], v[108:111], v[232:235]
    v_exp_f32 v35, v79
    v_mfma_f32_16x16x32_bf16 a[168:171], a[232:235], v[36:39], a[168:171]
    s_waitcnt lgkmcnt(4)
    v_add_f32 v24, v24, v34
    v_cvt_pk_bf16_f32 v113, v34, v35
    v_mfma_f32_16x16x32_bf16 v[140:143], a[236:239], v[96:99], v[140:143]
    ds_read_b64_tr_b16 a[248:249], v14 offset:32768
    ds_read_b64_tr_b16 a[250:251], v22 offset:32768
    v_mfma_f32_16x16x32_bf16 v[172:175], a[236:239], v[100:103], v[172:175]
    v_add_f32 v24, v24, v35
    v_mfma_f32_16x16x32_bf16 v[204:207], a[236:239], v[104:107], v[204:207]
    v_exp_f32 v30, v80
    v_mfma_f32_16x16x32_bf16 v[236:239], a[236:239], v[108:111], v[236:239]
    s_mov_b32 s34, 133120
    buffer_load_dwordx4 v29, s[20:23], s34 offen offset:3072 nt lds
    v_mfma_f32_16x16x32_bf16 a[172:175], a[236:239], v[36:39], a[172:175]
    s_waitcnt lgkmcnt(4)
    v_exp_f32 v31, v81
    v_mfma_f32_16x16x32_bf16 v[144:147], a[240:243], v[96:99], v[144:147]
    ds_read_b64_tr_b16 a[252:253], v15 offset:32768
    ds_read_b64_tr_b16 a[254:255], v23 offset:32768
    v_mfma_f32_16x16x32_bf16 v[176:179], a[240:243], v[100:103], v[176:179]
    v_add_f32 v25, v25, v30
    v_cvt_pk_bf16_f32 v116, v30, v31
    v_mfma_f32_16x16x32_bf16 v[208:211], a[240:243], v[104:107], v[208:211]
    v_add_f32 v25, v25, v31
    v_mfma_f32_16x16x32_bf16 v[240:243], a[240:243], v[108:111], v[240:243]
    v_exp_f32 v32, v82
    v_mfma_f32_16x16x32_bf16 a[176:179], a[240:243], v[36:39], a[176:179]
    s_waitcnt lgkmcnt(4)
    v_exp_f32 v33, v83
    v_mfma_f32_16x16x32_bf16 v[148:151], a[244:247], v[96:99], v[148:151]
    ds_read_b64_tr_b16 a[224:225], v8 offset:49152
    ds_read_b64_tr_b16 a[226:227], v16 offset:49152
    v_mfma_f32_16x16x32_bf16 v[180:183], a[244:247], v[100:103], v[180:183]
    s_lshr_b32 s99, s3, 4
    s_and_b32 s99, s99, 7
    s_lshl_b32 s99, s99, 2
    v_mfma_f32_16x16x32_bf16 v[212:215], a[244:247], v[104:107], v[212:215]
    s_add_u32 s99, s99, s28
    s_mul_i32 s99, s99, 7168
    v_subrev_u32 v0, 151552, v3
    v_mfma_f32_16x16x32_bf16 v[244:247], a[244:247], v[108:111], v[244:247]
    v_lshlrev_b32 v0, 5, v0
    v_add_f32 v25, v25, v32
    v_mfma_f32_16x16x32_bf16 a[180:183], a[244:247], v[36:39], a[180:183]
    s_waitcnt lgkmcnt(4)
    v_cvt_pk_bf16_f32 v117, v32, v33
    v_add_f32 v25, v25, v33
    v_mfma_f32_16x16x32_bf16 v[152:155], a[248:251], v[96:99], v[152:155]
    s_mov_b32 exec_hi, 0x00ffffff
    buffer_load_dword a200, v0, s[20:23], s99 offen
    s_mov_b32 exec_hi, -1
    v_mfma_f32_16x16x32_bf16 v[184:187], a[248:251], v[100:103], v[184:187]
    ds_read_b64_tr_b16 a[228:229], v9 offset:49152
    ds_read_b64_tr_b16 a[230:231], v17 offset:49152
    v_mfma_f32_16x16x32_bf16 v[216:219], a[248:251], v[104:107], v[216:219]
    ds_write2st64_b64 v1, v[112:113], v[116:117] offset0:5 offset1:6
    v_mfma_f32_16x16x32_bf16 v[248:251], a[248:251], v[108:111], v[248:251]
    v_exp_f32 v34, v84
    v_mfma_f32_16x16x32_bf16 a[184:187], a[248:251], v[36:39], a[184:187]
    s_waitcnt lgkmcnt(5)
    v_exp_f32 v35, v85
    v_mfma_f32_16x16x32_bf16 v[156:159], a[252:255], v[96:99], v[156:159]
    ds_read_b64_tr_b16 a[232:233], v10 offset:49152
    ds_read_b64_tr_b16 a[234:235], v18 offset:49152
    v_mfma_f32_16x16x32_bf16 v[188:191], a[252:255], v[100:103], v[188:191]
    v_add_f32 v26, v26, v34
    v_cvt_pk_bf16_f32 v120, v34, v35
    v_mfma_f32_16x16x32_bf16 v[220:223], a[252:255], v[104:107], v[220:223]
    v_add_f32 v26, v26, v35
    v_mfma_f32_16x16x32_bf16 v[252:255], a[252:255], v[108:111], v[252:255]
    v_exp_f32 v30, v86
    v_mfma_f32_16x16x32_bf16 a[188:191], a[252:255], v[36:39], a[188:191]
    v_exp_f32 v31, v87
    v_add_f32 v26, v26, v30
    v_cvt_pk_bf16_f32 v121, v30, v31
    v_add_f32 v26, v26, v31
    v_exp_f32 v32, v88
    v_exp_f32 v33, v89
    v_add_f32 v27, v27, v32
    v_cvt_pk_bf16_f32 v124, v32, v33
    v_add_f32 v27, v27, v33
    v_exp_f32 v34, v90
    v_exp_f32 v35, v91
    v_add_f32 v27, v27, v34
    v_cvt_pk_bf16_f32 v125, v34, v35
    v_add_f32 v27, v27, v35
    ds_write2st64_b64 v1, v[120:121], v[124:125] offset0:7 offset1:8
    v_exp_f32 v30, v92
    v_exp_f32 v31, v93
    v_add_f32 v28, v28, v30
    v_cvt_pk_bf16_f32 v36, v30, v31
    v_add_f32 v28, v28, v31
    v_exp_f32 v32, v94
    v_exp_f32 v33, v95
    v_add_f32 v28, v28, v32
    v_cvt_pk_bf16_f32 v37, v32, v33
    v_add_f32 v28, v28, v33
    ds_write_b64 v1, v[36:37] offset:4608
    s_cbranch_vccnz L_rare43
L_back43:
    s_waitcnt lgkmcnt(0)
    s_barrier
    ds_read_b64 v[114:115], v2 offset:2560
    ds_read_b64 v[118:119], v2 offset:3072
    ds_read_b64 v[122:123], v2 offset:3584
    ds_read_b64 v[126:127], v2 offset:4096
    ds_read_b64 v[38:39], v2 offset:4608
    s_waitcnt lgkmcnt(4)
    v_mfma_f32_16x16x32_bf16 v[128:131], a[224:227], v[112:115], v[128:131]
    s_waitcnt lgkmcnt(3)
    ds_read_b64_tr_b16 a[236:237], v11 offset:49152
    ds_read_b64_tr_b16 a[238:239], v19 offset:49152
    v_mfma_f32_16x16x32_bf16 v[160:163], a[224:227], v[116:119], v[160:163]
    s_waitcnt lgkmcnt(4)
    v_mfma_f32_16x16x32_bf16 v[192:195], a[224:227], v[120:123], v[192:195]
    s_waitcnt lgkmcnt(3)
    v_mbcnt_lo_u32_b32 v0, -1, 0
    v_mbcnt_hi_u32_b32 v0, -1, v0
    v_mfma_f32_16x16x32_bf16 v[224:227], a[224:227], v[124:127], v[224:227]
    s_waitcnt lgkmcnt(2)
    s_nop 0
    v_mfma_f32_16x16x32_bf16 a[160:163], a[224:227], v[36:39], a[160:163]
    v_lshrrev_b32 v3, 2, v0
    v_lshlrev_b32 v3, 7, v3
    v_mfma_f32_16x16x32_bf16 v[132:135], a[228:231], v[112:115], v[132:135]
    ds_read_b64_tr_b16 a[240:241], v12 offset:49152
    ds_read_b64_tr_b16 a[242:243], v20 offset:49152
    v_mfma_f32_16x16x32_bf16 v[164:167], a[228:231], v[116:119], v[164:167]
    v_and_b32 v30, 3, v0
    v_lshl_add_u32 v3, v30, 3, v3
    v_mfma_f32_16x16x32_bf16 v[196:199], a[228:231], v[120:123], v[196:199]
    s_lshl_b32 s99, s31, 1
    s_xor_b32 s99, s99, s30
    v_bfe_u32 v30, v0, 3, 2
    v_mfma_f32_16x16x32_bf16 v[228:231], a[228:231], v[124:127], v[228:231]
    v_xor_b32 v30, s99, v30
    v_mfma_f32_16x16x32_bf16 a[164:167], a[228:231], v[36:39], a[164:167]
    v_lshl_add_u32 v30, v30, 5, v3
    v_xor_b32 v31, 32, v30
    v_mfma_f32_16x16x32_bf16 v[136:139], a[232:235], v[112:115], v[136:139]
    s_lshl_b32 s98, s30, 1
    s_xor_b32 s98, s98, 0
    s_lshl_b32 s98, s98, 12
    v_mfma_f32_16x16x32_bf16 v[168:171], a[232:235], v[116:119], v[168:171]
    s_lshl_b32 s99, s31, 14
    s_add_u32 s99, s99, s98
    s_add_u32 s99, s99, 65536
    v_mfma_f32_16x16x32_bf16 v[200:203], a[232:235], v[120:123], v[200:203]
    ds_read_b64_tr_b16 a[244:245], v13 offset:49152
    ds_read_b64_tr_b16 a[246:247], v21 offset:49152
    v_mfma_f32_16x16x32_bf16 v[232:235], a[232:235], v[124:127], v[232:235]
    v_add_u32 v40, s99, v30
    v_xor_b32 v48, 0x4000, v40
    v_mfma_f32_16x16x32_bf16 a[168:171], a[232:235], v[36:39], a[168:171]
    s_waitcnt lgkmcnt(4)
    v_add_u32 v41, s99, v31
    v_xor_b32 v49, 0x4000, v41
    v_mfma_f32_16x16x32_bf16 v[140:143], a[236:239], v[112:115], v[140:143]
    s_lshl_b32 s98, s30, 1
    s_xor_b32 s98, s98, 1
    s_lshl_b32 s98, s98, 12
    v_mfma_f32_16x16x32_bf16 v[172:175], a[236:239], v[116:119], v[172:175]
    s_lshl_b32 s99, s31, 14
    s_add_u32 s99, s99, s98
    s_add_u32 s99, s99, 65536
    v_mfma_f32_16x16x32_bf16 v[204:207], a[236:239], v[120:123], v[204:207]
    ds_read_b64_tr_b16 a[248:249], v14 offset:49152
    ds_read_b64_tr_b16 a[250:251], v22 offset:49152
    v_mfma_f32_16x16x32_bf16 v[236:239], a[236:239], v[124:127], v[236:239]
    v_add_u32 v42, s99, v30
    v_xor_b32 v50, 0x4000, v42
    v_mfma_f32_16x16x32_bf16 a[172:175], a[236:239], v[36:39], a[172:175]
    s_waitcnt lgkmcnt(4)
    v_add_u32 v43, s99, v31
    v_xor_b32 v51, 0x4000, v43
    v_mfma_f32_16x16x32_bf16 v[144:147], a[240:243], v[112:115], v[144:147]
    s_lshl_b32 s98, s30, 1
    s_xor_b32 s98, s98, 2
    s_lshl_b32 s98, s98, 12
    v_mfma_f32_16x16x32_bf16 v[176:179], a[240:243], v[116:119], v[176:179]
    s_lshl_b32 s99, s31, 14
    s_add_u32 s99, s99, s98
    s_add_u32 s99, s99, 65536
    v_mfma_f32_16x16x32_bf16 v[208:211], a[240:243], v[120:123], v[208:211]
    ds_read_b64_tr_b16 a[252:253], v15 offset:49152
    ds_read_b64_tr_b16 a[254:255], v23 offset:49152
    v_mfma_f32_16x16x32_bf16 v[240:243], a[240:243], v[124:127], v[240:243]
    v_add_u32 v44, s99, v30
    v_xor_b32 v52, 0x4000, v44
    v_mfma_f32_16x16x32_bf16 a[176:179], a[240:243], v[36:39], a[176:179]
    s_waitcnt lgkmcnt(4)
    v_add_u32 v45, s99, v31
    v_xor_b32 v53, 0x4000, v45
    v_mfma_f32_16x16x32_bf16 v[148:151], a[244:247], v[112:115], v[148:151]
    s_lshl_b32 s98, s30, 1
    s_xor_b32 s98, s98, 3
    s_lshl_b32 s98, s98, 12
    v_mfma_f32_16x16x32_bf16 v[180:183], a[244:247], v[116:119], v[180:183]
    s_lshl_b32 s99, s31, 14
    s_add_u32 s99, s99, s98
    s_add_u32 s99, s99, 65536
    v_mfma_f32_16x16x32_bf16 v[212:215], a[244:247], v[120:123], v[212:215]
    v_add_u32 v46, s99, v30
    v_xor_b32 v54, 0x4000, v46
    v_mfma_f32_16x16x32_bf16 v[244:247], a[244:247], v[124:127], v[244:247]
    v_add_u32 v47, s99, v31
    v_xor_b32 v55, 0x4000, v47
    v_mfma_f32_16x16x32_bf16 a[180:183], a[244:247], v[36:39], a[180:183]
    s_waitcnt lgkmcnt(2)
    v_mov_b32 v30, v24
    v_mov_b32 v31, v24
    v_mfma_f32_16x16x32_bf16 v[152:155], a[248:251], v[112:115], v[152:155]
    s_nop 0
    v_permlane32_swap_b32 v30, v31
    v_mfma_f32_16x16x32_bf16 v[184:187], a[248:251], v[116:119], v[184:187]
    v_add_f32 v30, v30, v31
    v_mov_b32 v31, v30
    v_mfma_f32_16x16x32_bf16 v[216:219], a[248:251], v[120:123], v[216:219]
    s_nop 0
    v_permlane16_swap_b32 v30, v31
    v_add_f32 v24, v30, v31
    v_mfma_f32_16x16x32_bf16 v[248:251], a[248:251], v[124:127], v[248:251]
    v_mov_b32 v30, v25
    v_mov_b32 v31, v25
    v_mfma_f32_16x16x32_bf16 a[184:187], a[248:251], v[36:39], a[184:187]
    s_waitcnt lgkmcnt(0)
    s_nop 0
    v_permlane32_swap_b32 v30, v31
    v_mfma_f32_16x16x32_bf16 v[156:159], a[252:255], v[112:115], v[156:159]
    v_add_f32 v30, v30, v31
    v_mov_b32 v31, v30
    v_mfma_f32_16x16x32_bf16 v[188:191], a[252:255], v[116:119], v[188:191]
    s_nop 0
    v_permlane16_swap_b32 v30, v31
    v_add_f32 v25, v30, v31
    v_mfma_f32_16x16x32_bf16 v[220:223], a[252:255], v[120:123], v[220:223]
    v_mov_b32 v30, v26
    v_mov_b32 v31, v26
    v_mfma_f32_16x16x32_bf16 v[252:255], a[252:255], v[124:127], v[252:255]
    s_nop 0
    v_permlane32_swap_b32 v30, v31
    v_mfma_f32_16x16x32_bf16 a[188:191], a[252:255], v[36:39], a[188:191]
    v_add_f32 v30, v30, v31
    v_mov_b32 v31, v30
    s_nop 0
    s_nop 0
    v_permlane16_swap_b32 v30, v31
    v_add_f32 v26, v30, v31
    v_mov_b32 v30, v27
    v_mov_b32 v31, v27
    s_nop 0
    s_nop 0
    v_permlane32_swap_b32 v30, v31
    v_add_f32 v30, v30, v31
    v_mov_b32 v31, v30
    s_nop 0
    s_nop 0
    v_permlane16_swap_b32 v30, v31
    v_add_f32 v27, v30, v31
    v_mov_b32 v30, v28
    v_mov_b32 v31, v28
    s_nop 0
    s_nop 0
    v_permlane32_swap_b32 v30, v31
    v_add_f32 v30, v30, v31
    v_mov_b32 v31, v30
    s_nop 0
    s_nop 0
    v_permlane16_swap_b32 v30, v31
    v_add_f32 v28, v30, v31
    v_and_b32 v3, 15, v0
    v_lshlrev_b32 v3, 2, v3
    s_mul_i32 s99, s28, 320
    s_add_u32 s99, s99, 147456
    v_add_u32 v30, s99, v3
    ds_write_b32 v30, v24 offset:0
    ds_write_b32 v30, v25 offset:64
    ds_write_b32 v30, v26 offset:128
    ds_write_b32 v30, v27 offset:192
    ds_write_b32 v30, v28 offset:256
    v_lshlrev_b32 v0, 4, v0
    s_lshl_b32 s99, s30, 16
    s_lshl_b32 s98, s31, 12
    s_add_u32 s99, s99, s98
    s_lshl_b32 s98, s30, 11
    s_add_u32 s99, s99, s98
    s_add_u32 s99, s99, 32768
    v_add_u32 v6, s99, v0
    v_xor_b32 v7, 0x800, v6
L_oproj:
    s_memrealtime s[96:97]
    s_waitcnt vmcnt(1)
    s_waitcnt lgkmcnt(0)
    s_barrier
    ds_read_b64_tr_b16 a[224:225], v40 offset:0
    ds_read_b64_tr_b16 a[226:227], v40 offset:2048
    ds_read_b64_tr_b16 a[96:97], v41 offset:0
    ds_read_b64_tr_b16 a[98:99], v41 offset:2048
    ds_read_b64_tr_b16 a[228:229], v42 offset:0
    ds_read_b64_tr_b16 a[230:231], v42 offset:2048
    v_cvt_pk_bf16_f32 v64, v128, v129
    v_cvt_pk_bf16_f32 v65, v130, v131
    v_cvt_pk_bf16_f32 v66, v132, v133
    v_cvt_pk_bf16_f32 v67, v134, v135
    v_cvt_pk_bf16_f32 v80, v160, v161
    v_cvt_pk_bf16_f32 v81, v162, v163
    v_cvt_pk_bf16_f32 v82, v164, v165
    v_cvt_pk_bf16_f32 v83, v166, v167
    v_cvt_pk_bf16_f32 v96, v192, v193
    v_cvt_pk_bf16_f32 v97, v194, v195
    v_cvt_pk_bf16_f32 v98, v196, v197
    v_cvt_pk_bf16_f32 v99, v198, v199
    v_cvt_pk_bf16_f32 v112, v224, v225
    v_cvt_pk_bf16_f32 v113, v226, v227
    v_cvt_pk_bf16_f32 v114, v228, v229
    v_cvt_pk_bf16_f32 v115, v230, v231
    s_waitcnt lgkmcnt(4)
    v_mfma_f32_16x16x32_bf16 v[8:11], a[224:227], v[64:67], 0
    ds_read_b64_tr_b16 a[100:101], v43 offset:0
    ds_read_b64_tr_b16 a[102:103], v43 offset:2048
    v_mfma_f32_16x16x32_bf16 v[16:19], a[224:227], v[80:83], 0
    v_cvt_pk_bf16_f32 v68, v136, v137
    v_cvt_pk_bf16_f32 v69, v138, v139
    v_mfma_f32_16x16x32_bf16 v[56:59], a[224:227], v[96:99], 0
    v_cvt_pk_bf16_f32 v70, v140, v141
    v_cvt_pk_bf16_f32 v71, v142, v143
    v_mfma_f32_16x16x32_bf16 v[32:35], a[224:227], v[112:115], 0
    s_waitcnt lgkmcnt(4)
    v_cvt_pk_bf16_f32 v84, v168, v169
    v_cvt_pk_bf16_f32 v85, v170, v171
    v_mfma_f32_16x16x32_bf16 v[12:15], a[96:99], v[64:67], 0
    v_cvt_pk_bf16_f32 v86, v172, v173
    v_cvt_pk_bf16_f32 v87, v174, v175
    v_mfma_f32_16x16x32_bf16 v[20:23], a[96:99], v[80:83], 0
    v_cvt_pk_bf16_f32 v100, v200, v201
    v_cvt_pk_bf16_f32 v101, v202, v203
    v_mfma_f32_16x16x32_bf16 v[60:63], a[96:99], v[96:99], 0
    v_cvt_pk_bf16_f32 v102, v204, v205
    v_cvt_pk_bf16_f32 v103, v206, v207
    v_cvt_pk_bf16_f32 v116, v232, v233
    v_cvt_pk_bf16_f32 v117, v234, v235
    v_cvt_pk_bf16_f32 v118, v236, v237
    v_cvt_pk_bf16_f32 v119, v238, v239
    v_mfma_f32_16x16x32_bf16 v[36:39], a[96:99], v[112:115], 0
    s_waitcnt lgkmcnt(2)
    ds_read_b64_tr_b16 a[232:233], v44 offset:0
    ds_read_b64_tr_b16 a[234:235], v44 offset:2048
    v_mfma_f32_16x16x32_bf16 v[8:11], a[228:231], v[68:71], v[8:11]
    ds_read_b64_tr_b16 a[104:105], v45 offset:0
    ds_read_b64_tr_b16 a[106:107], v45 offset:2048
    v_mfma_f32_16x16x32_bf16 v[16:19], a[228:231], v[84:87], v[16:19]
    v_cvt_pk_bf16_f32 v72, v144, v145
    v_cvt_pk_bf16_f32 v73, v146, v147
    v_mfma_f32_16x16x32_bf16 v[56:59], a[228:231], v[100:103], v[56:59]
    v_cvt_pk_bf16_f32 v74, v148, v149
    v_cvt_pk_bf16_f32 v75, v150, v151
    v_mfma_f32_16x16x32_bf16 v[32:35], a[228:231], v[116:119], v[32:35]
    s_waitcnt lgkmcnt(4)
    v_cvt_pk_bf16_f32 v88, v176, v177
    v_cvt_pk_bf16_f32 v89, v178, v179
    v_mfma_f32_16x16x32_bf16 v[12:15], a[100:103], v[68:71], v[12:15]
    v_cvt_pk_bf16_f32 v90, v180, v181
    v_cvt_pk_bf16_f32 v91, v182, v183
    v_mfma_f32_16x16x32_bf16 v[20:23], a[100:103], v[84:87], v[20:23]
    v_cvt_pk_bf16_f32 v104, v208, v209
    v_cvt_pk_bf16_f32 v105, v210, v211
    v_mfma_f32_16x16x32_bf16 v[60:63], a[100:103], v[100:103], v[60:63]
    v_cvt_pk_bf16_f32 v106, v212, v213
    v_cvt_pk_bf16_f32 v107, v214, v215
    v_cvt_pk_bf16_f32 v120, v240, v241
    v_cvt_pk_bf16_f32 v121, v242, v243
    v_cvt_pk_bf16_f32 v122, v244, v245
    v_cvt_pk_bf16_f32 v123, v246, v247
    v_mfma_f32_16x16x32_bf16 v[36:39], a[100:103], v[116:119], v[36:39]
    s_waitcnt lgkmcnt(2)
    ds_read_b64_tr_b16 a[236:237], v46 offset:0
    ds_read_b64_tr_b16 a[238:239], v46 offset:2048
    v_mfma_f32_16x16x32_bf16 v[8:11], a[232:235], v[72:75], v[8:11]
    ds_read_b64_tr_b16 a[108:109], v47 offset:0
    ds_read_b64_tr_b16 a[110:111], v47 offset:2048
    v_mfma_f32_16x16x32_bf16 v[16:19], a[232:235], v[88:91], v[16:19]
    v_cvt_pk_bf16_f32 v76, v152, v153
    v_cvt_pk_bf16_f32 v77, v154, v155
    v_mfma_f32_16x16x32_bf16 v[56:59], a[232:235], v[104:107], v[56:59]
    v_cvt_pk_bf16_f32 v78, v156, v157
    v_cvt_pk_bf16_f32 v79, v158, v159
    v_mfma_f32_16x16x32_bf16 v[32:35], a[232:235], v[120:123], v[32:35]
    s_waitcnt lgkmcnt(4)
    v_cvt_pk_bf16_f32 v92, v184, v185
    v_cvt_pk_bf16_f32 v93, v186, v187
    v_mfma_f32_16x16x32_bf16 v[12:15], a[104:107], v[72:75], v[12:15]
    v_cvt_pk_bf16_f32 v94, v188, v189
    v_cvt_pk_bf16_f32 v95, v190, v191
    v_mfma_f32_16x16x32_bf16 v[20:23], a[104:107], v[88:91], v[20:23]
    v_cvt_pk_bf16_f32 v108, v216, v217
    v_cvt_pk_bf16_f32 v109, v218, v219
    v_mfma_f32_16x16x32_bf16 v[60:63], a[104:107], v[104:107], v[60:63]
    v_cvt_pk_bf16_f32 v110, v220, v221
    v_cvt_pk_bf16_f32 v111, v222, v223
    v_cvt_pk_bf16_f32 v124, v248, v249
    v_cvt_pk_bf16_f32 v125, v250, v251
    v_cvt_pk_bf16_f32 v126, v252, v253
    v_cvt_pk_bf16_f32 v127, v254, v255
    v_mfma_f32_16x16x32_bf16 v[36:39], a[104:107], v[120:123], v[36:39]
    s_waitcnt lgkmcnt(2)
    v_add_u32 v40, 0xffff0000, v40
    ds_read_b64_tr_b16 a[240:241], v40 offset:0
    ds_read_b64_tr_b16 a[242:243], v40 offset:2048
    v_mfma_f32_16x16x32_bf16 v[8:11], a[236:239], v[76:79], v[8:11]
    v_add_u32 v41, 0xffff0000, v41
    ds_read_b64_tr_b16 a[128:129], v41 offset:0
    ds_read_b64_tr_b16 a[130:131], v41 offset:2048
    v_mfma_f32_16x16x32_bf16 v[16:19], a[236:239], v[92:95], v[16:19]
    v_add_u32 v31, s29, v0
    v_add_u32 v31, 131072, v31
    v_mfma_f32_16x16x32_bf16 v[56:59], a[236:239], v[108:111], v[56:59]
    ds_write_b128 v31, a[160:163] offset:0
    v_mfma_f32_16x16x32_bf16 v[32:35], a[236:239], v[124:127], v[32:35]
    s_waitcnt lgkmcnt(5)
    ds_write_b128 v31, a[164:167] offset:1024
    v_mfma_f32_16x16x32_bf16 v[12:15], a[108:111], v[76:79], v[12:15]
    v_add_u32 v42, 0xffff0000, v42
    ds_read_b64_tr_b16 a[244:245], v42 offset:0
    ds_read_b64_tr_b16 a[246:247], v42 offset:2048
    v_mfma_f32_16x16x32_bf16 v[20:23], a[108:111], v[92:95], v[20:23]
    ds_write_b128 v31, a[168:171] offset:2048
    v_mfma_f32_16x16x32_bf16 v[60:63], a[108:111], v[108:111], v[60:63]
    ds_write_b128 v31, a[172:175] offset:3072
    v_mfma_f32_16x16x32_bf16 v[36:39], a[108:111], v[124:127], v[36:39]
    s_waitcnt lgkmcnt(8)
    ds_write_b128 v6, v[64:67] offset:0
    v_mfma_f32_16x16x32_bf16 v[128:131], a[240:243], v[64:67], 0
    v_add_u32 v43, 0xffff0000, v43
    ds_read_b64_tr_b16 a[132:133], v43 offset:0
    ds_read_b64_tr_b16 a[134:135], v43 offset:2048
    v_mfma_f32_16x16x32_bf16 v[136:139], a[240:243], v[80:83], 0
    ds_write_b128 v6, v[80:83] offset:8192
    v_mfma_f32_16x16x32_bf16 v[144:147], a[240:243], v[96:99], 0
    ds_write_b128 v6, v[96:99] offset:16384
    v_mfma_f32_16x16x32_bf16 v[152:155], a[240:243], v[112:115], 0
    s_waitcnt lgkmcnt(11)
    ds_write_b128 v6, v[112:115] offset:24576
    v_mfma_f32_16x16x32_bf16 v[132:135], a[128:131], v[64:67], 0
    v_add_u32 v44, 0xffff0000, v44
    ds_read_b64_tr_b16 a[248:249], v44 offset:0
    ds_read_b64_tr_b16 a[250:251], v44 offset:2048
    v_mfma_f32_16x16x32_bf16 v[140:143], a[128:131], v[80:83], 0
    ds_write_b128 v6, v[68:71] offset:1024
    v_mfma_f32_16x16x32_bf16 v[148:151], a[128:131], v[96:99], 0
    s_waitcnt lgkmcnt(14)
    ds_write_b128 v6, v[84:87] offset:9216
    v_mfma_f32_16x16x32_bf16 v[156:159], a[128:131], v[112:115], 0
    s_waitcnt lgkmcnt(12)
    ds_write_b128 v6, v[100:103] offset:17408
    v_mfma_f32_16x16x32_bf16 v[128:131], a[244:247], v[68:71], v[128:131]
    v_add_u32 v45, 0xffff0000, v45
    ds_read_b64_tr_b16 a[136:137], v45 offset:0
    ds_read_b64_tr_b16 a[138:139], v45 offset:2048
    v_mfma_f32_16x16x32_bf16 v[136:139], a[244:247], v[84:87], v[136:139]
    s_waitcnt lgkmcnt(14)
    ds_write_b128 v6, v[116:119] offset:25600
    v_mfma_f32_16x16x32_bf16 v[144:147], a[244:247], v[100:103], v[144:147]
    s_waitcnt lgkmcnt(14)
    ds_write_b128 v7, v[72:75] offset:0
    v_mfma_f32_16x16x32_bf16 v[152:155], a[244:247], v[116:119], v[152:155]
    s_waitcnt lgkmcnt(12)
    ds_write_b128 v7, v[88:91] offset:8192
    v_mfma_f32_16x16x32_bf16 v[132:135], a[132:135], v[68:71], v[132:135]
    v_add_u32 v46, 0xffff0000, v46
    ds_read_b64_tr_b16 a[252:253], v46 offset:0
    ds_read_b64_tr_b16 a[254:255], v46 offset:2048
    v_mfma_f32_16x16x32_bf16 v[140:143], a[132:135], v[84:87], v[140:143]
    s_waitcnt lgkmcnt(14)
    ds_write_b128 v7, v[104:107] offset:16384
    v_mfma_f32_16x16x32_bf16 v[148:151], a[132:135], v[100:103], v[148:151]
    s_waitcnt lgkmcnt(14)
    ds_write_b128 v7, v[120:123] offset:24576
    v_mfma_f32_16x16x32_bf16 v[156:159], a[132:135], v[116:119], v[156:159]
    s_waitcnt lgkmcnt(12)
    ds_write_b128 v7, v[76:79] offset:1024
    v_mfma_f32_16x16x32_bf16 v[128:131], a[248:251], v[72:75], v[128:131]
    v_add_u32 v47, 0xffff0000, v47
    ds_read_b64_tr_b16 a[140:141], v47 offset:0
    ds_read_b64_tr_b16 a[142:143], v47 offset:2048
    v_mfma_f32_16x16x32_bf16 v[136:139], a[248:251], v[88:91], v[136:139]
    s_waitcnt lgkmcnt(14)
    ds_write_b128 v7, v[92:95] offset:9216
    v_mfma_f32_16x16x32_bf16 v[144:147], a[248:251], v[104:107], v[144:147]
    s_waitcnt lgkmcnt(14)
    ds_write_b128 v7, v[108:111] offset:17408
    v_mfma_f32_16x16x32_bf16 v[152:155], a[248:251], v[120:123], v[152:155]
    s_waitcnt lgkmcnt(12)
    ds_write_b128 v7, v[124:127] offset:25600
    v_mfma_f32_16x16x32_bf16 v[132:135], a[136:139], v[72:75], v[132:135]
    v_xor_b32 v1, 0x1000, v6
    v_xor_b32 v2, 0x1000, v7
    v_mfma_f32_16x16x32_bf16 v[140:143], a[136:139], v[88:91], v[140:143]
    s_lshl_b32 s99, s30, 13
    s_lshl_b32 s98, s31, 10
    s_add_u32 s99, s99, s98
    v_mfma_f32_16x16x32_bf16 v[148:151], a[136:139], v[104:107], v[148:151]
    v_add_u32 v4, s99, v0
    v_mfma_f32_16x16x32_bf16 v[156:159], a[136:139], v[120:123], v[156:159]
    s_lshl_b32 s99, s28, 10
    v_add_u32 v5, s99, v0
    s_xor_b32 s99, s28, 1
    s_mul_i32 s99, s99, 320
    s_add_u32 s99, s99, 147456
    v_add_u32 v30, s99, v3
    v_add_u32 v3, 147712, v3
    ds_read_b32 v244, v30 offset:0
    ds_read_b32 v245, v30 offset:64
    s_waitcnt lgkmcnt(14)
    ds_read_b32 v246, v30 offset:128
    s_waitcnt lgkmcnt(14)
    ds_read_b32 v247, v30 offset:192
    s_waitcnt lgkmcnt(14)
    ds_read_b32 v248, v3 offset:0
    s_waitcnt lgkmcnt(14)
    ds_read_b32 v249, v3 offset:320
    s_waitcnt lgkmcnt(14)
    ds_read_b32 v250, v3 offset:640
    s_waitcnt lgkmcnt(14)
    ds_read_b32 v251, v3 offset:960
    s_waitcnt lgkmcnt(7)
    v_add_f32 v24, v24, v244
    s_waitcnt lgkmcnt(6)
    v_add_f32 v25, v25, v245
    s_waitcnt lgkmcnt(5)
    v_add_f32 v26, v26, v246
    s_waitcnt lgkmcnt(4)
    v_add_f32 v27, v27, v247
    s_waitcnt lgkmcnt(2)
    v_add_f32 v248, v248, v249
    s_waitcnt lgkmcnt(0)
    v_add_f32 v250, v250, v251
    v_add_f32 v28, v248, v250
    v_add_f32 v244, v24, v25
    v_add_f32 v245, v26, v27
    v_add_f32 v244, v244, v245
    v_add_f32 v244, v244, v28
    s_mov_b32 s99, 0x4e800000
    v_cmp_nge_f32 vcc, s99, v244
    s_lshl_b32 s98, s28, 2
    s_add_u32 s98, s98, 149504
    v_mov_b32 v245, s98
    s_cmp_lg_u64 vcc, 0
    s_cselect_b32 s99, 1, 0
    v_mov_b32 v244, s99
    ds_write_b32 v245, v244
    s_waitcnt lgkmcnt(0)
    s_barrier
    v_mfma_f32_16x16x32_bf16 v[128:131], a[252:255], v[76:79], v[128:131]
    ds_read_b64_tr_b16 a[224:225], v48 offset:0
    ds_read_b64_tr_b16 a[226:227], v48 offset:2048
    ds_read_b128 a[0:3], v1 offset:0
    ds_read_b128 a[16:19], v1 offset:8192
    v_mfma_f32_16x16x32_bf16 v[136:139], a[252:255], v[92:95], v[136:139]
    ds_read_b128 a[32:35], v1 offset:16384
    ds_read_b128 a[48:51], v1 offset:24576
    v_mfma_f32_16x16x32_bf16 v[144:147], a[252:255], v[108:111], v[144:147]
    ds_read_b64_tr_b16 a[112:113], v49 offset:0
    ds_read_b64_tr_b16 a[114:115], v49 offset:2048
    v_mfma_f32_16x16x32_bf16 v[152:155], a[252:255], v[124:127], v[152:155]
    ds_read_b128 a[4:7], v1 offset:1024
    ds_read_b128 a[20:23], v1 offset:9216
    v_mfma_f32_16x16x32_bf16 v[132:135], a[140:143], v[76:79], v[132:135]
    ds_read_b128 a[36:39], v1 offset:17408
    ds_read_b128 a[52:55], v1 offset:25600
    v_mfma_f32_16x16x32_bf16 v[140:143], a[140:143], v[92:95], v[140:143]
    ds_read_b128 a[8:11], v2 offset:0
    ds_read_b128 a[24:27], v2 offset:8192
    v_mfma_f32_16x16x32_bf16 v[148:151], a[140:143], v[108:111], v[148:151]
    ds_read_b128 a[40:43], v2 offset:16384
    s_waitcnt lgkmcnt(14)
    ds_read_b128 a[56:59], v2 offset:24576
    v_mfma_f32_16x16x32_bf16 v[156:159], a[140:143], v[124:127], v[156:159]
    s_waitcnt lgkmcnt(13)
    ds_read_b64_tr_b16 a[228:229], v50 offset:0
    ds_read_b64_tr_b16 a[230:231], v50 offset:2048
    v_mfma_f32_16x16x32_bf16 v[8:11], a[224:227], a[0:3], v[8:11]
    s_waitcnt lgkmcnt(14)
    ds_read_b128 a[12:15], v2 offset:1024
    s_waitcnt lgkmcnt(14)
    ds_read_b128 a[28:31], v2 offset:9216
    v_mfma_f32_16x16x32_bf16 v[16:19], a[224:227], a[16:19], v[16:19]
    s_waitcnt lgkmcnt(14)
    ds_read_b128 a[44:47], v2 offset:17408
    s_waitcnt lgkmcnt(14)
    ds_read_b128 a[60:63], v2 offset:25600
    v_mfma_f32_16x16x32_bf16 v[56:59], a[224:227], a[32:35], v[56:59]
    s_waitcnt lgkmcnt(14)
    ds_read_b64_tr_b16 a[116:117], v51 offset:0
    s_waitcnt lgkmcnt(14)
    ds_read_b64_tr_b16 a[118:119], v51 offset:2048
    v_mfma_f32_16x16x32_bf16 v[32:35], a[224:227], a[48:51], v[32:35]
    v_rcp_f32 v24, v24
    v_mfma_f32_16x16x32_bf16 v[12:15], a[112:115], a[0:3], v[12:15]
    s_waitcnt lgkmcnt(14)
    ds_read_b64_tr_b16 a[232:233], v52 offset:0
    s_waitcnt lgkmcnt(14)
    ds_read_b64_tr_b16 a[234:235], v52 offset:2048
    v_mfma_f32_16x16x32_bf16 v[20:23], a[112:115], a[16:19], v[20:23]
    v_rcp_f32 v25, v25
    v_mfma_f32_16x16x32_bf16 v[60:63], a[112:115], a[32:35], v[60:63]
    v_rcp_f32 v26, v26
    v_mfma_f32_16x16x32_bf16 v[36:39], a[112:115], a[48:51], v[36:39]
    s_waitcnt lgkmcnt(8)
    v_rcp_f32 v27, v27
    v_mfma_f32_16x16x32_bf16 v[8:11], a[228:231], a[4:7], v[8:11]
    ds_read_b64_tr_b16 a[120:121], v53 offset:0
    ds_read_b64_tr_b16 a[122:123], v53 offset:2048
    v_mfma_f32_16x16x32_bf16 v[16:19], a[228:231], a[20:23], v[16:19]
    v_rcp_f32 v28, v28
    s_waitcnt lgkmcnt(6)
    s_barrier
    v_mfma_f32_16x16x32_bf16 v[56:59], a[228:231], a[36:39], v[56:59]
    s_add_u32 m0, s29, 32768
    s_mov_b32 s34, 256
    buffer_load_dwordx4 v29, s[20:23], s34 offen offset:0 nt lds
    v_mfma_f32_16x16x32_bf16 v[32:35], a[228:231], a[52:55], v[32:35]
    s_waitcnt lgkmcnt(4)
    v_mfma_f32_16x16x32_bf16 v[12:15], a[116:119], a[4:7], v[12:15]
    s_xor_b32 s99, s29, 0x2000
    s_add_u32 s99, s99, 131072
    v_add_u32 v31, s99, v0
    v_mfma_f32_16x16x32_bf16 v[20:23], a[116:119], a[20:23], v[20:23]
    s_mov_b32 s34, 6400
    buffer_load_dwordx4 v29, s[20:23], s34 offen offset:1024 nt lds
    ds_read_b128 v[176:179], v31 offset:0
    v_mfma_f32_16x16x32_bf16 v[60:63], a[116:119], a[36:39], v[60:63]
    ds_read_b64_tr_b16 a[236:237], v54 offset:0
    ds_read_b64_tr_b16 a[238:239], v54 offset:2048
    v_mfma_f32_16x16x32_bf16 v[36:39], a[116:119], a[52:55], v[36:39]
    s_waitcnt lgkmcnt(5)
    ds_read_b128 v[180:183], v31 offset:1024
    ds_read_b128 v[184:187], v31 offset:2048
    v_mfma_f32_16x16x32_bf16 v[8:11], a[232:235], a[8:11], v[8:11]
    s_mov_b32 s34, 12544
    buffer_load_dwordx4 v29, s[20:23], s34 offen offset:2048 nt lds
    ds_read_b128 v[188:191], v31 offset:3072
    v_mfma_f32_16x16x32_bf16 v[16:19], a[232:235], a[24:27], v[16:19]
    ds_read_b64_tr_b16 a[124:125], v55 offset:0
    ds_read_b64_tr_b16 a[126:127], v55 offset:2048
    v_mfma_f32_16x16x32_bf16 v[56:59], a[232:235], a[40:43], v[56:59]
    v_mov_b32 v30, 149504
    ds_read_b128 v[244:247], v30
    v_mfma_f32_16x16x32_bf16 v[32:35], a[232:235], a[56:59], v[32:35]
    s_waitcnt lgkmcnt(9)
    s_mov_b32 s34, 18688
    buffer_load_dwordx4 v29, s[20:23], s34 offen offset:3072 nt lds
    v_mfma_f32_16x16x32_bf16 v[12:15], a[120:123], a[8:11], v[12:15]
    v_add_u32 v48, 0xffff0000, v48
    ds_read_b64_tr_b16 a[240:241], v48 offset:0
    ds_read_b64_tr_b16 a[242:243], v48 offset:2048
    v_mfma_f32_16x16x32_bf16 v[20:23], a[120:123], a[24:27], v[20:23]
    v_accvgpr_read_b32 v160, a176
    v_accvgpr_read_b32 v161, a177
    v_mfma_f32_16x16x32_bf16 v[60:63], a[120:123], a[40:43], v[60:63]
    s_add_u32 m0, s29, 49152
    s_mov_b32 s34, 114944
    buffer_load_dwordx4 v29, s[20:23], s34 offen offset:0 nt lds
    v_mfma_f32_16x16x32_bf16 v[36:39], a[120:123], a[56:59], v[36:39]
    s_waitcnt lgkmcnt(8)
    v_accvgpr_read_b32 v162, a178
    v_accvgpr_read_b32 v163, a179
    v_mfma_f32_16x16x32_bf16 v[8:11], a[236:239], a[12:15], v[8:11]
    v_add_u32 v49, 0xffff0000, v49
    ds_read_b64_tr_b16 a[144:145], v49 offset:0
    ds_read_b64_tr_b16 a[146:147], v49 offset:2048
    v_mfma_f32_16x16x32_bf16 v[16:19], a[236:239], a[28:31], v[16:19]
    s_mov_b32 s34, 121088
    buffer_load_dwordx4 v29, s[20:23], s34 offen offset:1024 nt lds
    v_accvgpr_read_b32 v164, a180
    v_mfma_f32_16x16x32_bf16 v[56:59], a[236:239], a[44:47], v[56:59]
    v_accvgpr_read_b32 v165, a181
    v_accvgpr_read_b32 v166, a182
    v_mfma_f32_16x16x32_bf16 v[32:35], a[236:239], a[60:63], v[32:35]
    s_waitcnt lgkmcnt(5)
    v_accvgpr_read_b32 v167, a183
    v_accvgpr_read_b32 v168, a184
    v_mfma_f32_16x16x32_bf16 v[12:15], a[124:127], a[12:15], v[12:15]
    s_mov_b32 s34, 127232
    buffer_load_dwordx4 v29, s[20:23], s34 offen offset:2048 nt lds
    v_accvgpr_read_b32 v169, a185
    v_mfma_f32_16x16x32_bf16 v[20:23], a[124:127], a[28:31], v[20:23]
    v_add_u32 v50, 0xffff0000, v50
    ds_read_b64_tr_b16 a[244:245], v50 offset:0
    ds_read_b64_tr_b16 a[246:247], v50 offset:2048
    v_mfma_f32_16x16x32_bf16 v[60:63], a[124:127], a[44:47], v[60:63]
    v_accvgpr_read_b32 v170, a186
    v_accvgpr_read_b32 v171, a187
    v_mfma_f32_16x16x32_bf16 v[36:39], a[124:127], a[60:63], v[36:39]
    s_waitcnt lgkmcnt(4)
    s_mov_b32 s34, 133376
    buffer_load_dwordx4 v29, s[20:23], s34 offen offset:3072 nt lds
    v_mfma_f32_16x16x32_bf16 v[128:131], a[240:243], a[0:3], v[128:131]
    v_add_u32 v51, 0xffff0000, v51
    ds_read_b64_tr_b16 a[148:149], v51 offset:0
    ds_read_b64_tr_b16 a[150:151], v51 offset:2048
    v_mfma_f32_16x16x32_bf16 v[136:139], a[240:243], a[16:19], v[136:139]
    v_accvgpr_read_b32 v172, a188
    v_accvgpr_read_b32 v173, a189
    v_mfma_f32_16x16x32_bf16 v[144:147], a[240:243], a[32:35], v[144:147]
    v_accvgpr_read_b32 v174, a190
    v_accvgpr_read_b32 v175, a191
    v_mfma_f32_16x16x32_bf16 v[152:155], a[240:243], a[48:51], v[152:155]
    s_waitcnt lgkmcnt(4)
    v_or3_b32 v244, v244, v245, v246
    v_or_b32 v244, v244, v247
    v_mfma_f32_16x16x32_bf16 v[132:135], a[144:147], a[0:3], v[132:135]
    s_nop 0
    v_readfirstlane_b32 s99, v244
    v_mfma_f32_16x16x32_bf16 v[140:143], a[144:147], a[16:19], v[140:143]
    s_nop 1
    s_andn2_b32 s99, s99, s39
    s_cbranch_scc1 L_restart
    v_mfma_f32_16x16x32_bf16 v[148:151], a[144:147], a[32:35], v[148:151]
    v_add_u32 v52, 0xffff0000, v52
    ds_read_b64_tr_b16 a[248:249], v52 offset:0
    ds_read_b64_tr_b16 a[250:251], v52 offset:2048
    v_mfma_f32_16x16x32_bf16 v[156:159], a[144:147], a[48:51], v[156:159]
    s_waitcnt lgkmcnt(4)
    v_add_f32 v160, v160, v176
    v_add_f32 v161, v161, v177
    v_mfma_f32_16x16x32_bf16 v[128:131], a[244:247], a[4:7], v[128:131]
    v_add_u32 v53, 0xffff0000, v53
    ds_read_b64_tr_b16 a[152:153], v53 offset:0
    ds_read_b64_tr_b16 a[154:155], v53 offset:2048
    v_mfma_f32_16x16x32_bf16 v[136:139], a[244:247], a[20:23], v[136:139]
    v_add_f32 v162, v162, v178
    v_add_f32 v163, v163, v179
    v_mfma_f32_16x16x32_bf16 v[144:147], a[244:247], a[36:39], v[144:147]
    v_add_f32 v164, v164, v180
    v_add_f32 v165, v165, v181
    v_mfma_f32_16x16x32_bf16 v[152:155], a[244:247], a[52:55], v[152:155]
    s_waitcnt lgkmcnt(4)
    v_add_f32 v166, v166, v182
    v_add_f32 v167, v167, v183
    v_mfma_f32_16x16x32_bf16 v[132:135], a[148:151], a[4:7], v[132:135]
    v_add_u32 v54, 0xffff0000, v54
    ds_read_b64_tr_b16 a[252:253], v54 offset:0
    ds_read_b64_tr_b16 a[254:255], v54 offset:2048
    v_mfma_f32_16x16x32_bf16 v[140:143], a[148:151], a[20:23], v[140:143]
    v_add_f32 v168, v168, v184
    v_add_f32 v169, v169, v185
    v_mfma_f32_16x16x32_bf16 v[148:151], a[148:151], a[36:39], v[148:151]
    v_add_f32 v170, v170, v186
    v_add_f32 v171, v171, v187
    v_mfma_f32_16x16x32_bf16 v[156:159], a[148:151], a[52:55], v[156:159]
    s_waitcnt lgkmcnt(4)
    v_add_f32 v172, v172, v188
    v_add_f32 v173, v173, v189
    v_mfma_f32_16x16x32_bf16 v[128:131], a[248:251], a[8:11], v[128:131]
    v_add_u32 v55, 0xffff0000, v55
    ds_read_b64_tr_b16 a[156:157], v55 offset:0
    ds_read_b64_tr_b16 a[158:159], v55 offset:2048
    v_mfma_f32_16x16x32_bf16 v[136:139], a[248:251], a[24:27], v[136:139]
    v_add_f32 v174, v174, v190
    v_add_f32 v175, v175, v191
    v_mfma_f32_16x16x32_bf16 v[144:147], a[248:251], a[40:43], v[144:147]
    v_cvt_pk_bf16_f32 v160, v160, v161
    v_cvt_pk_bf16_f32 v161, v162, v163
    v_mfma_f32_16x16x32_bf16 v[152:155], a[248:251], a[56:59], v[152:155]
    s_waitcnt lgkmcnt(4)
    v_cvt_pk_bf16_f32 v162, v164, v165
    v_cvt_pk_bf16_f32 v163, v166, v167
    v_mfma_f32_16x16x32_bf16 v[132:135], a[152:155], a[8:11], v[132:135]
    v_cvt_pk_bf16_f32 v164, v168, v169
    v_cvt_pk_bf16_f32 v165, v170, v171
    v_mfma_f32_16x16x32_bf16 v[140:143], a[152:155], a[24:27], v[140:143]
    v_cvt_pk_bf16_f32 v166, v172, v173
    v_cvt_pk_bf16_f32 v167, v174, v175
    s_lshl_b32 s99, s31, 12
    s_xor_b32 s98, s30, 1
    s_lshl_b32 s98, s98, 11
    s_add_u32 s99, s99, s98
    s_add_u32 s99, s99, 155648
    v_add_u32 v31, s99, v0
    ds_write_b128 v31, v[160:163] offset:0
    ds_write_b128 v31, v[164:167] offset:1024
    s_waitcnt lgkmcnt(2)
    s_waitcnt lgkmcnt(0)
    s_waitcnt vmcnt(0)
    s_barrier
    v_mfma_f32_16x16x32_bf16 v[148:151], a[152:155], a[40:43], v[148:151]
    s_xor_b32 s99, s31, 0
    s_lshl_b32 s99, s99, 12
    s_xor_b32 s98, s30, 0
    v_mfma_f32_16x16x32_bf16 v[156:159], a[152:155], a[56:59], v[156:159]
    ds_read_b64_tr_b16 a[224:225], v40 offset:32768
    ds_read_b64_tr_b16 a[226:227], v40 offset:34816
    v_mfma_f32_16x16x32_bf16 v[128:131], a[252:255], a[12:15], v[128:131]
    s_lshl_b32 s98, s98, 11
    s_add_u32 s99, s99, s98
    s_add_u32 s99, s99, 155648
    v_mfma_f32_16x16x32_bf16 v[136:139], a[252:255], a[28:31], v[136:139]
    ds_read_b64_tr_b16 a[228:229], v41 offset:32768
    ds_read_b64_tr_b16 a[230:231], v41 offset:34816
    v_mfma_f32_16x16x32_bf16 v[144:147], a[252:255], a[44:47], v[144:147]
    ds_read_b64_tr_b16 a[232:233], v42 offset:32768
    ds_read_b64_tr_b16 a[234:235], v42 offset:34816
    v_mfma_f32_16x16x32_bf16 v[152:155], a[252:255], a[60:63], v[152:155]
    v_mul_f32 v8, v24, v8
    v_mul_f32 v9, v24, v9
    v_mfma_f32_16x16x32_bf16 v[132:135], a[156:159], a[12:15], v[132:135]
    v_mul_f32 v10, v24, v10
    v_mul_f32 v11, v24, v11
    v_mfma_f32_16x16x32_bf16 v[140:143], a[156:159], a[28:31], v[140:143]
    v_mul_f32 v12, v24, v12
    v_mul_f32 v13, v24, v13
    v_mfma_f32_16x16x32_bf16 v[148:151], a[156:159], a[44:47], v[148:151]
    v_mul_f32 v14, v24, v14
    v_mul_f32 v15, v24, v15
    v_mfma_f32_16x16x32_bf16 v[156:159], a[156:159], a[60:63], v[156:159]
    v_cvt_pk_bf16_f32 v8, v8, v9
    v_cvt_pk_bf16_f32 v9, v10, v11
    v_cvt_pk_bf16_f32 v10, v12, v13
    v_cvt_pk_bf16_f32 v11, v14, v15
    s_mov_b32 s43, 0
    buffer_store_dwordx4 v[8:11], v4, s[24:27], s43 offen offset:0 sc1
    v_mul_f32 v16, v25, v16
    v_mul_f32 v17, v25, v17
    v_mul_f32 v18, v25, v18
    v_mul_f32 v19, v25, v19
    v_mul_f32 v20, v25, v20
    v_mul_f32 v21, v25, v21
    v_mul_f32 v22, v25, v22
    v_mul_f32 v23, v25, v23
    v_cvt_pk_bf16_f32 v16, v16, v17
    v_cvt_pk_bf16_f32 v17, v18, v19
    v_cvt_pk_bf16_f32 v18, v20, v21
    v_cvt_pk_bf16_f32 v19, v22, v23
    s_mov_b32 s43, 0
    buffer_store_dwordx4 v[16:19], v4, s[24:27], s43 offen offset:2048 sc1
    v_mul_f32 v56, v26, v56
    v_mul_f32 v57, v26, v57
    v_mul_f32 v58, v26, v58
    v_mul_f32 v59, v26, v59
    v_mul_f32 v60, v26, v60
    v_mul_f32 v61, v26, v61
    v_mul_f32 v62, v26, v62
    v_mul_f32 v63, v26, v63
    v_cvt_pk_bf16_f32 v56, v56, v57
    v_cvt_pk_bf16_f32 v57, v58, v59
    v_cvt_pk_bf16_f32 v58, v60, v61
    v_cvt_pk_bf16_f32 v59, v62, v63
    s_mov_b32 s43, 4096
    buffer_store_dwordx4 v[56:59], v4, s[24:27], s43 offen offset:0 sc1
    v_mul_f32 v32, v27, v32
    v_mul_f32 v33, v27, v33
    v_mul_f32 v34, v27, v34
    v_mul_f32 v35, v27, v35
    v_mul_f32 v36, v27, v36
    v_mul_f32 v37, v27, v37
    v_mul_f32 v38, v27, v38
    v_mul_f32 v39, v27, v39
    v_cvt_pk_bf16_f32 v32, v32, v33
    v_cvt_pk_bf16_f32 v33, v34, v35
    v_cvt_pk_bf16_f32 v34, v36, v37
    v_cvt_pk_bf16_f32 v35, v38, v39
    s_mov_b32 s43, 4096
    buffer_store_dwordx4 v[32:35], v4, s[24:27], s43 offen offset:2048 sc1
    v_add_u32 v31, s99, v0
    ds_read_b128 a[64:67], v31
    ds_read_b128 a[68:71], v31 offset:1024
    s_xor_b32 s99, s31, 0
    s_lshl_b32 s99, s99, 12
    s_xor_b32 s98, s30, 1
    s_lshl_b32 s98, s98, 11
    s_add_u32 s99, s99, s98
    s_add_u32 s99, s99, 155648
    v_add_u32 v31, s99, v0
    ds_read_b128 a[72:75], v31
    ds_read_b128 a[76:79], v31 offset:1024
    s_waitcnt lgkmcnt(8)
    v_mfma_f32_16x16x32_bf16 v[160:163], a[224:227], v[64:67], 0
    s_add_u32 m0, s29, 98304
    s_mov_b32 s34, 384
    buffer_load_dwordx4 v29, s[20:23], s34 offen offset:0 nt lds
    v_mfma_f32_16x16x32_bf16 v[168:171], a[224:227], v[80:83], 0
    s_xor_b32 s99, s31, 1
    s_lshl_b32 s99, s99, 12
    s_xor_b32 s98, s30, 0
    v_mfma_f32_16x16x32_bf16 v[176:179], a[224:227], v[96:99], 0
    s_lshl_b32 s98, s98, 11
    s_add_u32 s99, s99, s98
    s_add_u32 s99, s99, 155648
    v_mfma_f32_16x16x32_bf16 v[184:187], a[224:227], v[112:115], 0
    s_waitcnt lgkmcnt(6)
    ds_read_b64_tr_b16 a[236:237], v43 offset:32768
    ds_read_b64_tr_b16 a[238:239], v43 offset:34816
    v_mfma_f32_16x16x32_bf16 v[164:167], a[228:231], v[64:67], 0
    s_mov_b32 s34, 6528
    buffer_load_dwordx4 v29, s[20:23], s34 offen offset:1024 nt lds
    v_mfma_f32_16x16x32_bf16 v[172:175], a[228:231], v[80:83], 0
    ds_read_b64_tr_b16 a[240:241], v44 offset:32768
    ds_read_b64_tr_b16 a[242:243], v44 offset:34816
    v_mfma_f32_16x16x32_bf16 v[180:183], a[228:231], v[96:99], 0
    v_add_u32 v31, s99, v0
    ds_read_b128 a[80:83], v31
    v_mfma_f32_16x16x32_bf16 v[188:191], a[228:231], v[112:115], 0
    s_waitcnt lgkmcnt(8)
    ds_read_b128 a[84:87], v31 offset:1024
    v_mul_f32 v128, v24, v128
    v_mfma_f32_16x16x32_bf16 v[232:235], a[228:231], a[64:67], 0
    s_mov_b32 s34, 12672
    buffer_load_dwordx4 v29, s[20:23], s34 offen offset:2048 nt lds
    v_mul_f32 v129, v24, v129
    v_mfma_f32_16x16x32_bf16 v[224:227], a[96:99], a[64:67], 0
    s_xor_b32 s99, s31, 1
    s_lshl_b32 s99, s99, 12
    s_xor_b32 s98, s30, 1
    v_mfma_f32_16x16x32_bf16 v[228:231], a[128:131], a[64:67], 0
    s_lshl_b32 s98, s98, 11
    s_add_u32 s99, s99, s98
    s_add_u32 s99, s99, 155648
    v_mfma_f32_16x16x32_bf16 v[160:163], a[232:235], v[68:71], v[160:163]
    ds_read_b64_tr_b16 a[244:245], v45 offset:32768
    ds_read_b64_tr_b16 a[246:247], v45 offset:34816
    v_mfma_f32_16x16x32_bf16 v[168:171], a[232:235], v[84:87], v[168:171]
    s_mov_b32 s34, 18816
    buffer_load_dwordx4 v29, s[20:23], s34 offen offset:3072 nt lds
    v_mul_f32 v130, v24, v130
    v_mfma_f32_16x16x32_bf16 v[176:179], a[232:235], v[100:103], v[176:179]
    v_add_u32 v31, s99, v0
    ds_read_b128 a[88:91], v31
    v_mfma_f32_16x16x32_bf16 v[184:187], a[232:235], v[116:119], v[184:187]
    s_waitcnt lgkmcnt(7)
    ds_read_b128 a[92:95], v31 offset:1024
    v_mul_f32 v131, v24, v131
    v_mfma_f32_16x16x32_bf16 v[164:167], a[236:239], v[68:71], v[164:167]
    ds_read_b64_tr_b16 a[248:249], v46 offset:32768
    ds_read_b64_tr_b16 a[250:251], v46 offset:34816
    v_mfma_f32_16x16x32_bf16 v[172:175], a[236:239], v[84:87], v[172:175]
    s_add_u32 m0, s29, 114688
    s_mov_b32 s34, 115072
    buffer_load_dwordx4 v29, s[20:23], s34 offen offset:0 nt lds
    v_mfma_f32_16x16x32_bf16 v[180:183], a[236:239], v[100:103], v[180:183]
    v_mul_f32 v132, v24, v132
    v_mul_f32 v133, v24, v133
    v_mfma_f32_16x16x32_bf16 v[188:191], a[236:239], v[116:119], v[188:191]
    v_mul_f32 v134, v24, v134
    v_mul_f32 v135, v24, v135
    v_mfma_f32_16x16x32_bf16 v[232:235], a[236:239], a[68:71], v[232:235]
    v_cvt_pk_bf16_f32 v128, v128, v129
    v_cvt_pk_bf16_f32 v129, v130, v131
    v_mfma_f32_16x16x32_bf16 v[224:227], a[100:103], a[68:71], v[224:227]
    s_mov_b32 s34, 121216
    buffer_load_dwordx4 v29, s[20:23], s34 offen offset:1024 nt lds
    v_cvt_pk_bf16_f32 v130, v132, v133
    v_mfma_f32_16x16x32_bf16 v[228:231], a[132:135], a[68:71], v[228:231]
    s_waitcnt lgkmcnt(8)
    v_cvt_pk_bf16_f32 v131, v134, v135
    v_mfma_f32_16x16x32_bf16 v[160:163], a[240:243], v[72:75], v[160:163]
    s_mov_b32 s43, 16384
    buffer_store_dwordx4 v[128:131], v4, s[24:27], s43 offen offset:0 sc1
    v_mul_f32 v136, v25, v136
    v_mfma_f32_16x16x32_bf16 v[168:171], a[240:243], v[88:91], v[168:171]
    ds_read_b64_tr_b16 a[252:253], v47 offset:32768
    ds_read_b64_tr_b16 a[254:255], v47 offset:34816
    v_mfma_f32_16x16x32_bf16 v[176:179], a[240:243], v[104:107], v[176:179]
    s_mov_b32 s34, 127360
    buffer_load_dwordx4 v29, s[20:23], s34 offen offset:2048 nt lds
    v_mul_f32 v137, v25, v137
    v_mfma_f32_16x16x32_bf16 v[184:187], a[240:243], v[120:123], v[184:187]
    s_waitcnt lgkmcnt(6)
    v_mul_f32 v138, v25, v138
    v_mul_f32 v139, v25, v139
    v_mfma_f32_16x16x32_bf16 v[164:167], a[244:247], v[72:75], v[164:167]
    ds_read_b64_tr_b16 a[224:225], v48 offset:32768
    ds_read_b64_tr_b16 a[226:227], v48 offset:34816
    v_mfma_f32_16x16x32_bf16 v[172:175], a[244:247], v[88:91], v[172:175]
    v_mul_f32 v140, v25, v140
    v_mul_f32 v141, v25, v141
    v_mfma_f32_16x16x32_bf16 v[180:183], a[244:247], v[104:107], v[180:183]
    s_mov_b32 s34, 133504
    buffer_load_dwordx4 v29, s[20:23], s34 offen offset:3072 nt lds
    v_mul_f32 v142, v25, v142
    v_mfma_f32_16x16x32_bf16 v[188:191], a[244:247], v[120:123], v[188:191]
    v_mul_f32 v143, v25, v143
    v_cvt_pk_bf16_f32 v136, v136, v137
    v_mfma_f32_16x16x32_bf16 v[232:235], a[244:247], a[72:75], v[232:235]
    s_load_dwordx2 s[12:13], s[0:1], 88
    s_load_dwordx2 s[14:15], s[0:1], 96
    s_waitcnt lgkmcnt(0)
    v_mfma_f32_16x16x32_bf16 v[224:227], a[104:107], a[72:75], v[224:227]
    s_lshr_b32 s99, s3, 4
    s_lshl_b32 s99, s99, 11
    s_add_u32 s99, s99, 33554432
    v_mfma_f32_16x16x32_bf16 v[228:231], a[136:139], a[72:75], v[228:231]
    s_add_u32 s14, s14, s99
    s_addc_u32 s15, s15, 0
    v_cvt_pk_bf16_f32 v137, v138, v139
    v_mfma_f32_16x16x32_bf16 v[160:163], a[248:251], v[76:79], v[160:163]
    s_and_b32 s99, s3, 15
    s_lshl_b32 s99, s99, 7
    v_lshrrev_b32 v1, 1, v0
    v_mfma_f32_16x16x32_bf16 v[168:171], a[248:251], v[92:95], v[168:171]
    ds_read_b64_tr_b16 a[228:229], v49 offset:32768
    ds_read_b64_tr_b16 a[230:231], v49 offset:34816
    v_mfma_f32_16x16x32_bf16 v[176:179], a[248:251], v[108:111], v[176:179]
    v_add_u32 v1, s99, v1
    v_mov_b32 v2, 0
    v_mfma_f32_16x16x32_bf16 v[184:187], a[248:251], v[124:127], v[184:187]
    v_mov_b32 v3, 0
    v_cvt_pk_bf16_f32 v138, v140, v141
    v_mfma_f32_16x16x32_bf16 v[164:167], a[252:255], v[76:79], v[164:167]
    ds_read_b64_tr_b16 a[232:233], v50 offset:32768
    ds_read_b64_tr_b16 a[234:235], v50 offset:34816
    v_mfma_f32_16x16x32_bf16 v[172:175], a[252:255], v[92:95], v[172:175]
    v_cvt_pk_bf16_f32 v139, v142, v143
    v_mfma_f32_16x16x32_bf16 v[180:183], a[252:255], v[108:111], v[180:183]
    s_mov_b32 s43, 16384
    buffer_store_dwordx4 v[136:139], v4, s[24:27], s43 offen offset:2048 sc1
    v_mul_f32 v144, v26, v144
    v_mfma_f32_16x16x32_bf16 v[188:191], a[252:255], v[124:127], v[188:191]
    s_add_u32 m0, s29, 65536
    s_mov_b32 s34, 512
    buffer_load_dwordx4 v29, s[20:23], s34 offen offset:0 nt lds
    v_mfma_f32_16x16x32_bf16 v[232:235], a[252:255], a[76:79], v[232:235]
    v_mul_f32 v145, v26, v145
    v_mul_f32 v146, v26, v146
    v_mfma_f32_16x16x32_bf16 v[224:227], a[108:111], a[76:79], v[224:227]
    v_mul_f32 v147, v26, v147
    v_mul_f32 v148, v26, v148
    v_mfma_f32_16x16x32_bf16 v[228:231], a[140:143], a[76:79], v[228:231]
    v_mul_f32 v149, v26, v149
    v_mul_f32 v150, v26, v150
    v_mfma_f32_16x16x32_bf16 v[160:163], a[224:227], a[0:3], v[160:163]
    ds_read_b64_tr_b16 a[236:237], v51 offset:32768
    ds_read_b64_tr_b16 a[238:239], v51 offset:34816
    v_mfma_f32_16x16x32_bf16 v[168:171], a[224:227], a[16:19], v[168:171]
    v_mul_f32 v151, v26, v151
    v_cvt_pk_bf16_f32 v144, v144, v145
    v_mfma_f32_16x16x32_bf16 v[176:179], a[224:227], a[32:35], v[176:179]
    v_cvt_pk_bf16_f32 v145, v146, v147
    v_cvt_pk_bf16_f32 v146, v148, v149
    v_mfma_f32_16x16x32_bf16 v[184:187], a[224:227], a[48:51], v[184:187]
    s_waitcnt lgkmcnt(4)
    s_mov_b32 s34, 6656
    buffer_load_dwordx4 v29, s[20:23], s34 offen offset:1024 nt lds
    v_mfma_f32_16x16x32_bf16 v[164:167], a[228:231], a[0:3], v[164:167]
    ds_read_b64_tr_b16 a[240:241], v52 offset:32768
    ds_read_b64_tr_b16 a[242:243], v52 offset:34816
    v_mfma_f32_16x16x32_bf16 v[172:175], a[228:231], a[16:19], v[172:175]
    v_cvt_pk_bf16_f32 v147, v150, v151
    v_mfma_f32_16x16x32_bf16 v[180:183], a[228:231], a[32:35], v[180:183]
    s_mov_b32 s43, 20480
    buffer_store_dwordx4 v[144:147], v4, s[24:27], s43 offen offset:0 sc1
    v_mul_f32 v152, v27, v152
    v_mfma_f32_16x16x32_bf16 v[188:191], a[228:231], a[48:51], v[188:191]
    v_mul_f32 v153, v27, v153
    v_mul_f32 v154, v27, v154
    v_mfma_f32_16x16x32_bf16 v[232:235], a[228:231], a[80:83], v[232:235]
    v_mul_f32 v155, v27, v155
    v_mul_f32 v156, v27, v156
    v_mfma_f32_16x16x32_bf16 v[224:227], a[112:115], a[80:83], v[224:227]
    v_mul_f32 v157, v27, v157
    v_mul_f32 v158, v27, v158
    v_mfma_f32_16x16x32_bf16 v[228:231], a[144:147], a[80:83], v[228:231]
    s_waitcnt lgkmcnt(4)
    s_mov_b32 s34, 12800
    buffer_load_dwordx4 v29, s[20:23], s34 offen offset:2048 nt lds
    v_mfma_f32_16x16x32_bf16 v[160:163], a[232:235], a[4:7], v[160:163]
    ds_read_b64_tr_b16 a[244:245], v53 offset:32768
    ds_read_b64_tr_b16 a[246:247], v53 offset:34816
    v_mfma_f32_16x16x32_bf16 v[168:171], a[232:235], a[20:23], v[168:171]
    v_mul_f32 v159, v27, v159
    v_cvt_pk_bf16_f32 v152, v152, v153
    v_mfma_f32_16x16x32_bf16 v[176:179], a[232:235], a[36:39], v[176:179]
    v_cvt_pk_bf16_f32 v153, v154, v155
    v_cvt_pk_bf16_f32 v154, v156, v157
    v_mfma_f32_16x16x32_bf16 v[184:187], a[232:235], a[52:55], v[184:187]
    s_waitcnt lgkmcnt(4)
    v_cvt_pk_bf16_f32 v155, v158, v159
    v_mfma_f32_16x16x32_bf16 v[164:167], a[236:239], a[4:7], v[164:167]
    s_mov_b32 s43, 20480
    buffer_store_dwordx4 v[152:155], v4, s[24:27], s43 offen offset:2048 sc1
    v_mfma_f32_16x16x32_bf16 v[172:175], a[236:239], a[20:23], v[172:175]
    ds_read_b64_tr_b16 a[248:249], v54 offset:32768
    ds_read_b64_tr_b16 a[250:251], v54 offset:34816
    v_mfma_f32_16x16x32_bf16 v[180:183], a[236:239], a[36:39], v[180:183]
    s_mov_b32 s34, 18944
    buffer_load_dwordx4 v29, s[20:23], s34 offen offset:3072 nt lds
    v_mfma_f32_16x16x32_bf16 v[188:191], a[236:239], a[52:55], v[188:191]
    v_mfma_f32_16x16x32_bf16 v[232:235], a[236:239], a[84:87], v[232:235]
    v_mfma_f32_16x16x32_bf16 v[224:227], a[116:119], a[84:87], v[224:227]
    v_mfma_f32_16x16x32_bf16 v[228:231], a[148:151], a[84:87], v[228:231]
    s_waitcnt lgkmcnt(4)
    v_mfma_f32_16x16x32_bf16 v[160:163], a[240:243], a[8:11], v[160:163]
    ds_read_b64_tr_b16 a[252:253], v55 offset:32768
    ds_read_b64_tr_b16 a[254:255], v55 offset:34816
    v_mfma_f32_16x16x32_bf16 v[168:171], a[240:243], a[24:27], v[168:171]
    v_mfma_f32_16x16x32_bf16 v[176:179], a[240:243], a[40:43], v[176:179]
    v_mfma_f32_16x16x32_bf16 v[184:187], a[240:243], a[56:59], v[184:187]
    s_waitcnt lgkmcnt(4)
    v_mfma_f32_16x16x32_bf16 v[164:167], a[244:247], a[8:11], v[164:167]
    v_mfma_f32_16x16x32_bf16 v[172:175], a[244:247], a[24:27], v[172:175]
    v_mfma_f32_16x16x32_bf16 v[180:183], a[244:247], a[40:43], v[180:183]
    v_mfma_f32_16x16x32_bf16 v[188:191], a[244:247], a[56:59], v[188:191]
    v_mfma_f32_16x16x32_bf16 v[232:235], a[244:247], a[88:91], v[232:235]
    v_mfma_f32_16x16x32_bf16 v[224:227], a[120:123], a[88:91], v[224:227]
    v_mfma_f32_16x16x32_bf16 v[228:231], a[152:155], a[88:91], v[228:231]
    s_waitcnt lgkmcnt(2)
    v_mfma_f32_16x16x32_bf16 v[160:163], a[248:251], a[12:15], v[160:163]
    s_waitcnt lgkmcnt(0)
    s_waitcnt vmcnt(7)
    s_barrier
    v_mfma_f32_16x16x32_bf16 v[168:171], a[248:251], a[28:31], v[168:171]
    v_add_u32 v40, 0x10000, v40
    ds_read_b64_tr_b16 a[224:225], v40 offset:32768
    ds_read_b64_tr_b16 a[226:227], v40 offset:34816
    v_mfma_f32_16x16x32_bf16 v[176:179], a[248:251], a[44:47], v[176:179]
    v_add_u32 v41, 0x10000, v41
    ds_read_b64_tr_b16 a[228:229], v41 offset:32768
    ds_read_b64_tr_b16 a[230:231], v41 offset:34816
    v_mfma_f32_16x16x32_bf16 v[184:187], a[248:251], a[60:63], v[184:187]
    v_add_u32 v42, 0x10000, v42
    ds_read_b64_tr_b16 a[232:233], v42 offset:32768
    ds_read_b64_tr_b16 a[234:235], v42 offset:34816
    v_mfma_f32_16x16x32_bf16 v[164:167], a[252:255], a[12:15], v[164:167]
    v_mfma_f32_16x16x32_bf16 v[172:175], a[252:255], a[28:31], v[172:175]
    v_mfma_f32_16x16x32_bf16 v[180:183], a[252:255], a[44:47], v[180:183]
    v_mfma_f32_16x16x32_bf16 v[188:191], a[252:255], a[60:63], v[188:191]
    v_mfma_f32_16x16x32_bf16 v[232:235], a[252:255], a[92:95], v[232:235]
    v_mfma_f32_16x16x32_bf16 v[224:227], a[124:127], a[92:95], v[224:227]
    v_mfma_f32_16x16x32_bf16 v[228:231], a[156:159], a[92:95], v[228:231]
    s_waitcnt lgkmcnt(4)
    v_mfma_f32_16x16x32_bf16 v[192:195], a[224:227], v[64:67], 0
    s_add_u32 m0, s29, 81920
    s_mov_b32 s34, 115200
    buffer_load_dwordx4 v29, s[20:23], s34 offen offset:0 nt lds
    v_mfma_f32_16x16x32_bf16 v[200:203], a[224:227], v[80:83], 0
    v_add_u32 v43, 0x10000, v43
    ds_read_b64_tr_b16 a[236:237], v43 offset:32768
    ds_read_b64_tr_b16 a[238:239], v43 offset:34816
    v_mfma_f32_16x16x32_bf16 v[208:211], a[224:227], v[96:99], 0
    v_mfma_f32_16x16x32_bf16 v[216:219], a[224:227], v[112:115], 0
    s_waitcnt lgkmcnt(4)
    v_mfma_f32_16x16x32_bf16 v[196:199], a[228:231], v[64:67], 0
    s_mov_b32 s34, 121344
    buffer_load_dwordx4 v29, s[20:23], s34 offen offset:1024 nt lds
    v_mfma_f32_16x16x32_bf16 v[204:207], a[228:231], v[80:83], 0
    v_add_u32 v44, 0x10000, v44
    ds_read_b64_tr_b16 a[240:241], v44 offset:32768
    ds_read_b64_tr_b16 a[242:243], v44 offset:34816
    v_mfma_f32_16x16x32_bf16 v[212:215], a[228:231], v[96:99], 0
    v_mul_f32 v160, v24, v160
    v_mul_f32 v161, v24, v161
    v_mfma_f32_16x16x32_bf16 v[220:223], a[228:231], v[112:115], 0
    v_mul_f32 v162, v24, v162
    v_mul_f32 v163, v24, v163
    v_mfma_f32_16x16x32_bf16 v[236:239], a[228:231], a[64:67], 0
    s_waitcnt lgkmcnt(4)
    s_mov_b32 s34, 127488
    buffer_load_dwordx4 v29, s[20:23], s34 offen offset:2048 nt lds
    v_mfma_f32_16x16x32_bf16 v[192:195], a[232:235], v[68:71], v[192:195]
    v_add_u32 v45, 0x10000, v45
    ds_read_b64_tr_b16 a[244:245], v45 offset:32768
    ds_read_b64_tr_b16 a[246:247], v45 offset:34816
    v_mfma_f32_16x16x32_bf16 v[200:203], a[232:235], v[84:87], v[200:203]
    v_mul_f32 v164, v24, v164
    v_mul_f32 v165, v24, v165
    v_mfma_f32_16x16x32_bf16 v[208:211], a[232:235], v[100:103], v[208:211]
    v_mul_f32 v166, v24, v166
    v_mul_f32 v167, v24, v167
    v_mfma_f32_16x16x32_bf16 v[216:219], a[232:235], v[116:119], v[216:219]
    s_waitcnt lgkmcnt(4)
    s_mov_b32 s34, 133632
    buffer_load_dwordx4 v29, s[20:23], s34 offen offset:3072 nt lds
    v_mfma_f32_16x16x32_bf16 v[196:199], a[236:239], v[68:71], v[196:199]
    v_add_u32 v46, 0x10000, v46
    ds_read_b64_tr_b16 a[248:249], v46 offset:32768
    ds_read_b64_tr_b16 a[250:251], v46 offset:34816
    v_mfma_f32_16x16x32_bf16 v[204:207], a[236:239], v[84:87], v[204:207]
    v_cvt_pk_bf16_f32 v160, v160, v161
    v_cvt_pk_bf16_f32 v161, v162, v163
    v_mfma_f32_16x16x32_bf16 v[212:215], a[236:239], v[100:103], v[212:215]
    v_cvt_pk_bf16_f32 v162, v164, v165
    v_cvt_pk_bf16_f32 v163, v166, v167
    v_mfma_f32_16x16x32_bf16 v[220:223], a[236:239], v[116:119], v[220:223]
    s_mov_b32 s43, 32768
    buffer_store_dwordx4 v[160:163], v4, s[24:27], s43 offen offset:0 sc1
    v_mul_f32 v168, v25, v168
    v_mfma_f32_16x16x32_bf16 v[236:239], a[236:239], a[68:71], v[236:239]
    s_waitcnt lgkmcnt(4)
    v_mul_f32 v169, v25, v169
    v_mul_f32 v170, v25, v170
    v_mfma_f32_16x16x32_bf16 v[192:195], a[240:243], v[72:75], v[192:195]
    v_add_u32 v47, 0x10000, v47
    ds_read_b64_tr_b16 a[252:253], v47 offset:32768
    ds_read_b64_tr_b16 a[254:255], v47 offset:34816
    v_mfma_f32_16x16x32_bf16 v[200:203], a[240:243], v[88:91], v[200:203]
    v_mul_f32 v171, v25, v171
    v_mul_f32 v172, v25, v172
    v_mfma_f32_16x16x32_bf16 v[208:211], a[240:243], v[104:107], v[208:211]
    v_mul_f32 v173, v25, v173
    v_mul_f32 v174, v25, v174
    v_mfma_f32_16x16x32_bf16 v[216:219], a[240:243], v[120:123], v[216:219]
    s_waitcnt lgkmcnt(4)
    v_mul_f32 v175, v25, v175
    v_cvt_pk_bf16_f32 v168, v168, v169
    v_mfma_f32_16x16x32_bf16 v[196:199], a[244:247], v[72:75], v[196:199]
    v_add_u32 v48, 0x10000, v48
    ds_read_b64_tr_b16 a[224:225], v48 offset:32768
    ds_read_b64_tr_b16 a[226:227], v48 offset:34816
    v_mfma_f32_16x16x32_bf16 v[204:207], a[244:247], v[88:91], v[204:207]
    v_cvt_pk_bf16_f32 v169, v170, v171
    v_cvt_pk_bf16_f32 v170, v172, v173
    v_mfma_f32_16x16x32_bf16 v[212:215], a[244:247], v[104:107], v[212:215]
    s_add_u32 m0, s29, 0
    s_mov_b32 s34, 640
    buffer_load_dwordx4 v29, s[20:23], s34 offen offset:0 nt lds
    v_mfma_f32_16x16x32_bf16 v[220:223], a[244:247], v[120:123], v[220:223]
    v_cvt_pk_bf16_f32 v171, v174, v175
    v_mfma_f32_16x16x32_bf16 v[236:239], a[244:247], a[72:75], v[236:239]
    s_waitcnt lgkmcnt(4)
    s_mov_b32 s43, 32768
    buffer_store_dwordx4 v[168:171], v4, s[24:27], s43 offen offset:2048 sc1
    v_mfma_f32_16x16x32_bf16 v[192:195], a[248:251], v[76:79], v[192:195]
    v_add_u32 v49, 0x10000, v49
    ds_read_b64_tr_b16 a[228:229], v49 offset:32768
    ds_read_b64_tr_b16 a[230:231], v49 offset:34816
    v_mfma_f32_16x16x32_bf16 v[200:203], a[248:251], v[92:95], v[200:203]
    v_mul_f32 v176, v26, v176
    v_mul_f32 v177, v26, v177
    v_mfma_f32_16x16x32_bf16 v[208:211], a[248:251], v[108:111], v[208:211]
    v_mul_f32 v178, v26, v178
    v_mul_f32 v179, v26, v179
    v_mfma_f32_16x16x32_bf16 v[216:219], a[248:251], v[124:127], v[216:219]
    s_waitcnt lgkmcnt(4)
    v_mul_f32 v180, v26, v180
    v_mul_f32 v181, v26, v181
    v_mfma_f32_16x16x32_bf16 v[196:199], a[252:255], v[76:79], v[196:199]
    s_mov_b32 s34, 6784
    buffer_load_dwordx4 v29, s[20:23], s34 offen offset:1024 nt lds
    v_mul_f32 v182, v26, v182
    v_mfma_f32_16x16x32_bf16 v[204:207], a[252:255], v[92:95], v[204:207]
    v_add_u32 v50, 0x10000, v50
    ds_read_b64_tr_b16 a[232:233], v50 offset:32768
    ds_read_b64_tr_b16 a[234:235], v50 offset:34816
    v_mfma_f32_16x16x32_bf16 v[212:215], a[252:255], v[108:111], v[212:215]
    v_mul_f32 v183, v26, v183
    v_cvt_pk_bf16_f32 v176, v176, v177
    v_mfma_f32_16x16x32_bf16 v[220:223], a[252:255], v[124:127], v[220:223]
    v_cvt_pk_bf16_f32 v177, v178, v179
    v_cvt_pk_bf16_f32 v178, v180, v181
    v_mfma_f32_16x16x32_bf16 v[236:239], a[252:255], a[76:79], v[236:239]
    s_waitcnt lgkmcnt(4)
    v_cvt_pk_bf16_f32 v179, v182, v183
    v_mfma_f32_16x16x32_bf16 v[192:195], a[224:227], a[0:3], v[192:195]
    s_mov_b32 s43, 36864
    buffer_store_dwordx4 v[176:179], v4, s[24:27], s43 offen offset:0 sc1
    v_mfma_f32_16x16x32_bf16 v[200:203], a[224:227], a[16:19], v[200:203]
    v_add_u32 v51, 0x10000, v51
    ds_read_b64_tr_b16 a[236:237], v51 offset:32768
    ds_read_b64_tr_b16 a[238:239], v51 offset:34816
    v_mfma_f32_16x16x32_bf16 v[208:211], a[224:227], a[32:35], v[208:211]
    s_mov_b32 s34, 12928
    buffer_load_dwordx4 v29, s[20:23], s34 offen offset:2048 nt lds
    v_mul_f32 v184, v27, v184
    v_mfma_f32_16x16x32_bf16 v[216:219], a[224:227], a[48:51], v[216:219]
    s_waitcnt lgkmcnt(4)
    v_mul_f32 v185, v27, v185
    v_mul_f32 v186, v27, v186
    v_mfma_f32_16x16x32_bf16 v[196:199], a[228:231], a[0:3], v[196:199]
    v_add_u32 v52, 0x10000, v52
    ds_read_b64_tr_b16 a[240:241], v52 offset:32768
    ds_read_b64_tr_b16 a[242:243], v52 offset:34816
    v_mfma_f32_16x16x32_bf16 v[204:207], a[228:231], a[16:19], v[204:207]
    v_mul_f32 v187, v27, v187
    v_mul_f32 v188, v27, v188
    v_mfma_f32_16x16x32_bf16 v[212:215], a[228:231], a[32:35], v[212:215]
    v_mul_f32 v189, v27, v189
    v_mul_f32 v190, v27, v190
    v_mfma_f32_16x16x32_bf16 v[220:223], a[228:231], a[48:51], v[220:223]
    v_mul_f32 v191, v27, v191
    v_cvt_pk_bf16_f32 v184, v184, v185
    v_mfma_f32_16x16x32_bf16 v[236:239], a[228:231], a[80:83], v[236:239]
    s_waitcnt lgkmcnt(4)
    v_cvt_pk_bf16_f32 v185, v186, v187
    v_cvt_pk_bf16_f32 v186, v188, v189
    v_mfma_f32_16x16x32_bf16 v[192:195], a[232:235], a[4:7], v[192:195]
    s_mov_b32 s34, 19072
    buffer_load_dwordx4 v29, s[20:23], s34 offen offset:3072 nt lds
    v_cvt_pk_bf16_f32 v187, v190, v191
    v_mfma_f32_16x16x32_bf16 v[200:203], a[232:235], a[20:23], v[200:203]
    s_mov_b32 s43, 36864
    buffer_store_dwordx4 v[184:187], v4, s[24:27], s43 offen offset:2048 sc1
    v_mfma_f32_16x16x32_bf16 v[208:211], a[232:235], a[36:39], v[208:211]
    v_add_u32 v53, 0x10000, v53
    ds_read_b64_tr_b16 a[244:245], v53 offset:32768
    ds_read_b64_tr_b16 a[246:247], v53 offset:34816
    v_mfma_f32_16x16x32_bf16 v[216:219], a[232:235], a[52:55], v[216:219]
    s_waitcnt lgkmcnt(4)
    v_mfma_f32_16x16x32_bf16 v[196:199], a[236:239], a[4:7], v[196:199]
    v_add_u32 v54, 0x10000, v54
    ds_read_b64_tr_b16 a[248:249], v54 offset:32768
    ds_read_b64_tr_b16 a[250:251], v54 offset:34816
    v_mfma_f32_16x16x32_bf16 v[204:207], a[236:239], a[20:23], v[204:207]
    v_mul_f32 v224, v28, v224
    v_mul_f32 v225, v28, v225
    v_mfma_f32_16x16x32_bf16 v[212:215], a[236:239], a[36:39], v[212:215]
    v_mul_f32 v226, v28, v226
    v_mul_f32 v227, v28, v227
    v_mfma_f32_16x16x32_bf16 v[220:223], a[236:239], a[52:55], v[220:223]
    v_cvt_pk_bf16_f32 v240, v224, v225
    v_cvt_pk_bf16_f32 v241, v226, v227
    v_mfma_f32_16x16x32_bf16 v[236:239], a[236:239], a[84:87], v[236:239]
    s_waitcnt lgkmcnt(4)
    v_mul_f32 v228, v28, v228
    v_mul_f32 v229, v28, v229
    v_mfma_f32_16x16x32_bf16 v[192:195], a[240:243], a[8:11], v[192:195]
    v_add_u32 v55, 0x10000, v55
    ds_read_b64_tr_b16 a[252:253], v55 offset:32768
    ds_read_b64_tr_b16 a[254:255], v55 offset:34816
    v_mfma_f32_16x16x32_bf16 v[200:203], a[240:243], a[24:27], v[200:203]
    v_mul_f32 v230, v28, v230
    v_mul_f32 v231, v28, v231
    v_mfma_f32_16x16x32_bf16 v[208:211], a[240:243], a[40:43], v[208:211]
    v_cvt_pk_bf16_f32 v242, v228, v229
    v_cvt_pk_bf16_f32 v243, v230, v231
    v_mfma_f32_16x16x32_bf16 v[216:219], a[240:243], a[56:59], v[216:219]
    s_waitcnt lgkmcnt(4)
    s_mov_b32 s43, 114688
    buffer_store_dwordx4 v[240:243], v5, s[24:27], s43 offen sc1
    v_mfma_f32_16x16x32_bf16 v[196:199], a[244:247], a[8:11], v[196:199]
    v_mul_f32 v232, v28, v232
    v_mul_f32 v233, v28, v233
    v_mfma_f32_16x16x32_bf16 v[204:207], a[244:247], a[24:27], v[204:207]
    v_mul_f32 v234, v28, v234
    v_mul_f32 v235, v28, v235
    v_mfma_f32_16x16x32_bf16 v[212:215], a[244:247], a[40:43], v[212:215]
    v_cvt_pk_bf16_f32 v240, v232, v233
    v_cvt_pk_bf16_f32 v241, v234, v235
    v_mfma_f32_16x16x32_bf16 v[220:223], a[244:247], a[56:59], v[220:223]
    s_waitcnt lgkmcnt(0)
    s_waitcnt vmcnt(9)
    s_barrier
    s_cmp_lg_u32 s28, 0
    s_cbranch_scc1 L_nopub0
    s_mov_b64 exec, 0x3
    v_mov_b32 v2, s96
    v_mov_b32 v3, s97
    s_mov_b64 exec, 0xffff
    global_store_dwordx2 v1, v[2:3], s[14:15] sc1
    s_mov_b64 exec, -1
L_nopub0:
    v_mfma_f32_16x16x32_bf16 v[236:239], a[244:247], a[88:91], v[236:239]
    ds_read_b64_tr_b16 a[224:225], v40 offset:0
    ds_read_b64_tr_b16 a[226:227], v40 offset:2048
    v_mfma_f32_16x16x32_bf16 v[192:195], a[248:251], a[12:15], v[192:195]
    ds_read_b64_tr_b16 a[228:229], v41 offset:0
    ds_read_b64_tr_b16 a[230:231], v41 offset:2048
    v_mfma_f32_16x16x32_bf16 v[200:203], a[248:251], a[28:31], v[200:203]
    ds_read_b64_tr_b16 a[232:233], v42 offset:0
    ds_read_b64_tr_b16 a[234:235], v42 offset:2048
    v_mfma_f32_16x16x32_bf16 v[208:211], a[248:251], a[44:47], v[208:211]
    v_mfma_f32_16x16x32_bf16 v[216:219], a[248:251], a[60:63], v[216:219]
    v_mfma_f32_16x16x32_bf16 v[196:199], a[252:255], a[12:15], v[196:199]
    v_mfma_f32_16x16x32_bf16 v[204:207], a[252:255], a[28:31], v[204:207]
    v_mfma_f32_16x16x32_bf16 v[212:215], a[252:255], a[44:47], v[212:215]
    v_mfma_f32_16x16x32_bf16 v[220:223], a[252:255], a[60:63], v[220:223]
    v_mfma_f32_16x16x32_bf16 v[236:239], a[252:255], a[92:95], v[236:239]
    s_waitcnt lgkmcnt(4)
    v_mfma_f32_16x16x32_bf16 v[128:131], a[224:227], v[64:67], 0
    s_add_u32 m0, s29, 16384
    s_mov_b32 s34, 115328
    buffer_load_dwordx4 v29, s[20:23], s34 offen offset:0 nt lds
    v_mfma_f32_16x16x32_bf16 v[136:139], a[224:227], v[80:83], 0
    ds_read_b64_tr_b16 a[236:237], v43 offset:0
    ds_read_b64_tr_b16 a[238:239], v43 offset:2048
    v_mfma_f32_16x16x32_bf16 v[144:147], a[224:227], v[96:99], 0
    v_mfma_f32_16x16x32_bf16 v[152:155], a[224:227], v[112:115], 0
    s_waitcnt lgkmcnt(4)
    v_mfma_f32_16x16x32_bf16 v[132:135], a[228:231], v[64:67], 0
    s_mov_b32 s34, 121472
    buffer_load_dwordx4 v29, s[20:23], s34 offen offset:1024 nt lds
    v_mfma_f32_16x16x32_bf16 v[140:143], a[228:231], v[80:83], 0
    ds_read_b64_tr_b16 a[240:241], v44 offset:0
    ds_read_b64_tr_b16 a[242:243], v44 offset:2048
    v_mfma_f32_16x16x32_bf16 v[148:151], a[228:231], v[96:99], 0
    v_mul_f32 v192, v24, v192
    v_mul_f32 v193, v24, v193
    v_mfma_f32_16x16x32_bf16 v[156:159], a[228:231], v[112:115], 0
    v_mul_f32 v194, v24, v194
    v_mul_f32 v195, v24, v195
    v_mfma_f32_16x16x32_bf16 v[224:227], a[228:231], a[64:67], 0
    s_waitcnt lgkmcnt(4)
    s_mov_b32 s34, 127616
    buffer_load_dwordx4 v29, s[20:23], s34 offen offset:2048 nt lds
    v_mfma_f32_16x16x32_bf16 v[128:131], a[232:235], v[68:71], v[128:131]
    ds_read_b64_tr_b16 a[244:245], v45 offset:0
    ds_read_b64_tr_b16 a[246:247], v45 offset:2048
    v_mfma_f32_16x16x32_bf16 v[136:139], a[232:235], v[84:87], v[136:139]
    v_mul_f32 v196, v24, v196
    v_mul_f32 v197, v24, v197
    v_mfma_f32_16x16x32_bf16 v[144:147], a[232:235], v[100:103], v[144:147]
    v_mul_f32 v198, v24, v198
    v_mul_f32 v199, v24, v199
    v_mfma_f32_16x16x32_bf16 v[152:155], a[232:235], v[116:119], v[152:155]
    s_waitcnt lgkmcnt(4)
    s_mov_b32 s34, 133760
    buffer_load_dwordx4 v29, s[20:23], s34 offen offset:3072 nt lds
    v_mfma_f32_16x16x32_bf16 v[132:135], a[236:239], v[68:71], v[132:135]
    ds_read_b64_tr_b16 a[248:249], v46 offset:0
    ds_read_b64_tr_b16 a[250:251], v46 offset:2048
    v_mfma_f32_16x16x32_bf16 v[140:143], a[236:239], v[84:87], v[140:143]
    v_cvt_pk_bf16_f32 v192, v192, v193
    v_cvt_pk_bf16_f32 v193, v194, v195
    v_mfma_f32_16x16x32_bf16 v[148:151], a[236:239], v[100:103], v[148:151]
    v_cvt_pk_bf16_f32 v194, v196, v197
    v_cvt_pk_bf16_f32 v195, v198, v199
    v_mfma_f32_16x16x32_bf16 v[156:159], a[236:239], v[116:119], v[156:159]
    s_mov_b32 s43, 49152
    buffer_store_dwordx4 v[192:195], v4, s[24:27], s43 offen offset:0 sc1
    v_mul_f32 v200, v25, v200
    v_mfma_f32_16x16x32_bf16 v[224:227], a[236:239], a[68:71], v[224:227]
    s_waitcnt lgkmcnt(4)
    v_mul_f32 v201, v25, v201
    v_mul_f32 v202, v25, v202
    v_mfma_f32_16x16x32_bf16 v[128:131], a[240:243], v[72:75], v[128:131]
    ds_read_b64_tr_b16 a[252:253], v47 offset:0
    ds_read_b64_tr_b16 a[254:255], v47 offset:2048
    v_mfma_f32_16x16x32_bf16 v[136:139], a[240:243], v[88:91], v[136:139]
    v_mul_f32 v203, v25, v203
    v_mul_f32 v204, v25, v204
    v_mfma_f32_16x16x32_bf16 v[144:147], a[240:243], v[104:107], v[144:147]
    v_mul_f32 v205, v25, v205
    v_mul_f32 v206, v25, v206
    v_mfma_f32_16x16x32_bf16 v[152:155], a[240:243], v[120:123], v[152:155]
    s_waitcnt lgkmcnt(4)
    v_mul_f32 v207, v25, v207
    v_cvt_pk_bf16_f32 v200, v200, v201
    v_mfma_f32_16x16x32_bf16 v[132:135], a[244:247], v[72:75], v[132:135]
    ds_read_b64_tr_b16 a[224:225], v48 offset:0
    ds_read_b64_tr_b16 a[226:227], v48 offset:2048
    v_mfma_f32_16x16x32_bf16 v[140:143], a[244:247], v[88:91], v[140:143]
    v_cvt_pk_bf16_f32 v201, v202, v203
    v_cvt_pk_bf16_f32 v202, v204, v205
    v_mfma_f32_16x16x32_bf16 v[148:151], a[244:247], v[104:107], v[148:151]
    s_add_u32 m0, s29, 32768
    s_mov_b32 s34, 768
    buffer_load_dwordx4 v29, s[20:23], s34 offen offset:0 nt lds
    v_mfma_f32_16x16x32_bf16 v[156:159], a[244:247], v[120:123], v[156:159]
    v_cvt_pk_bf16_f32 v203, v206, v207
    v_mfma_f32_16x16x32_bf16 v[224:227], a[244:247], a[72:75], v[224:227]
    s_waitcnt lgkmcnt(4)
    s_mov_b32 s43, 49152
    buffer_store_dwordx4 v[200:203], v4, s[24:27], s43 offen offset:2048 sc1
    v_mfma_f32_16x16x32_bf16 v[128:131], a[248:251], v[76:79], v[128:131]
    ds_read_b64_tr_b16 a[228:229], v49 offset:0
    ds_read_b64_tr_b16 a[230:231], v49 offset:2048
    v_mfma_f32_16x16x32_bf16 v[136:139], a[248:251], v[92:95], v[136:139]
    v_mul_f32 v208, v26, v208
    v_mul_f32 v209, v26, v209
    v_mfma_f32_16x16x32_bf16 v[144:147], a[248:251], v[108:111], v[144:147]
    v_mul_f32 v210, v26, v210
    v_mul_f32 v211, v26, v211
    v_mfma_f32_16x16x32_bf16 v[152:155], a[248:251], v[124:127], v[152:155]
    s_waitcnt lgkmcnt(4)
    v_mul_f32 v212, v26, v212
    v_mul_f32 v213, v26, v213
    v_mfma_f32_16x16x32_bf16 v[132:135], a[252:255], v[76:79], v[132:135]
    s_mov_b32 s34, 6912
    buffer_load_dwordx4 v29, s[20:23], s34 offen offset:1024 nt lds
    v_mul_f32 v214, v26, v214
    v_mfma_f32_16x16x32_bf16 v[140:143], a[252:255], v[92:95], v[140:143]
    ds_read_b64_tr_b16 a[232:233], v50 offset:0
    ds_read_b64_tr_b16 a[234:235], v50 offset:2048
    v_mfma_f32_16x16x32_bf16 v[148:151], a[252:255], v[108:111], v[148:151]
    v_mul_f32 v215, v26, v215
    v_cvt_pk_bf16_f32 v208, v208, v209
    v_mfma_f32_16x16x32_bf16 v[156:159], a[252:255], v[124:127], v[156:159]
    v_cvt_pk_bf16_f32 v209, v210, v211
    v_cvt_pk_bf16_f32 v210, v212, v213
    v_mfma_f32_16x16x32_bf16 v[224:227], a[252:255], a[76:79], v[224:227]
    s_waitcnt lgkmcnt(4)
    v_cvt_pk_bf16_f32 v211, v214, v215
    v_mfma_f32_16x16x32_bf16 v[128:131], a[224:227], a[0:3], v[128:131]
    s_mov_b32 s43, 53248
    buffer_store_dwordx4 v[208:211], v4, s[24:27], s43 offen offset:0 sc1
    v_mfma_f32_16x16x32_bf16 v[136:139], a[224:227], a[16:19], v[136:139]
    ds_read_b64_tr_b16 a[236:237], v51 offset:0
    ds_read_b64_tr_b16 a[238:239], v51 offset:2048
    v_mfma_f32_16x16x32_bf16 v[144:147], a[224:227], a[32:35], v[144:147]
    s_mov_b32 s34, 13056
    buffer_load_dwordx4 v29, s[20:23], s34 offen offset:2048 nt lds
    v_mul_f32 v216, v27, v216
    v_mfma_f32_16x16x32_bf16 v[152:155], a[224:227], a[48:51], v[152:155]
    s_waitcnt lgkmcnt(4)
    v_mul_f32 v217, v27, v217
    v_mul_f32 v218, v27, v218
    v_mfma_f32_16x16x32_bf16 v[132:135], a[228:231], a[0:3], v[132:135]
    ds_read_b64_tr_b16 a[240:241], v52 offset:0
    ds_read_b64_tr_b16 a[242:243], v52 offset:2048
    v_mfma_f32_16x16x32_bf16 v[140:143], a[228:231], a[16:19], v[140:143]
    v_mul_f32 v219, v27, v219
    v_mul_f32 v220, v27, v220
    v_mfma_f32_16x16x32_bf16 v[148:151], a[228:231], a[32:35], v[148:151]
    v_mul_f32 v221, v27, v221
    v_mul_f32 v222, v27, v222
    v_mfma_f32_16x16x32_bf16 v[156:159], a[228:231], a[48:51], v[156:159]
    v_mul_f32 v223, v27, v223
    v_cvt_pk_bf16_f32 v216, v216, v217
    v_mfma_f32_16x16x32_bf16 v[224:227], a[228:231], a[80:83], v[224:227]
    s_waitcnt lgkmcnt(4)
    v_cvt_pk_bf16_f32 v217, v218, v219
    v_cvt_pk_bf16_f32 v218, v220, v221
    v_mfma_f32_16x16x32_bf16 v[128:131], a[232:235], a[4:7], v[128:131]
    s_mov_b32 s34, 19200
    buffer_load_dwordx4 v29, s[20:23], s34 offen offset:3072 nt lds
    v_cvt_pk_bf16_f32 v219, v222, v223
    v_mfma_f32_16x16x32_bf16 v[136:139], a[232:235], a[20:23], v[136:139]
    s_mov_b32 s43, 53248
    buffer_store_dwordx4 v[216:219], v4, s[24:27], s43 offen offset:2048 sc1
    v_mfma_f32_16x16x32_bf16 v[144:147], a[232:235], a[36:39], v[144:147]
    ds_read_b64_tr_b16 a[244:245], v53 offset:0
    ds_read_b64_tr_b16 a[246:247], v53 offset:2048
    v_mfma_f32_16x16x32_bf16 v[152:155], a[232:235], a[52:55], v[152:155]
    s_waitcnt lgkmcnt(4)
    v_mfma_f32_16x16x32_bf16 v[132:135], a[236:239], a[4:7], v[132:135]
    ds_read_b64_tr_b16 a[248:249], v54 offset:0
    ds_read_b64_tr_b16 a[250:251], v54 offset:2048
    v_mfma_f32_16x16x32_bf16 v[140:143], a[236:239], a[20:23], v[140:143]
    v_mul_f32 v236, v28, v236
    v_mul_f32 v237, v28, v237
    v_mfma_f32_16x16x32_bf16 v[148:151], a[236:239], a[36:39], v[148:151]
    v_mul_f32 v238, v28, v238
    v_mul_f32 v239, v28, v239
    v_mfma_f32_16x16x32_bf16 v[156:159], a[236:239], a[52:55], v[156:159]
    v_cvt_pk_bf16_f32 v242, v236, v237
    v_cvt_pk_bf16_f32 v243, v238, v239
    v_mfma_f32_16x16x32_bf16 v[224:227], a[236:239], a[84:87], v[224:227]
    s_waitcnt lgkmcnt(4)
    s_mov_b32 s43, 118784
    buffer_store_dwordx4 v[240:243], v5, s[24:27], s43 offen sc1
    v_mfma_f32_16x16x32_bf16 v[128:131], a[240:243], a[8:11], v[128:131]
    ds_read_b64_tr_b16 a[252:253], v55 offset:0
    ds_read_b64_tr_b16 a[254:255], v55 offset:2048
    v_mfma_f32_16x16x32_bf16 v[136:139], a[240:243], a[24:27], v[136:139]
    v_mfma_f32_16x16x32_bf16 v[144:147], a[240:243], a[40:43], v[144:147]
    v_mfma_f32_16x16x32_bf16 v[152:155], a[240:243], a[56:59], v[152:155]
    s_waitcnt lgkmcnt(4)
    v_mfma_f32_16x16x32_bf16 v[132:135], a[244:247], a[8:11], v[132:135]
    v_mfma_f32_16x16x32_bf16 v[140:143], a[244:247], a[24:27], v[140:143]
    v_mfma_f32_16x16x32_bf16 v[148:151], a[244:247], a[40:43], v[148:151]
    v_mfma_f32_16x16x32_bf16 v[156:159], a[244:247], a[56:59], v[156:159]
    s_waitcnt lgkmcnt(0)
    s_waitcnt vmcnt(9)
    s_barrier
    s_cmp_lg_u32 s28, 0
    s_cbranch_scc1 L_nopub1
    s_mov_b64 exec, 0x7
    v_mov_b32 v2, s96
    v_mov_b32 v3, s97
    s_mov_b64 exec, 0xffff
    global_store_dwordx2 v1, v[2:3], s[14:15] sc1
    s_mov_b64 exec, -1
L_nopub1:
    v_mfma_f32_16x16x32_bf16 v[224:227], a[244:247], a[88:91], v[224:227]
    v_add_u32 v40, 0xffff0000, v40
    ds_read_b64_tr_b16 a[224:225], v40 offset:0
    ds_read_b64_tr_b16 a[226:227], v40 offset:2048
    v_mfma_f32_16x16x32_bf16 v[128:131], a[248:251], a[12:15], v[128:131]
    v_add_u32 v41, 0xffff0000, v41
    ds_read_b64_tr_b16 a[228:229], v41 offset:0
    ds_read_b64_tr_b16 a[230:231], v41 offset:2048
    v_mfma_f32_16x16x32_bf16 v[136:139], a[248:251], a[28:31], v[136:139]
    v_add_u32 v42, 0xffff0000, v42
    ds_read_b64_tr_b16 a[232:233], v42 offset:0
    ds_read_b64_tr_b16 a[234:235], v42 offset:2048
    v_mfma_f32_16x16x32_bf16 v[144:147], a[248:251], a[44:47], v[144:147]
    v_mfma_f32_16x16x32_bf16 v[152:155], a[248:251], a[60:63], v[152:155]
    v_mfma_f32_16x16x32_bf16 v[132:135], a[252:255], a[12:15], v[132:135]
    v_mfma_f32_16x16x32_bf16 v[140:143], a[252:255], a[28:31], v[140:143]
    v_mfma_f32_16x16x32_bf16 v[148:151], a[252:255], a[44:47], v[148:151]
    v_mfma_f32_16x16x32_bf16 v[156:159], a[252:255], a[60:63], v[156:159]
    v_mfma_f32_16x16x32_bf16 v[224:227], a[252:255], a[92:95], v[224:227]
    s_waitcnt lgkmcnt(4)
    v_mfma_f32_16x16x32_bf16 v[160:163], a[224:227], v[64:67], 0
    s_add_u32 m0, s29, 49152
    s_mov_b32 s34, 115456
    buffer_load_dwordx4 v29, s[20:23], s34 offen offset:0 nt lds
    v_mfma_f32_16x16x32_bf16 v[168:171], a[224:227], v[80:83], 0
    v_add_u32 v43, 0xffff0000, v43
    ds_read_b64_tr_b16 a[236:237], v43 offset:0
    ds_read_b64_tr_b16 a[238:239], v43 offset:2048
    v_mfma_f32_16x16x32_bf16 v[176:179], a[224:227], v[96:99], 0
    v_mfma_f32_16x16x32_bf16 v[184:187], a[224:227], v[112:115], 0
    s_waitcnt lgkmcnt(4)
    v_mfma_f32_16x16x32_bf16 v[164:167], a[228:231], v[64:67], 0
    s_mov_b32 s34, 121600
    buffer_load_dwordx4 v29, s[20:23], s34 offen offset:1024 nt lds
    v_mfma_f32_16x16x32_bf16 v[172:175], a[228:231], v[80:83], 0
    v_add_u32 v44, 0xffff0000, v44
    ds_read_b64_tr_b16 a[240:241], v44 offset:0
    ds_read_b64_tr_b16 a[242:243], v44 offset:2048
    v_mfma_f32_16x16x32_bf16 v[180:183], a[228:231], v[96:99], 0
    v_mul_f32 v128, v24, v128
    v_mul_f32 v129, v24, v129
    v_mfma_f32_16x16x32_bf16 v[188:191], a[228:231], v[112:115], 0
    v_mul_f32 v130, v24, v130
    v_mul_f32 v131, v24, v131
    v_mfma_f32_16x16x32_bf16 v[228:231], a[228:231], a[64:67], 0
    s_waitcnt lgkmcnt(4)
    s_mov_b32 s34, 127744
    buffer_load_dwordx4 v29, s[20:23], s34 offen offset:2048 nt lds
    v_mfma_f32_16x16x32_bf16 v[160:163], a[232:235], v[68:71], v[160:163]
    v_add_u32 v45, 0xffff0000, v45
    ds_read_b64_tr_b16 a[244:245], v45 offset:0
    ds_read_b64_tr_b16 a[246:247], v45 offset:2048
    v_mfma_f32_16x16x32_bf16 v[168:171], a[232:235], v[84:87], v[168:171]
    v_mul_f32 v132, v24, v132
    v_mul_f32 v133, v24, v133
    v_mfma_f32_16x16x32_bf16 v[176:179], a[232:235], v[100:103], v[176:179]
    v_mul_f32 v134, v24, v134
    v_mul_f32 v135, v24, v135
    v_mfma_f32_16x16x32_bf16 v[184:187], a[232:235], v[116:119], v[184:187]
    s_waitcnt lgkmcnt(4)
    s_mov_b32 s34, 133888
    buffer_load_dwordx4 v29, s[20:23], s34 offen offset:3072 nt lds
    v_mfma_f32_16x16x32_bf16 v[164:167], a[236:239], v[68:71], v[164:167]
    v_add_u32 v46, 0xffff0000, v46
    ds_read_b64_tr_b16 a[248:249], v46 offset:0
    ds_read_b64_tr_b16 a[250:251], v46 offset:2048
    v_mfma_f32_16x16x32_bf16 v[172:175], a[236:239], v[84:87], v[172:175]
    v_cvt_pk_bf16_f32 v128, v128, v129
    v_cvt_pk_bf16_f32 v129, v130, v131
    v_mfma_f32_16x16x32_bf16 v[180:183], a[236:239], v[100:103], v[180:183]
    v_cvt_pk_bf16_f32 v130, v132, v133
    v_cvt_pk_bf16_f32 v131, v134, v135
    v_mfma_f32_16x16x32_bf16 v[188:191], a[236:239], v[116:119], v[188:191]
    s_mov_b32 s43, 65536
    buffer_store_dwordx4 v[128:131], v4, s[24:27], s43 offen offset:0 sc1
    v_mul_f32 v136, v25, v136
    v_mfma_f32_16x16x32_bf16 v[228:231], a[236:239], a[68:71], v[228:231]
    s_waitcnt lgkmcnt(4)
    v_mul_f32 v137, v25, v137
    v_mul_f32 v138, v25, v138
    v_mfma_f32_16x16x32_bf16 v[160:163], a[240:243], v[72:75], v[160:163]
    v_add_u32 v47, 0xffff0000, v47
    ds_read_b64_tr_b16 a[252:253], v47 offset:0
    ds_read_b64_tr_b16 a[254:255], v47 offset:2048
    v_mfma_f32_16x16x32_bf16 v[168:171], a[240:243], v[88:91], v[168:171]
    v_mul_f32 v139, v25, v139
    v_mul_f32 v140, v25, v140
    v_mfma_f32_16x16x32_bf16 v[176:179], a[240:243], v[104:107], v[176:179]
    v_mul_f32 v141, v25, v141
    v_mul_f32 v142, v25, v142
    v_mfma_f32_16x16x32_bf16 v[184:187], a[240:243], v[120:123], v[184:187]
    s_waitcnt lgkmcnt(4)
    v_mul_f32 v143, v25, v143
    v_cvt_pk_bf16_f32 v136, v136, v137
    v_mfma_f32_16x16x32_bf16 v[164:167], a[244:247], v[72:75], v[164:167]
    v_add_u32 v48, 0xffff0000, v48
    ds_read_b64_tr_b16 a[224:225], v48 offset:0
    ds_read_b64_tr_b16 a[226:227], v48 offset:2048
    v_mfma_f32_16x16x32_bf16 v[172:175], a[244:247], v[88:91], v[172:175]
    v_cvt_pk_bf16_f32 v137, v138, v139
    v_cvt_pk_bf16_f32 v138, v140, v141
    v_mfma_f32_16x16x32_bf16 v[180:183], a[244:247], v[104:107], v[180:183]
    v_cvt_pk_bf16_f32 v139, v142, v143
    v_mfma_f32_16x16x32_bf16 v[188:191], a[244:247], v[120:123], v[188:191]
    s_mov_b32 s43, 65536
    buffer_store_dwordx4 v[136:139], v4, s[24:27], s43 offen offset:2048 sc1
    v_mfma_f32_16x16x32_bf16 v[228:231], a[244:247], a[72:75], v[228:231]
    s_waitcnt lgkmcnt(4)
    v_mfma_f32_16x16x32_bf16 v[160:163], a[248:251], v[76:79], v[160:163]
    v_add_u32 v49, 0xffff0000, v49
    ds_read_b64_tr_b16 a[228:229], v49 offset:0
    ds_read_b64_tr_b16 a[230:231], v49 offset:2048
    v_mfma_f32_16x16x32_bf16 v[168:171], a[248:251], v[92:95], v[168:171]
    v_mul_f32 v144, v26, v144
    v_mul_f32 v145, v26, v145
    v_mfma_f32_16x16x32_bf16 v[176:179], a[248:251], v[108:111], v[176:179]
    v_mul_f32 v146, v26, v146
    v_mul_f32 v147, v26, v147
    v_mfma_f32_16x16x32_bf16 v[184:187], a[248:251], v[124:127], v[184:187]
    s_waitcnt lgkmcnt(4)
    v_mul_f32 v148, v26, v148
    v_mul_f32 v149, v26, v149
    v_mfma_f32_16x16x32_bf16 v[164:167], a[252:255], v[76:79], v[164:167]
    v_add_u32 v50, 0xffff0000, v50
    ds_read_b64_tr_b16 a[232:233], v50 offset:0
    ds_read_b64_tr_b16 a[234:235], v50 offset:2048
    v_mfma_f32_16x16x32_bf16 v[172:175], a[252:255], v[92:95], v[172:175]
    v_mul_f32 v150, v26, v150
    v_mul_f32 v151, v26, v151
    v_mfma_f32_16x16x32_bf16 v[180:183], a[252:255], v[108:111], v[180:183]
    v_cvt_pk_bf16_f32 v144, v144, v145
    v_cvt_pk_bf16_f32 v145, v146, v147
    v_mfma_f32_16x16x32_bf16 v[188:191], a[252:255], v[124:127], v[188:191]
    v_cvt_pk_bf16_f32 v146, v148, v149
    v_cvt_pk_bf16_f32 v147, v150, v151
    v_mfma_f32_16x16x32_bf16 v[228:231], a[252:255], a[76:79], v[228:231]
    s_waitcnt lgkmcnt(4)
    s_mov_b32 s43, 69632
    buffer_store_dwordx4 v[144:147], v4, s[24:27], s43 offen offset:0 sc1
    v_mfma_f32_16x16x32_bf16 v[160:163], a[224:227], a[0:3], v[160:163]
    v_add_u32 v51, 0xffff0000, v51
    ds_read_b64_tr_b16 a[236:237], v51 offset:0
    ds_read_b64_tr_b16 a[238:239], v51 offset:2048
    v_mfma_f32_16x16x32_bf16 v[168:171], a[224:227], a[16:19], v[168:171]
    v_mfma_f32_16x16x32_bf16 v[176:179], a[224:227], a[32:35], v[176:179]
    v_mul_f32 v152, v27, v152
    v_mul_f32 v153, v27, v153
    v_mfma_f32_16x16x32_bf16 v[184:187], a[224:227], a[48:51], v[184:187]
    s_waitcnt lgkmcnt(4)
    v_mul_f32 v154, v27, v154
    v_mul_f32 v155, v27, v155
    v_mfma_f32_16x16x32_bf16 v[164:167], a[228:231], a[0:3], v[164:167]
    v_add_u32 v52, 0xffff0000, v52
    ds_read_b64_tr_b16 a[240:241], v52 offset:0
    ds_read_b64_tr_b16 a[242:243], v52 offset:2048
    v_mfma_f32_16x16x32_bf16 v[172:175], a[228:231], a[16:19], v[172:175]
    v_mul_f32 v156, v27, v156
    v_mul_f32 v157, v27, v157
    v_mfma_f32_16x16x32_bf16 v[180:183], a[228:231], a[32:35], v[180:183]
    v_mul_f32 v158, v27, v158
    v_mul_f32 v159, v27, v159
    v_mfma_f32_16x16x32_bf16 v[188:191], a[228:231], a[48:51], v[188:191]
    v_cvt_pk_bf16_f32 v152, v152, v153
    v_cvt_pk_bf16_f32 v153, v154, v155
    v_mfma_f32_16x16x32_bf16 v[228:231], a[228:231], a[80:83], v[228:231]
    s_waitcnt lgkmcnt(4)
    v_cvt_pk_bf16_f32 v154, v156, v157
    v_cvt_pk_bf16_f32 v155, v158, v159
    v_mfma_f32_16x16x32_bf16 v[160:163], a[232:235], a[4:7], v[160:163]
    s_mov_b32 s43, 69632
    buffer_store_dwordx4 v[152:155], v4, s[24:27], s43 offen offset:2048 sc1
    v_mfma_f32_16x16x32_bf16 v[168:171], a[232:235], a[20:23], v[168:171]
    v_add_u32 v53, 0xffff0000, v53
    ds_read_b64_tr_b16 a[244:245], v53 offset:0
    ds_read_b64_tr_b16 a[246:247], v53 offset:2048
    v_mfma_f32_16x16x32_bf16 v[176:179], a[232:235], a[36:39], v[176:179]
    v_mfma_f32_16x16x32_bf16 v[184:187], a[232:235], a[52:55], v[184:187]
    s_waitcnt lgkmcnt(4)
    v_mfma_f32_16x16x32_bf16 v[164:167], a[236:239], a[4:7], v[164:167]
    v_add_u32 v54, 0xffff0000, v54
    ds_read_b64_tr_b16 a[248:249], v54 offset:0
    ds_read_b64_tr_b16 a[250:251], v54 offset:2048
    v_mfma_f32_16x16x32_bf16 v[172:175], a[236:239], a[20:23], v[172:175]
    v_mul_f32 v224, v28, v224
    v_mul_f32 v225, v28, v225
    v_mfma_f32_16x16x32_bf16 v[180:183], a[236:239], a[36:39], v[180:183]
    v_mul_f32 v226, v28, v226
    v_mul_f32 v227, v28, v227
    v_mfma_f32_16x16x32_bf16 v[188:191], a[236:239], a[52:55], v[188:191]
    v_cvt_pk_bf16_f32 v240, v224, v225
    v_cvt_pk_bf16_f32 v241, v226, v227
    v_mfma_f32_16x16x32_bf16 v[228:231], a[236:239], a[84:87], v[228:231]
    s_waitcnt lgkmcnt(4)
    v_mfma_f32_16x16x32_bf16 v[160:163], a[240:243], a[8:11], v[160:163]
    v_add_u32 v55, 0xffff0000, v55
    ds_read_b64_tr_b16 a[252:253], v55 offset:0
    ds_read_b64_tr_b16 a[254:255], v55 offset:2048
    v_mfma_f32_16x16x32_bf16 v[168:171], a[240:243], a[24:27], v[168:171]
    v_mfma_f32_16x16x32_bf16 v[176:179], a[240:243], a[40:43], v[176:179]
    v_mfma_f32_16x16x32_bf16 v[184:187], a[240:243], a[56:59], v[184:187]
    s_waitcnt lgkmcnt(4)
    v_mfma_f32_16x16x32_bf16 v[164:167], a[244:247], a[8:11], v[164:167]
    v_mfma_f32_16x16x32_bf16 v[172:175], a[244:247], a[24:27], v[172:175]
    v_mfma_f32_16x16x32_bf16 v[180:183], a[244:247], a[40:43], v[180:183]
    v_mfma_f32_16x16x32_bf16 v[188:191], a[244:247], a[56:59], v[188:191]
    s_waitcnt lgkmcnt(0)
    s_waitcnt vmcnt(4)
    s_barrier
    s_cmp_lg_u32 s28, 0
    s_cbranch_scc1 L_nopub2
    s_mov_b64 exec, 0xf
    v_mov_b32 v2, s96
    v_mov_b32 v3, s97
    s_mov_b64 exec, 0xffff
    global_store_dwordx2 v1, v[2:3], s[14:15] sc1
    s_mov_b64 exec, -1
L_nopub2:
    v_mfma_f32_16x16x32_bf16 v[228:231], a[244:247], a[88:91], v[228:231]
    ds_read_b64_tr_b16 a[224:225], v40 offset:32768
    ds_read_b64_tr_b16 a[226:227], v40 offset:34816
    v_mfma_f32_16x16x32_bf16 v[160:163], a[248:251], a[12:15], v[160:163]
    ds_read_b64_tr_b16 a[228:229], v41 offset:32768
    ds_read_b64_tr_b16 a[230:231], v41 offset:34816
    v_mfma_f32_16x16x32_bf16 v[168:171], a[248:251], a[28:31], v[168:171]
    ds_read_b64_tr_b16 a[232:233], v42 offset:32768
    ds_read_b64_tr_b16 a[234:235], v42 offset:34816
    v_mfma_f32_16x16x32_bf16 v[176:179], a[248:251], a[44:47], v[176:179]
    v_mfma_f32_16x16x32_bf16 v[184:187], a[248:251], a[60:63], v[184:187]
    v_mfma_f32_16x16x32_bf16 v[164:167], a[252:255], a[12:15], v[164:167]
    v_mfma_f32_16x16x32_bf16 v[172:175], a[252:255], a[28:31], v[172:175]
    v_mfma_f32_16x16x32_bf16 v[180:183], a[252:255], a[44:47], v[180:183]
    v_mfma_f32_16x16x32_bf16 v[188:191], a[252:255], a[60:63], v[188:191]
    v_mfma_f32_16x16x32_bf16 v[228:231], a[252:255], a[92:95], v[228:231]
    s_waitcnt lgkmcnt(4)
    v_mfma_f32_16x16x32_bf16 v[192:195], a[224:227], v[64:67], 0
    ds_read_b64_tr_b16 a[236:237], v43 offset:32768
    ds_read_b64_tr_b16 a[238:239], v43 offset:34816
    v_mfma_f32_16x16x32_bf16 v[200:203], a[224:227], v[80:83], 0
    v_mfma_f32_16x16x32_bf16 v[208:211], a[224:227], v[96:99], 0
    v_mfma_f32_16x16x32_bf16 v[216:219], a[224:227], v[112:115], 0
    s_waitcnt lgkmcnt(4)
    v_mfma_f32_16x16x32_bf16 v[196:199], a[228:231], v[64:67], 0
    ds_read_b64_tr_b16 a[240:241], v44 offset:32768
    ds_read_b64_tr_b16 a[242:243], v44 offset:34816
    v_mfma_f32_16x16x32_bf16 v[204:207], a[228:231], v[80:83], 0
    v_mul_f32 v160, v24, v160
    v_mul_f32 v161, v24, v161
    v_mfma_f32_16x16x32_bf16 v[212:215], a[228:231], v[96:99], 0
    v_mul_f32 v162, v24, v162
    v_mul_f32 v163, v24, v163
    v_mfma_f32_16x16x32_bf16 v[220:223], a[228:231], v[112:115], 0
    v_mul_f32 v164, v24, v164
    v_mul_f32 v165, v24, v165
    v_mfma_f32_16x16x32_bf16 v[232:235], a[228:231], a[64:67], 0
    s_waitcnt lgkmcnt(4)
    v_mul_f32 v166, v24, v166
    v_mul_f32 v167, v24, v167
    v_mfma_f32_16x16x32_bf16 v[192:195], a[232:235], v[68:71], v[192:195]
    ds_read_b64_tr_b16 a[244:245], v45 offset:32768
    ds_read_b64_tr_b16 a[246:247], v45 offset:34816
    v_mfma_f32_16x16x32_bf16 v[200:203], a[232:235], v[84:87], v[200:203]
    v_cvt_pk_bf16_f32 v160, v160, v161
    v_cvt_pk_bf16_f32 v161, v162, v163
    v_mfma_f32_16x16x32_bf16 v[208:211], a[232:235], v[100:103], v[208:211]
    v_cvt_pk_bf16_f32 v162, v164, v165
    v_cvt_pk_bf16_f32 v163, v166, v167
    v_mfma_f32_16x16x32_bf16 v[216:219], a[232:235], v[116:119], v[216:219]
    s_waitcnt lgkmcnt(4)
    s_mov_b32 s43, 81920
    buffer_store_dwordx4 v[160:163], v4, s[24:27], s43 offen offset:0 sc1
    v_mfma_f32_16x16x32_bf16 v[196:199], a[236:239], v[68:71], v[196:199]
    ds_read_b64_tr_b16 a[248:249], v46 offset:32768
    ds_read_b64_tr_b16 a[250:251], v46 offset:34816
    v_mfma_f32_16x16x32_bf16 v[204:207], a[236:239], v[84:87], v[204:207]
    v_mfma_f32_16x16x32_bf16 v[212:215], a[236:239], v[100:103], v[212:215]
    v_mfma_f32_16x16x32_bf16 v[220:223], a[236:239], v[116:119], v[220:223]
    v_mul_f32 v168, v25, v168
    v_mul_f32 v169, v25, v169
    v_mfma_f32_16x16x32_bf16 v[232:235], a[236:239], a[68:71], v[232:235]
    s_waitcnt lgkmcnt(4)
    v_mul_f32 v170, v25, v170
    v_mul_f32 v171, v25, v171
    v_mfma_f32_16x16x32_bf16 v[192:195], a[240:243], v[72:75], v[192:195]
    ds_read_b64_tr_b16 a[252:253], v47 offset:32768
    ds_read_b64_tr_b16 a[254:255], v47 offset:34816
    v_mfma_f32_16x16x32_bf16 v[200:203], a[240:243], v[88:91], v[200:203]
    v_mul_f32 v172, v25, v172
    v_mul_f32 v173, v25, v173
    v_mfma_f32_16x16x32_bf16 v[208:211], a[240:243], v[104:107], v[208:211]
    v_mul_f32 v174, v25, v174
    v_mul_f32 v175, v25, v175
    v_mfma_f32_16x16x32_bf16 v[216:219], a[240:243], v[120:123], v[216:219]
    s_waitcnt lgkmcnt(4)
    v_cvt_pk_bf16_f32 v168, v168, v169
    v_cvt_pk_bf16_f32 v169, v170, v171
    v_mfma_f32_16x16x32_bf16 v[196:199], a[244:247], v[72:75], v[196:199]
    ds_read_b64_tr_b16 a[224:225], v48 offset:32768
    ds_read_b64_tr_b16 a[226:227], v48 offset:34816
    v_mfma_f32_16x16x32_bf16 v[204:207], a[244:247], v[88:91], v[204:207]
    v_cvt_pk_bf16_f32 v170, v172, v173
    v_cvt_pk_bf16_f32 v171, v174, v175
    v_mfma_f32_16x16x32_bf16 v[212:215], a[244:247], v[104:107], v[212:215]
    s_mov_b32 s43, 81920
    buffer_store_dwordx4 v[168:171], v4, s[24:27], s43 offen offset:2048 sc1
    v_mfma_f32_16x16x32_bf16 v[220:223], a[244:247], v[120:123], v[220:223]
    v_mfma_f32_16x16x32_bf16 v[232:235], a[244:247], a[72:75], v[232:235]
    s_waitcnt lgkmcnt(4)
    v_mfma_f32_16x16x32_bf16 v[192:195], a[248:251], v[76:79], v[192:195]
    ds_read_b64_tr_b16 a[228:229], v49 offset:32768
    ds_read_b64_tr_b16 a[230:231], v49 offset:34816
    v_mfma_f32_16x16x32_bf16 v[200:203], a[248:251], v[92:95], v[200:203]
    v_mul_f32 v176, v26, v176
    v_mul_f32 v177, v26, v177
    v_mfma_f32_16x16x32_bf16 v[208:211], a[248:251], v[108:111], v[208:211]
    v_mul_f32 v178, v26, v178
    v_mul_f32 v179, v26, v179
    v_mfma_f32_16x16x32_bf16 v[216:219], a[248:251], v[124:127], v[216:219]
    s_waitcnt lgkmcnt(4)
    v_mul_f32 v180, v26, v180
    v_mul_f32 v181, v26, v181
    v_mfma_f32_16x16x32_bf16 v[196:199], a[252:255], v[76:79], v[196:199]
    ds_read_b64_tr_b16 a[232:233], v50 offset:32768
    ds_read_b64_tr_b16 a[234:235], v50 offset:34816
    v_mfma_f32_16x16x32_bf16 v[204:207], a[252:255], v[92:95], v[204:207]
    v_mul_f32 v182, v26, v182
    v_mul_f32 v183, v26, v183
    v_mfma_f32_16x16x32_bf16 v[212:215], a[252:255], v[108:111], v[212:215]
    v_cvt_pk_bf16_f32 v176, v176, v177
    v_cvt_pk_bf16_f32 v177, v178, v179
    v_mfma_f32_16x16x32_bf16 v[220:223], a[252:255], v[124:127], v[220:223]
    v_cvt_pk_bf16_f32 v178, v180, v181
    v_cvt_pk_bf16_f32 v179, v182, v183
    v_mfma_f32_16x16x32_bf16 v[232:235], a[252:255], a[76:79], v[232:235]
    s_waitcnt lgkmcnt(4)
    s_mov_b32 s43, 86016
    buffer_store_dwordx4 v[176:179], v4, s[24:27], s43 offen offset:0 sc1
    v_mfma_f32_16x16x32_bf16 v[192:195], a[224:227], a[0:3], v[192:195]
    ds_read_b64_tr_b16 a[236:237], v51 offset:32768
    ds_read_b64_tr_b16 a[238:239], v51 offset:34816
    v_mfma_f32_16x16x32_bf16 v[200:203], a[224:227], a[16:19], v[200:203]
    v_mfma_f32_16x16x32_bf16 v[208:211], a[224:227], a[32:35], v[208:211]
    v_mul_f32 v184, v27, v184
    v_mul_f32 v185, v27, v185
    v_mfma_f32_16x16x32_bf16 v[216:219], a[224:227], a[48:51], v[216:219]
    s_waitcnt lgkmcnt(4)
    v_mul_f32 v186, v27, v186
    v_mul_f32 v187, v27, v187
    v_mfma_f32_16x16x32_bf16 v[196:199], a[228:231], a[0:3], v[196:199]
    s_and_b32 s36, s3, 15
    s_lshr_b32 s99, s36, 2
    s_max_u32 s99, s99, 3
    s_lshl_b32 s99, s99, 3
    v_mfma_f32_16x16x32_bf16 v[204:207], a[228:231], a[16:19], v[204:207]
    ds_read_b64_tr_b16 a[240:241], v52 offset:32768
    ds_read_b64_tr_b16 a[242:243], v52 offset:34816
    v_mfma_f32_16x16x32_bf16 v[212:215], a[228:231], a[32:35], v[212:215]
    v_lshrrev_b32 v30, 6, v0
    v_lshlrev_b32 v30, 7, v30
    v_mfma_f32_16x16x32_bf16 v[220:223], a[228:231], a[48:51], v[220:223]
    v_add_u32 v31, s99, v30
    v_mul_f32 v188, v27, v188
    v_mfma_f32_16x16x32_bf16 v[232:235], a[228:231], a[80:83], v[232:235]
    s_waitcnt lgkmcnt(4)
    v_mul_f32 v189, v27, v189
    v_mul_f32 v190, v27, v190
    v_mfma_f32_16x16x32_bf16 v[192:195], a[232:235], a[4:7], v[192:195]
    ds_read_b64_tr_b16 a[244:245], v53 offset:32768
    ds_read_b64_tr_b16 a[246:247], v53 offset:34816
    v_mfma_f32_16x16x32_bf16 v[200:203], a[232:235], a[20:23], v[200:203]
    v_mul_f32 v191, v27, v191
    v_cvt_pk_bf16_f32 v184, v184, v185
    v_mfma_f32_16x16x32_bf16 v[208:211], a[232:235], a[36:39], v[208:211]
    v_cvt_pk_bf16_f32 v185, v186, v187
    v_cvt_pk_bf16_f32 v186, v188, v189
    v_mfma_f32_16x16x32_bf16 v[216:219], a[232:235], a[52:55], v[216:219]
    s_waitcnt lgkmcnt(4)
    v_cvt_pk_bf16_f32 v187, v190, v191
    v_mfma_f32_16x16x32_bf16 v[196:199], a[236:239], a[4:7], v[196:199]
    s_mov_b32 s43, 86016
    buffer_store_dwordx4 v[184:187], v4, s[24:27], s43 offen offset:2048 sc1
    v_mul_f32 v228, v28, v228
    v_mfma_f32_16x16x32_bf16 v[204:207], a[236:239], a[20:23], v[204:207]
    ds_read_b64_tr_b16 a[248:249], v54 offset:32768
    ds_read_b64_tr_b16 a[250:251], v54 offset:34816
    v_mfma_f32_16x16x32_bf16 v[212:215], a[236:239], a[36:39], v[212:215]
    v_mul_f32 v229, v28, v229
    v_mul_f32 v230, v28, v230
    v_mfma_f32_16x16x32_bf16 v[220:223], a[236:239], a[52:55], v[220:223]
    v_mul_f32 v231, v28, v231
    v_mfma_f32_16x16x32_bf16 v[232:235], a[236:239], a[84:87], v[232:235]
    s_waitcnt lgkmcnt(4)
    v_cvt_pk_bf16_f32 v242, v228, v229
    v_cvt_pk_bf16_f32 v243, v230, v231
    v_mfma_f32_16x16x32_bf16 v[192:195], a[240:243], a[8:11], v[192:195]
    s_mov_b32 s43, 122880
    buffer_store_dwordx4 v[240:243], v5, s[24:27], s43 offen sc1
    v_mfma_f32_16x16x32_bf16 v[200:203], a[240:243], a[24:27], v[200:203]
    ds_read_b64_tr_b16 a[252:253], v55 offset:32768
    ds_read_b64_tr_b16 a[254:255], v55 offset:34816
    v_mfma_f32_16x16x32_bf16 v[208:211], a[240:243], a[40:43], v[208:211]
    v_mfma_f32_16x16x32_bf16 v[216:219], a[240:243], a[56:59], v[216:219]
    s_waitcnt lgkmcnt(4)
    v_mfma_f32_16x16x32_bf16 v[196:199], a[244:247], a[8:11], v[196:199]
    v_mfma_f32_16x16x32_bf16 v[204:207], a[244:247], a[24:27], v[204:207]
    v_mfma_f32_16x16x32_bf16 v[212:215], a[244:247], a[40:43], v[212:215]
    global_load_dwordx2 v[32:33], v31, s[14:15] sc1
    v_mfma_f32_16x16x32_bf16 v[220:223], a[244:247], a[56:59], v[220:223]
    v_mfma_f32_16x16x32_bf16 v[232:235], a[244:247], a[88:91], v[232:235]
    s_waitcnt lgkmcnt(2)
    v_mfma_f32_16x16x32_bf16 v[192:195], a[248:251], a[12:15], v[192:195]
    v_mfma_f32_16x16x32_bf16 v[200:203], a[248:251], a[28:31], v[200:203]
    v_mfma_f32_16x16x32_bf16 v[208:211], a[248:251], a[44:47], v[208:211]
    v_mfma_f32_16x16x32_bf16 v[216:219], a[248:251], a[60:63], v[216:219]
    s_waitcnt lgkmcnt(0)
    v_mfma_f32_16x16x32_bf16 v[196:199], a[252:255], a[12:15], v[196:199]
    v_mfma_f32_16x16x32_bf16 v[204:207], a[252:255], a[28:31], v[204:207]
    v_mfma_f32_16x16x32_bf16 v[212:215], a[252:255], a[44:47], v[212:215]
    v_mfma_f32_16x16x32_bf16 v[220:223], a[252:255], a[60:63], v[220:223]
    v_mfma_f32_16x16x32_bf16 v[232:235], a[252:255], a[92:95], v[232:235]
    v_mul_f32 v192, v24, v192
    v_mul_f32 v193, v24, v193
    v_mul_f32 v194, v24, v194
    v_mul_f32 v195, v24, v195
    v_mul_f32 v196, v24, v196
    v_mul_f32 v197, v24, v197
    v_mul_f32 v198, v24, v198
    v_mul_f32 v199, v24, v199
    v_cvt_pk_bf16_f32 v192, v192, v193
    v_cvt_pk_bf16_f32 v193, v194, v195
    v_cvt_pk_bf16_f32 v194, v196, v197
    v_cvt_pk_bf16_f32 v195, v198, v199
    s_mov_b32 s43, 98304
    buffer_store_dwordx4 v[192:195], v4, s[24:27], s43 offen offset:0 sc1
    v_mul_f32 v200, v25, v200
    v_mul_f32 v201, v25, v201
    v_mul_f32 v202, v25, v202
    v_mul_f32 v203, v25, v203
    v_mul_f32 v204, v25, v204
    v_mul_f32 v205, v25, v205
    v_mul_f32 v206, v25, v206
    v_mul_f32 v207, v25, v207
    v_cvt_pk_bf16_f32 v200, v200, v201
    v_cvt_pk_bf16_f32 v201, v202, v203
    v_cvt_pk_bf16_f32 v202, v204, v205
    v_cvt_pk_bf16_f32 v203, v206, v207
    s_mov_b32 s43, 98304
    buffer_store_dwordx4 v[200:203], v4, s[24:27], s43 offen offset:2048 sc1
    v_mul_f32 v208, v26, v208
    v_mul_f32 v209, v26, v209
    v_mul_f32 v210, v26, v210
    v_mul_f32 v211, v26, v211
    v_mul_f32 v212, v26, v212
    v_mul_f32 v213, v26, v213
    v_mul_f32 v214, v26, v214
    v_mul_f32 v215, v26, v215
    v_cvt_pk_bf16_f32 v208, v208, v209
    v_cvt_pk_bf16_f32 v209, v210, v211
    v_cvt_pk_bf16_f32 v210, v212, v213
    v_cvt_pk_bf16_f32 v211, v214, v215
    s_mov_b32 s43, 102400
    buffer_store_dwordx4 v[208:211], v4, s[24:27], s43 offen offset:0 sc1
    v_mul_f32 v216, v27, v216
    v_mul_f32 v217, v27, v217
    v_mul_f32 v218, v27, v218
    v_mul_f32 v219, v27, v219
    v_mul_f32 v220, v27, v220
    v_mul_f32 v221, v27, v221
    v_mul_f32 v222, v27, v222
    v_mul_f32 v223, v27, v223
    v_cvt_pk_bf16_f32 v216, v216, v217
    v_cvt_pk_bf16_f32 v217, v218, v219
    v_cvt_pk_bf16_f32 v218, v220, v221
    v_cvt_pk_bf16_f32 v219, v222, v223
    s_mov_b32 s43, 102400
    buffer_store_dwordx4 v[216:219], v4, s[24:27], s43 offen offset:2048 sc1
    v_mul_f32 v232, v28, v232
    v_mul_f32 v233, v28, v233
    v_mul_f32 v234, v28, v234
    v_mul_f32 v235, v28, v235
    v_cvt_pk_bf16_f32 v240, v232, v233
    v_cvt_pk_bf16_f32 v241, v234, v235
    v_mov_b32 v242, 0
    v_mov_b32 v243, 0
    s_mov_b32 s43, 126976
    buffer_store_dwordx4 v[240:243], v5, s[24:27], s43 offen sc1
    s_load_dwordx2 s[4:5], s[0:1], 96
    s_load_dwordx2 s[8:9], s[0:1], 80
    v_lshrrev_b32 v5, 4, v0
    v_and_b32 v4, 15, v5
    v_lshrrev_b32 v5, 4, v5
    v_lshlrev_b32 v16, 17, v5
    v_lshl_add_u32 v16, v4, 4, v16
    v_mul_u32_u24 v17, 1792, v4
    v_lshrrev_b32 v6, 1, v5
    v_lshl_add_u32 v17, v6, 3, v17
    v_and_b32 v19, 1, v5
    v_lshl_add_u32 v14, v19, 7, v17
    v_lshl_add_u32 v17, v19, 5, v17
    v_lshlrev_b32 v19, 30, v19
    v_and_b32 v6, 1, v4
    v_lshlrev_b32 v6, 4, v6
    v_mov_b32 v7, 0x3f80
    v_lshlrev_b32 v7, v6, v7
    v_lshrrev_b32 v6, 1, v4
    v_cmp_eq_u32 vcc, 0, v6
    s_nop 1
    v_cndmask_b32 v40, 0, v7, vcc
    v_cmp_eq_u32 vcc, 4, v6
    s_nop 1
    v_cndmask_b32 v44, 0, v7, vcc
    v_cmp_eq_u32 vcc, 1, v6
    s_nop 1
    v_cndmask_b32 v41, 0, v7, vcc
    v_cmp_eq_u32 vcc, 5, v6
    s_nop 1
    v_cndmask_b32 v45, 0, v7, vcc
    v_cmp_eq_u32 vcc, 2, v6
    s_nop 1
    v_cndmask_b32 v42, 0, v7, vcc
    v_cmp_eq_u32 vcc, 6, v6
    s_nop 1
    v_cndmask_b32 v46, 0, v7, vcc
    v_cmp_eq_u32 vcc, 3, v6
    s_nop 1
    v_cndmask_b32 v43, 0, v7, vcc
    v_cmp_eq_u32 vcc, 7, v6
    s_nop 1
    v_cndmask_b32 v47, 0, v7, vcc
    s_lshr_b32 s35, s3, 4
    v_mov_b32 v18, s49
    s_waitcnt lgkmcnt(0)
    s_lshl_b32 s99, s35, 21
    s_add_u32 s4, s4, s99
    s_addc_u32 s5, s5, 0
    s_mov_b32 s6, 2097152
    s_mov_b32 s7, 0x20000
    s_mov_b32 s10, 2064384
    s_mov_b32 s11, 0x20000
    s_and_b32 s16, s35, 7
    s_mul_i32 s16, s16, 258048
    s_lshr_b32 s17, s35, 3
    s_mul_i32 s17, s17, 896
    s_add_u32 s16, s16, s17
    s_lshl_b32 s17, s35, 4
    v_mov_b32 v8, s17
    s_lshl_b32 s19, s36, 2
    s_add_u32 s19, s19, s28
    s_mov_b32 s21, 0
    s_mov_b32 s22, 0
    s_mov_b64 s[46:47], 0
    v_mov_b32 v36, 150528
    s_waitcnt vmcnt(0)
L_drained:
    s_barrier
    s_cmp_lg_u32 s28, 0
    s_cbranch_scc1 L_nopub3
    s_mov_b64 exec, 0x7f
    v_mov_b32 v2, s96
    v_mov_b32 v3, s97
    s_mov_b64 exec, 0xffff
    global_store_dwordx2 v1, v[2:3], s[14:15] sc1
    s_mov_b64 exec, -1
L_nopub3:
    s_cmp_eq_u32 s28, 0
    s_cbranch_scc1 L_spin1_c
    s_cmp_lg_u32 s28, 0
    s_cbranch_scc1 L_spin1_j
L_spin1:
    global_load_dwordx2 v[32:33], v31, s[14:15] sc1
    s_waitcnt vmcnt(0)
L_spin1_c:
    v_subrev_co_u32 v32, vcc, s48, v32
    s_nop 1
    v_subb_co_u32 v33, vcc, v33, v18, vcc
    v_cmp_eq_u32 vcc, 0, v33
    s_nop 1
    s_cmp_eq_u64 vcc, -1
    s_cselect_b32 s99, 1, 0
    s_cbranch_scc1 L_spin1_d
    s_add_u32 s21, s21, 1
    s_cmp_lt_u32 s21, 2000
    s_cbranch_scc1 L_spin1
L_spin1_d:
    v_mov_b32 v35, s99
    ds_write_b32 v36, v35 offset:0
    s_waitcnt lgkmcnt(0)
L_spin1_j:
    s_barrier
    ds_read_b32 v35, v36 offset:0
    s_waitcnt lgkmcnt(0)
    v_readfirstlane_b32 s99, v35
    s_nop 1
    s_cmp_eq_u32 s99, 1
    s_cselect_b32 s23, 1, 0
    s_cbranch_scc0 L_have1
    s_lshl_b32 s20, s19, 10
    s_add_u32 s20, s20, 0
    buffer_load_dwordx4 v[64:67], v16, s[4:7], s20 offen offset:0 sc1
    buffer_load_dwordx4 v[68:71], v16, s[4:7], s20 offen offset:256 sc1
    buffer_load_dwordx4 v[72:75], v16, s[4:7], s20 offen offset:512 sc1
    buffer_load_dwordx4 v[76:79], v16, s[4:7], s20 offen offset:768 sc1
    s_add_u32 s20, s20, 524288
    buffer_load_dwordx4 v[80:83], v16, s[4:7], s20 offen offset:0 sc1
    buffer_load_dwordx4 v[84:87], v16, s[4:7], s20 offen offset:256 sc1
    buffer_load_dwordx4 v[88:91], v16, s[4:7], s20 offen offset:512 sc1
    buffer_load_dwordx4 v[92:95], v16, s[4:7], s20 offen offset:768 sc1
    s_add_u32 s20, s20, 524288
    buffer_load_dwordx4 v[96:99], v16, s[4:7], s20 offen offset:0 sc1
    buffer_load_dwordx4 v[100:103], v16, s[4:7], s20 offen offset:256 sc1
    buffer_load_dwordx4 v[104:107], v16, s[4:7], s20 offen offset:512 sc1
    buffer_load_dwordx4 v[108:111], v16, s[4:7], s20 offen offset:768 sc1
    s_add_u32 s20, s20, 524288
    buffer_load_dwordx4 v[112:115], v16, s[4:7], s20 offen offset:0 sc1
    buffer_load_dwordx4 v[116:119], v16, s[4:7], s20 offen offset:256 sc1
    buffer_load_dwordx4 v[120:123], v16, s[4:7], s20 offen offset:512 sc1
    buffer_load_dwordx4 v[124:127], v16, s[4:7], s20 offen offset:768 sc1
L_have1:
    s_cmp_lg_u32 s28, 0
    s_cbranch_scc1 L_noadd
    s_mov_b64 exec, 1
    v_mov_b32 v9, 1
    global_atomic_add v34, v8, v9, s[12:13] sc0
    s_mov_b64 exec, -1
L_noadd:
    s_lshr_b32 s99, s36, 2
    s_add_u32 s99, s99, 4
    s_lshl_b32 s98, s36, 1
    s_sub_u32 s98, s98, 23
    s_min_u32 s98, s98, 6
    s_max_u32 s98, s98, 2
    s_cmp_ge_u32 s36, 12
    s_cselect_b32 s99, s98, s99
    s_lshl_b32 s99, s99, 3
    v_add_u32 v31, s99, v30
    s_cmp_lg_u32 s28, 0
    s_cbranch_scc1 L_spin2_j
L_spin2:
    global_load_dwordx2 v[32:33], v31, s[14:15] sc1
    s_waitcnt vmcnt(0)
L_spin2_c:
    v_subrev_co_u32 v32, vcc, s48, v32
    s_nop 1
    v_subb_co_u32 v33, vcc, v33, v18, vcc
    v_cmp_eq_u32 vcc, 0, v33
    s_nop 1
    s_cmp_eq_u64 vcc, -1
    s_cselect_b32 s99, 1, 0
    s_cbranch_scc1 L_spin2_d
    s_add_u32 s21, s21, 1
    s_cmp_lt_u32 s21, 2000
    s_cbranch_scc1 L_spin2
L_spin2_d:
    v_mov_b32 v35, s99
    ds_write_b32 v36, v35 offset:4
    s_waitcnt lgkmcnt(0)
L_spin2_j:
    s_barrier
    ds_read_b32 v35, v36 offset:4
    s_waitcnt lgkmcnt(0)
    v_readfirstlane_b32 s99, v35
    s_nop 1
    s_cmp_eq_u32 s99, 1
    s_cselect_b32 s99, s23, 0
    s_cmp_eq_u32 s99, 1
    s_cbranch_scc0 L_slow
    s_branch L_second
L_slow:
    s_mov_b32 s21, 0
L_spin3:
    global_load_dword v32, v8, s[12:13] sc1
    s_waitcnt vmcnt(0)
    v_readfirstlane_b32 s99, v32
    s_nop 1
    s_cmp_eq_u32 s99, 16
    s_cbranch_scc1 L_both
    s_add_u32 s21, s21, 1
    s_cmp_lt_u32 s21, 2000
    s_cbranch_scc1 L_spin3
    s_lshl_b64 s[98:99], 1, s19
    s_mov_b64 exec, 1
    v_mov_b32 v32, s98
    v_mov_b32 v33, s99
    global_atomic_or_x2 v8, v[32:33], s[12:13] offset:8
    s_waitcnt vmcnt(0)
    s_mov_b64 exec, -1
    global_load_dword v32, v8, s[12:13] sc1
    s_waitcnt vmcnt(0)
    v_readfirstlane_b32 s99, v32
    s_nop 1
    s_cmp_eq_u32 s99, 16
    s_cbranch_scc0 L_next
L_both:
    s_lshl_b32 s20, s19, 10
    s_add_u32 s20, s20, 0
    buffer_load_dwordx4 v[64:67], v16, s[4:7], s20 offen offset:0 sc1
    buffer_load_dwordx4 v[68:71], v16, s[4:7], s20 offen offset:256 sc1
    buffer_load_dwordx4 v[72:75], v16, s[4:7], s20 offen offset:512 sc1
    buffer_load_dwordx4 v[76:79], v16, s[4:7], s20 offen offset:768 sc1
    s_add_u32 s20, s20, 524288
    buffer_load_dwordx4 v[80:83], v16, s[4:7], s20 offen offset:0 sc1
    buffer_load_dwordx4 v[84:87], v16, s[4:7], s20 offen offset:256 sc1
    buffer_load_dwordx4 v[88:91], v16, s[4:7], s20 offen offset:512 sc1
    buffer_load_dwordx4 v[92:95], v16, s[4:7], s20 offen offset:768 sc1
    s_add_u32 s20, s20, 524288
    buffer_load_dwordx4 v[96:99], v16, s[4:7], s20 offen offset:0 sc1
    buffer_load_dwordx4 v[100:103], v16, s[4:7], s20 offen offset:256 sc1
    buffer_load_dwordx4 v[104:107], v16, s[4:7], s20 offen offset:512 sc1
    buffer_load_dwordx4 v[108:111], v16, s[4:7], s20 offen offset:768 sc1
    s_add_u32 s20, s20, 524288
    buffer_load_dwordx4 v[112:115], v16, s[4:7], s20 offen offset:0 sc1
    buffer_load_dwordx4 v[116:119], v16, s[4:7], s20 offen offset:256 sc1
    buffer_load_dwordx4 v[120:123], v16, s[4:7], s20 offen offset:512 sc1
    buffer_load_dwordx4 v[124:127], v16, s[4:7], s20 offen offset:768 sc1
L_second:
    s_lshl_b32 s20, s19, 10
    s_add_u32 s20, s20, 65536
    buffer_load_dwordx4 v[176:179], v16, s[4:7], s20 offen offset:0 sc1
    buffer_load_dwordx4 v[180:183], v16, s[4:7], s20 offen offset:256 sc1
    buffer_load_dwordx4 v[184:187], v16, s[4:7], s20 offen offset:512 sc1
    buffer_load_dwordx4 v[188:191], v16, s[4:7], s20 offen offset:768 sc1
    s_add_u32 s20, s20, 524288
    buffer_load_dwordx4 v[192:195], v16, s[4:7], s20 offen offset:0 sc1
    buffer_load_dwordx4 v[196:199], v16, s[4:7], s20 offen offset:256 sc1
    buffer_load_dwordx4 v[200:203], v16, s[4:7], s20 offen offset:512 sc1
    buffer_load_dwordx4 v[204:207], v16, s[4:7], s20 offen offset:768 sc1
    s_add_u32 s20, s20, 524288
    buffer_load_dwordx4 v[208:211], v16, s[4:7], s20 offen offset:0 sc1
    buffer_load_dwordx4 v[212:215], v16, s[4:7], s20 offen offset:256 sc1
    buffer_load_dwordx4 v[216:219], v16, s[4:7], s20 offen offset:512 sc1
    buffer_load_dwordx4 v[220:223], v16, s[4:7], s20 offen offset:768 sc1
    s_add_u32 s20, s20, 524288
    buffer_load_dwordx4 v[224:227], v16, s[4:7], s20 offen offset:0 sc1
    buffer_load_dwordx4 v[228:231], v16, s[4:7], s20 offen offset:256 sc1
    buffer_load_dwordx4 v[232:235], v16, s[4:7], s20 offen offset:512 sc1
    buffer_load_dwordx4 v[236:239], v16, s[4:7], s20 offen offset:768 sc1
    s_add_u32 s21, s19, 0
    s_lshr_b32 s20, s21, 4
    s_lshl_b32 s20, s20, 7
    s_add_u32 s20, s20, s16
    s_bfe_u32 s99, s21, 0x30001
    s_mul_i32 s99, s99, 28672
    s_add_u32 s20, s20, s99
    s_and_b32 s99, s21, 1
    s_lshl_b32 s99, s99, 6
    s_add_u32 s50, s20, s99
    s_bfe_u32 s99, s21, 0x10003
    s_lshl_b32 s99, s99, 5
    v_xor_b32 v12, s99, v17
    s_add_u32 s21, s19, 64
    s_cmp_ge_u32 s21, 112
    s_cbranch_scc1 L_t9
    s_lshr_b32 s20, s21, 4
    s_lshl_b32 s20, s20, 7
    s_add_u32 s20, s20, s16
    s_bfe_u32 s99, s21, 0x30001
    s_mul_i32 s99, s99, 28672
    s_add_u32 s20, s20, s99
    s_and_b32 s99, s21, 1
    s_lshl_b32 s99, s99, 6
    s_add_u32 s51, s20, s99
    s_bfe_u32 s99, s21, 0x10003
    s_lshl_b32 s99, s99, 5
    v_xor_b32 v13, s99, v17
    s_branch L_sum
L_t9:
    s_bfe_u32 s20, s21, 0x20002
    s_and_b32 s99, s21, 1
    s_lshl_b32 s99, s99, 1
    s_bfe_u32 s98, s21, 0x10001
    s_xor_b32 s98, s98, 1
    s_add_u32 s99, s99, s98
    s_lshl_b32 s99, s99, 5
    s_lshl_b32 s51, s20, 8
    s_add_u32 s51, s51, s99
    s_add_u32 s51, s51, s16
    s_add_u32 s51, s51, 229376
    v_mov_b32 v13, v14
    s_cmp_eq_u32 s20, 3
    s_cbranch_scc0 L_sum
    v_add_u32 v13, v19, v14
L_sum:
    s_waitcnt vmcnt(31)
    v_mfma_f32_16x16x32_bf16 v[48:51], v[40:43], v[64:67], 0
    s_waitcnt vmcnt(30)
    v_mfma_f32_16x16x32_bf16 v[48:51], v[44:47], v[68:71], v[48:51]
    s_waitcnt vmcnt(29)
    v_mfma_f32_16x16x32_bf16 v[52:55], v[40:43], v[72:75], 0
    s_waitcnt vmcnt(28)
    v_mfma_f32_16x16x32_bf16 v[52:55], v[44:47], v[76:79], v[52:55]
    s_waitcnt vmcnt(27)
    v_mfma_f32_16x16x32_bf16 v[48:51], v[40:43], v[80:83], v[48:51]
    s_waitcnt vmcnt(26)
    v_mfma_f32_16x16x32_bf16 v[48:51], v[44:47], v[84:87], v[48:51]
    s_waitcnt vmcnt(25)
    v_mfma_f32_16x16x32_bf16 v[52:55], v[40:43], v[88:91], v[52:55]
    s_waitcnt vmcnt(24)
    v_mfma_f32_16x16x32_bf16 v[52:55], v[44:47], v[92:95], v[52:55]
    s_waitcnt vmcnt(23)
    v_mfma_f32_16x16x32_bf16 v[48:51], v[40:43], v[96:99], v[48:51]
    s_waitcnt vmcnt(22)
    v_mfma_f32_16x16x32_bf16 v[48:51], v[44:47], v[100:103], v[48:51]
    s_waitcnt vmcnt(21)
    v_mfma_f32_16x16x32_bf16 v[52:55], v[40:43], v[104:107], v[52:55]
    s_waitcnt vmcnt(20)
    v_mfma_f32_16x16x32_bf16 v[52:55], v[44:47], v[108:111], v[52:55]
    s_waitcnt vmcnt(19)
    v_mfma_f32_16x16x32_bf16 v[48:51], v[40:43], v[112:115], v[48:51]
    s_waitcnt vmcnt(18)
    v_mfma_f32_16x16x32_bf16 v[48:51], v[44:47], v[116:119], v[48:51]
    s_waitcnt vmcnt(17)
    v_mfma_f32_16x16x32_bf16 v[52:55], v[40:43], v[120:123], v[52:55]
    s_waitcnt vmcnt(16)
    v_mfma_f32_16x16x32_bf16 v[52:55], v[44:47], v[124:127], v[52:55]
    s_waitcnt vmcnt(15)
    v_mfma_f32_16x16x32_bf16 v[56:59], v[40:43], v[176:179], 0
    s_waitcnt vmcnt(14)
    v_mfma_f32_16x16x32_bf16 v[56:59], v[44:47], v[180:183], v[56:59]
    s_waitcnt vmcnt(13)
    v_mfma_f32_16x16x32_bf16 v[60:63], v[40:43], v[184:187], 0
    s_waitcnt vmcnt(12)
    v_mfma_f32_16x16x32_bf16 v[60:63], v[44:47], v[188:191], v[60:63]
    s_waitcnt vmcnt(11)
    v_mfma_f32_16x16x32_bf16 v[56:59], v[40:43], v[192:195], v[56:59]
    s_waitcnt vmcnt(10)
    v_mfma_f32_16x16x32_bf16 v[56:59], v[44:47], v[196:199], v[56:59]
    s_waitcnt vmcnt(9)
    v_mfma_f32_16x16x32_bf16 v[60:63], v[40:43], v[200:203], v[60:63]
    s_waitcnt vmcnt(8)
    v_mfma_f32_16x16x32_bf16 v[60:63], v[44:47], v[204:207], v[60:63]
    s_waitcnt vmcnt(7)
    v_mfma_f32_16x16x32_bf16 v[56:59], v[40:43], v[208:211], v[56:59]
    s_waitcnt vmcnt(6)
    v_mfma_f32_16x16x32_bf16 v[56:59], v[44:47], v[212:215], v[56:59]
    s_waitcnt vmcnt(5)
    v_mfma_f32_16x16x32_bf16 v[60:63], v[40:43], v[216:219], v[60:63]
    s_waitcnt vmcnt(4)
    v_mfma_f32_16x16x32_bf16 v[60:63], v[44:47], v[220:223], v[60:63]
    s_waitcnt vmcnt(3)
    v_mfma_f32_16x16x32_bf16 v[56:59], v[40:43], v[224:227], v[56:59]
    s_waitcnt vmcnt(2)
    v_mfma_f32_16x16x32_bf16 v[56:59], v[44:47], v[228:231], v[56:59]
    s_waitcnt vmcnt(1)
    v_mfma_f32_16x16x32_bf16 v[60:63], v[40:43], v[232:235], v[60:63]
    s_waitcnt vmcnt(0)
    v_mfma_f32_16x16x32_bf16 v[60:63], v[44:47], v[236:239], v[60:63]
    v_cvt_pk_bf16_f32 v48, v48, v49
    v_cvt_pk_bf16_f32 v49, v50, v51
    buffer_store_dwordx2 v[48:49], v12, s[8:11], s50 offen offset:0
    v_cvt_pk_bf16_f32 v52, v52, v53
    v_cvt_pk_bf16_f32 v53, v54, v55
    buffer_store_dwordx2 v[52:53], v12, s[8:11], s50 offen offset:16
    v_cvt_pk_bf16_f32 v56, v56, v57
    v_cvt_pk_bf16_f32 v57, v58, v59
    buffer_store_dwordx2 v[56:57], v13, s[8:11], s51 offen offset:0
    v_cvt_pk_bf16_f32 v60, v60, v61
    v_cvt_pk_bf16_f32 v61, v62, v63
    buffer_store_dwordx2 v[60:61], v13, s[8:11], s51 offen offset:16
L_next:
    s_cmp_lg_u32 s28, 0
    s_cbranch_scc1 L_done
    s_cmp_lg_u32 s22, 0
    s_cbranch_scc1 L_more
    s_mov_b32 s22, 1
    v_readfirstlane_b32 s99, v34
    s_nop 1
    s_cmp_eq_u32 s99, 15
    s_cbranch_scc0 L_done
    global_load_dwordx2 v[32:33], v8, s[12:13] offset:8 sc1
    s_waitcnt vmcnt(0)
    v_readfirstlane_b32 s46, v32
    v_readfirstlane_b32 s47, v33
L_more:
    s_nop 1
    s_cmp_eq_u64 s[46:47], 0
    s_cbranch_scc1 L_done
    s_ff1_i32_b64 s19, s[46:47]
    s_bitset0_b64 s[46:47], s19
    s_branch L_both
L_done:
L_end:
    s_endpgm
L_rare0:
    s_mov_b32 s38, 1
    s_call_b64 s[40:41], L_fix1
    s_branch L_back0
L_rare1:
    s_mov_b32 s38, 0
    s_call_b64 s[40:41], L_fixo
    s_branch L_back1
L_rare2:
    s_mov_b32 s38, 0
    s_call_b64 s[40:41], L_fix0
    s_branch L_back2
L_rare3:
    s_mov_b32 s38, 0
    s_call_b64 s[40:41], L_fixo
    s_branch L_back3
L_rare4:
    s_mov_b32 s38, 0
    s_call_b64 s[40:41], L_fix1
    s_branch L_back4
L_rare5:
    s_mov_b32 s38, 0
    s_call_b64 s[40:41], L_fixo
    s_branch L_back5
L_rare6:
    s_mov_b32 s38, 1
    s_call_b64 s[40:41], L_fix0
    s_branch L_back6
L_rare7:
    s_mov_b32 s38, 0
    s_call_b64 s[40:41], L_fixo
    s_branch L_back7
L_rare8:
    s_mov_b32 s38, 1
    s_call_b64 s[40:41], L_fix1
    s_branch L_back8
L_rare9:
    s_mov_b32 s38, 0
    s_call_b64 s[40:41], L_fixo
    s_branch L_back9
L_rare10:
    s_mov_b32 s38, 0
    s_call_b64 s[40:41], L_fix0
    s_branch L_back10
L_rare11:
    s_mov_b32 s38, 0
    s_call_b64 s[40:41], L_fixo
    s_branch L_back11
L_rare12:
    s_mov_b32 s38, 0
    s_call_b64 s[40:41], L_fix1
    s_branch L_back12
L_rare13:
    s_mov_b32 s38, 0
    s_call_b64 s[40:41], L_fixo
    s_branch L_back13
L_rare14:
    s_mov_b32 s38, 1
    s_call_b64 s[40:41], L_fix0
    s_branch L_back14
L_rare15:
    s_mov_b32 s38, 0
    s_call_b64 s[40:41], L_fixo
    s_branch L_back15
L_rare16:
    s_mov_b32 s38, 1
    s_call_b64 s[40:41], L_fix1
    s_branch L_back16
L_rare17:
    s_mov_b32 s38, 0
    s_call_b64 s[40:41], L_fixo
    s_branch L_back17
L_rare18:
    s_mov_b32 s38, 0
    s_call_b64 s[40:41], L_fix0
    s_branch L_back18
L_rare19:
    s_mov_b32 s38, 0
    s_call_b64 s[40:41], L_fixo
    s_branch L_back19
L_rare20:
    s_mov_b32 s38, 0
    s_call_b64 s[40:41], L_fix1
    s_branch L_back20
L_rare21:
    s_mov_b32 s38, 0
    s_call_b64 s[40:41], L_fixo
    s_branch L_back21
L_rare22:
    s_mov_b32 s38, 0
    s_call_b64 s[40:41], L_fix1
    s_branch L_back22
L_rare23:
    s_mov_b32 s38, 0
    s_call_b64 s[40:41], L_fixo
    s_branch L_back23
L_rare24:
    s_mov_b32 s38, 1
    s_call_b64 s[40:41], L_fix0
    s_branch L_back24
L_rare25:
    s_mov_b32 s38, 0
    s_call_b64 s[40:41], L_fixo
    s_branch L_back25
L_rare26:
    s_mov_b32 s38, 1
    s_call_b64 s[40:41], L_fix1
    s_branch L_back26
L_rare27:
    s_mov_b32 s38, 0
    s_call_b64 s[40:41], L_fixo
    s_branch L_back27
L_rare28:
    s_mov_b32 s38, 0
    s_call_b64 s[40:41], L_fix0
    s_branch L_back28
L_rare29:
    s_mov_b32 s38, 0
    s_call_b64 s[40:41], L_fixo
    s_branch L_back29
L_rare30:
    s_mov_b32 s38, 0
    s_call_b64 s[40:41], L_fix1
    s_branch L_back30
L_rare31:
    s_mov_b32 s38, 0
    s_call_b64 s[40:41], L_fixo
    s_branch L_back31
L_rare32:
    s_mov_b32 s38, 1
    s_call_b64 s[40:41], L_fix0
    s_branch L_back32
L_rare33:
    s_mov_b32 s38, 0
    s_call_b64 s[40:41], L_fixo
    s_branch L_back33
L_rare34:
    s_mov_b32 s38, 1
    s_call_b64 s[40:41], L_fix1
    s_branch L_back34
L_rare35:
    s_mov_b32 s38, 0
    s_call_b64 s[40:41], L_fixo
    s_branch L_back35
L_rare36:
    s_mov_b32 s38, 0
    s_call_b64 s[40:41], L_fix0
    s_branch L_back36
L_rare37:
    s_mov_b32 s38, 0
    s_call_b64 s[40:41], L_fixo
    s_branch L_back37
L_rare38:
    s_mov_b32 s38, 0
    s_call_b64 s[40:41], L_fix1
    s_branch L_back38
L_rare39:
    s_mov_b32 s38, 0
    s_call_b64 s[40:41], L_fixo
    s_branch L_back39
L_rare40:
    s_mov_b32 s38, 1
    s_call_b64 s[40:41], L_fix0
    s_branch L_back40
L_rare41:
    s_mov_b32 s38, 0
    s_call_b64 s[40:41], L_fixo
    s_branch L_back41
L_rare42:
    s_mov_b32 s38, 1
    s_call_b64 s[40:41], L_fix1
    s_branch L_back42
L_rare43:
    s_mov_b32 s38, 0
    s_call_b64 s[40:41], L_fixo
    s_branch L_back43
L_restart:
    s_waitcnt vmcnt(0) lgkmcnt(0)
    s_barrier
    s_mov_b32 s39, 1
    s_branch L_start
L_fix0:
    s_nop 15
    s_waitcnt lgkmcnt(0)
    v_max3_f32 v96, v60, v61, v62
    v_max_f32 v96, v96, v63
    v_max3_f32 v97, v64, v65, v66
    v_max_f32 v97, v97, v67
    v_max3_f32 v98, v68, v69, v70
    v_max_f32 v98, v98, v71
    v_max3_f32 v99, v72, v73, v74
    v_max_f32 v99, v99, v75
    v_max3_f32 v100, v92, v93, v94
    v_max_f32 v100, v100, v95
    v_mov_b32 v101, 0xff800000
    s_cmp_eq_u32 s38, 1
    s_cbranch_scc1 L_fix0_a
    v_mov_b32 v100, v101
L_fix0_a:
    v_mov_b32 v101, v96
    s_nop 1
    v_permlane32_swap_b32 v96, v101
    s_nop 1
    v_max_f32 v96, v96, v101
    v_mov_b32 v101, v96
    s_nop 1
    v_permlane16_swap_b32 v96, v101
    s_nop 1
    v_max_f32 v96, v96, v101
    v_mov_b32 v101, v97
    s_nop 1
    v_permlane32_swap_b32 v97, v101
    s_nop 1
    v_max_f32 v97, v97, v101
    v_mov_b32 v101, v97
    s_nop 1
    v_permlane16_swap_b32 v97, v101
    s_nop 1
    v_max_f32 v97, v97, v101
    v_mov_b32 v101, v98
    s_nop 1
    v_permlane32_swap_b32 v98, v101
    s_nop 1
    v_max_f32 v98, v98, v101
    v_mov_b32 v101, v98
    s_nop 1
    v_permlane16_swap_b32 v98, v101
    s_nop 1
    v_max_f32 v98, v98, v101
    v_mov_b32 v101, v99
    s_nop 1
    v_permlane32_swap_b32 v99, v101
    s_nop 1
    v_max_f32 v99, v99, v101
    v_mov_b32 v101, v99
    s_nop 1
    v_permlane16_swap_b32 v99, v101
    s_nop 1
    v_max_f32 v99, v99, v101
    v_mov_b32 v101, v100
    s_nop 1
    v_permlane32_swap_b32 v100, v101
    s_nop 1
    v_max_f32 v100, v100, v101
    v_mov_b32 v101, v100
    s_nop 1
    v_permlane16_swap_b32 v100, v101
    s_nop 1
    v_max_f32 v100, v100, v101
    s_mul_i32 s99, s28, 1280
    v_add_u32 v101, s99, v3
    ds_write_b32 v101, v96 offset:0
    ds_write_b32 v101, v97 offset:256
    ds_write_b32 v101, v98 offset:512
    ds_write_b32 v101, v99 offset:768
    ds_write_b32 v101, v100 offset:1024
    s_waitcnt lgkmcnt(0)
    s_barrier
    s_xor_b32 s99, s28, 1
    s_mul_i32 s99, s99, 1280
    v_add_u32 v101, s99, v3
    ds_read_b32 v102, v101 offset:0
    ds_read_b32 v103, v101 offset:256
    ds_read_b32 v104, v101 offset:512
    ds_read_b32 v105, v101 offset:768
    ds_read_b32 v106, v3 offset:1024
    ds_read_b32 v107, v3 offset:2304
    ds_read_b32 v108, v3 offset:3584
    ds_read_b32 v109, v3 offset:4864
    s_waitcnt lgkmcnt(0)
    v_max3_f32 v96, v96, v102, s36
    v_max3_f32 v97, v97, v103, s36
    v_max3_f32 v98, v98, v104, s36
    v_max3_f32 v99, v99, v105, s36
    v_max3_f32 v100, v106, v107, v108
    v_max3_f32 v100, v100, v109, s36
    v_sub_f32 v40, v40, v96
    v_sub_f32 v41, v41, v96
    v_sub_f32 v42, v42, v96
    v_sub_f32 v43, v43, v96
    v_sub_f32 v60, v60, v96
    v_sub_f32 v61, v61, v96
    v_sub_f32 v62, v62, v96
    v_sub_f32 v63, v63, v96
    v_sub_f32 v44, v44, v97
    v_sub_f32 v45, v45, v97
    v_sub_f32 v46, v46, v97
    v_sub_f32 v47, v47, v97
    v_sub_f32 v64, v64, v97
    v_sub_f32 v65, v65, v97
    v_sub_f32 v66, v66, v97
    v_sub_f32 v67, v67, v97
    v_sub_f32 v48, v48, v98
    v_sub_f32 v49, v49, v98
    v_sub_f32 v50, v50, v98
    v_sub_f32 v51, v51, v98
    v_sub_f32 v68, v68, v98
    v_sub_f32 v69, v69, v98
    v_sub_f32 v70, v70, v98
    v_sub_f32 v71, v71, v98
    v_sub_f32 v52, v52, v99
    v_sub_f32 v53, v53, v99
    v_sub_f32 v54, v54, v99
    v_sub_f32 v55, v55, v99
    v_sub_f32 v72, v72, v99
    v_sub_f32 v73, v73, v99
    v_sub_f32 v74, v74, v99
    v_sub_f32 v75, v75, v99
    v_sub_f32 v56, v56, v100
    v_sub_f32 v57, v57, v100
    v_sub_f32 v58, v58, v100
    v_sub_f32 v59, v59, v100
    s_cmp_eq_u32 s38, 0
    s_cbranch_scc1 L_fix0_b
    v_sub_f32 v92, v92, v100
    v_sub_f32 v93, v93, v100
    v_sub_f32 v94, v94, v100
    v_sub_f32 v95, v95, v100
L_fix0_b:
    s_cmp_eq_u32 s37, 1
    s_cbranch_scc1 L_fix0_c
    v_sub_f32 v96, 0, v96
    v_exp_f32 v96, v96
    s_nop 0
    v_mul_f32 v24, v24, v96
    v_accvgpr_write_b32 a192, v96
    v_sub_f32 v97, 0, v97
    v_exp_f32 v97, v97
    s_nop 0
    v_mul_f32 v25, v25, v97
    v_accvgpr_write_b32 a193, v97
    v_sub_f32 v98, 0, v98
    v_exp_f32 v98, v98
    s_nop 0
    v_mul_f32 v26, v26, v98
    v_accvgpr_write_b32 a194, v98
    v_sub_f32 v99, 0, v99
    v_exp_f32 v99, v99
    s_nop 0
    v_mul_f32 v27, v27, v99
    v_accvgpr_write_b32 a195, v99
    v_sub_f32 v100, 0, v100
    v_exp_f32 v100, v100
    s_nop 0
    v_mul_f32 v28, v28, v100
    v_accvgpr_write_b32 a196, v100
L_fix0_c:
    s_nop 3
    s_setpc_b64 s[40:41]
L_fix1:
    s_nop 15
    s_waitcnt lgkmcnt(0)
    v_max3_f32 v112, v76, v77, v78
    v_max_f32 v112, v112, v79
    v_max3_f32 v113, v80, v81, v82
    v_max_f32 v113, v113, v83
    v_max3_f32 v114, v84, v85, v86
    v_max_f32 v114, v114, v87
    v_max3_f32 v115, v88, v89, v90
    v_max_f32 v115, v115, v91
    v_max3_f32 v116, v92, v93, v94
    v_max_f32 v116, v116, v95
    v_mov_b32 v117, 0xff800000
    s_cmp_eq_u32 s38, 1
    s_cbranch_scc1 L_fix1_a
    v_mov_b32 v116, v117
L_fix1_a:
    v_mov_b32 v117, v112
    s_nop 1
    v_permlane32_swap_b32 v112, v117
    s_nop 1
    v_max_f32 v112, v112, v117
    v_mov_b32 v117, v112
    s_nop 1
    v_permlane16_swap_b32 v112, v117
    s_nop 1
    v_max_f32 v112, v112, v117
    v_mov_b32 v117, v113
    s_nop 1
    v_permlane32_swap_b32 v113, v117
    s_nop 1
    v_max_f32 v113, v113, v117
    v_mov_b32 v117, v113
    s_nop 1
    v_permlane16_swap_b32 v113, v117
    s_nop 1
    v_max_f32 v113, v113, v117
    v_mov_b32 v117, v114
    s_nop 1
    v_permlane32_swap_b32 v114, v117
    s_nop 1
    v_max_f32 v114, v114, v117
    v_mov_b32 v117, v114
    s_nop 1
    v_permlane16_swap_b32 v114, v117
    s_nop 1
    v_max_f32 v114, v114, v117
    v_mov_b32 v117, v115
    s_nop 1
    v_permlane32_swap_b32 v115, v117
    s_nop 1
    v_max_f32 v115, v115, v117
    v_mov_b32 v117, v115
    s_nop 1
    v_permlane16_swap_b32 v115, v117
    s_nop 1
    v_max_f32 v115, v115, v117
    v_mov_b32 v117, v116
    s_nop 1
    v_permlane32_swap_b32 v116, v117
    s_nop 1
    v_max_f32 v116, v116, v117
    v_mov_b32 v117, v116
    s_nop 1
    v_permlane16_swap_b32 v116, v117
    s_nop 1
    v_max_f32 v116, v116, v117
    s_mul_i32 s99, s28, 1280
    v_add_u32 v117, s99, v3
    ds_write_b32 v117, v112 offset:0
    ds_write_b32 v117, v113 offset:256
    ds_write_b32 v117, v114 offset:512
    ds_write_b32 v117, v115 offset:768
    ds_write_b32 v117, v116 offset:1024
    s_waitcnt lgkmcnt(0)
    s_barrier
    s_xor_b32 s99, s28, 1
    s_mul_i32 s99, s99, 1280
    v_add_u32 v117, s99, v3
    ds_read_b32 v118, v117 offset:0
    ds_read_b32 v119, v117 offset:256
    ds_read_b32 v120, v117 offset:512
    ds_read_b32 v121, v117 offset:768
    ds_read_b32 v122, v3 offset:1024
    ds_read_b32 v123, v3 offset:2304
    ds_read_b32 v124, v3 offset:3584
    ds_read_b32 v125, v3 offset:4864
    s_waitcnt lgkmcnt(0)
    v_max3_f32 v112, v112, v118, s36
    v_max3_f32 v113, v113, v119, s36
    v_max3_f32 v114, v114, v120, s36
    v_max3_f32 v115, v115, v121, s36
    v_max3_f32 v116, v122, v123, v124
    v_max3_f32 v116, v116, v125, s36
    v_sub_f32 v40, v40, v112
    v_sub_f32 v41, v41, v112
    v_sub_f32 v42, v42, v112
    v_sub_f32 v43, v43, v112
    v_sub_f32 v76, v76, v112
    v_sub_f32 v77, v77, v112
    v_sub_f32 v78, v78, v112
    v_sub_f32 v79, v79, v112
    v_sub_f32 v44, v44, v113
    v_sub_f32 v45, v45, v113
    v_sub_f32 v46, v46, v113
    v_sub_f32 v47, v47, v113
    v_sub_f32 v80, v80, v113
    v_sub_f32 v81, v81, v113
    v_sub_f32 v82, v82, v113
    v_sub_f32 v83, v83, v113
    v_sub_f32 v48, v48, v114
    v_sub_f32 v49, v49, v114
    v_sub_f32 v50, v50, v114
    v_sub_f32 v51, v51, v114
    v_sub_f32 v84, v84, v114
    v_sub_f32 v85, v85, v114
    v_sub_f32 v86, v86, v114
    v_sub_f32 v87, v87, v114
    v_sub_f32 v52, v52, v115
    v_sub_f32 v53, v53, v115
    v_sub_f32 v54, v54, v115
    v_sub_f32 v55, v55, v115
    v_sub_f32 v88, v88, v115
    v_sub_f32 v89, v89, v115
    v_sub_f32 v90, v90, v115
    v_sub_f32 v91, v91, v115
    v_sub_f32 v56, v56, v116
    v_sub_f32 v57, v57, v116
    v_sub_f32 v58, v58, v116
    v_sub_f32 v59, v59, v116
    s_cmp_eq_u32 s38, 0
    s_cbranch_scc1 L_fix1_b
    v_sub_f32 v92, v92, v116
    v_sub_f32 v93, v93, v116
    v_sub_f32 v94, v94, v116
    v_sub_f32 v95, v95, v116
L_fix1_b:
    s_cmp_eq_u32 s37, 1
    s_cbranch_scc1 L_fix1_c
    v_sub_f32 v112, 0, v112
    v_exp_f32 v112, v112
    s_nop 0
    v_mul_f32 v24, v24, v112
    v_accvgpr_write_b32 a192, v112
    v_sub_f32 v113, 0, v113
    v_exp_f32 v113, v113
    s_nop 0
    v_mul_f32 v25, v25, v113
    v_accvgpr_write_b32 a193, v113
    v_sub_f32 v114, 0, v114
    v_exp_f32 v114, v114
    s_nop 0
    v_mul_f32 v26, v26, v114
    v_accvgpr_write_b32 a194, v114
    v_sub_f32 v115, 0, v115
    v_exp_f32 v115, v115
    s_nop 0
    v_mul_f32 v27, v27, v115
    v_accvgpr_write_b32 a195, v115
    v_sub_f32 v116, 0, v116
    v_exp_f32 v116, v116
    s_nop 0
    v_mul_f32 v28, v28, v116
    v_accvgpr_write_b32 a196, v116
L_fix1_c:
    s_nop 3
    s_setpc_b64 s[40:41]
L_fixo:
    s_nop 15
    v_accvgpr_read_b32 v30, a192
    v_mul_f32 v128, v30, v128
    v_mul_f32 v129, v30, v129
    v_mul_f32 v130, v30, v130
    v_mul_f32 v131, v30, v131
    v_mul_f32 v132, v30, v132
    v_mul_f32 v133, v30, v133
    v_mul_f32 v134, v30, v134
    v_mul_f32 v135, v30, v135
    v_mul_f32 v136, v30, v136
    v_mul_f32 v137, v30, v137
    v_mul_f32 v138, v30, v138
    v_mul_f32 v139, v30, v139
    v_mul_f32 v140, v30, v140
    v_mul_f32 v141, v30, v141
    v_mul_f32 v142, v30, v142
    v_mul_f32 v143, v30, v143
    v_mul_f32 v144, v30, v144
    v_mul_f32 v145, v30, v145
    v_mul_f32 v146, v30, v146
    v_mul_f32 v147, v30, v147
    v_mul_f32 v148, v30, v148
    v_mul_f32 v149, v30, v149
    v_mul_f32 v150, v30, v150
    v_mul_f32 v151, v30, v151
    v_mul_f32 v152, v30, v152
    v_mul_f32 v153, v30, v153
    v_mul_f32 v154, v30, v154
    v_mul_f32 v155, v30, v155
    v_mul_f32 v156, v30, v156
    v_mul_f32 v157, v30, v157
    v_mul_f32 v158, v30, v158
    v_mul_f32 v159, v30, v159
    v_accvgpr_read_b32 v30, a193
    v_mul_f32 v160, v30, v160
    v_mul_f32 v161, v30, v161
    v_mul_f32 v162, v30, v162
    v_mul_f32 v163, v30, v163
    v_mul_f32 v164, v30, v164
    v_mul_f32 v165, v30, v165
    v_mul_f32 v166, v30, v166
    v_mul_f32 v167, v30, v167
    v_mul_f32 v168, v30, v168
    v_mul_f32 v169, v30, v169
    v_mul_f32 v170, v30, v170
    v_mul_f32 v171, v30, v171
    v_mul_f32 v172, v30, v172
    v_mul_f32 v173, v30, v173
    v_mul_f32 v174, v30, v174
    v_mul_f32 v175, v30, v175
    v_mul_f32 v176, v30, v176
    v_mul_f32 v177, v30, v177
    v_mul_f32 v178, v30, v178
    v_mul_f32 v179, v30, v179
    v_mul_f32 v180, v30, v180
    v_mul_f32 v181, v30, v181
    v_mul_f32 v182, v30, v182
    v_mul_f32 v183, v30, v183
    v_mul_f32 v184, v30, v184
    v_mul_f32 v185, v30, v185
    v_mul_f32 v186, v30, v186
    v_mul_f32 v187, v30, v187
    v_mul_f32 v188, v30, v188
    v_mul_f32 v189, v30, v189
    v_mul_f32 v190, v30, v190
    v_mul_f32 v191, v30, v191
    v_accvgpr_read_b32 v30, a194
    v_mul_f32 v192, v30, v192
    v_mul_f32 v193, v30, v193
    v_mul_f32 v194, v30, v194
    v_mul_f32 v195, v30, v195
    v_mul_f32 v196, v30, v196
    v_mul_f32 v197, v30, v197
    v_mul_f32 v198, v30, v198
    v_mul_f32 v199, v30, v199
    v_mul_f32 v200, v30, v200
    v_mul_f32 v201, v30, v201
    v_mul_f32 v202, v30, v202
    v_mul_f32 v203, v30, v203
    v_mul_f32 v204, v30, v204
    v_mul_f32 v205, v30, v205
    v_mul_f32 v206, v30, v206
    v_mul_f32 v207, v30, v207
    v_mul_f32 v208, v30, v208
    v_mul_f32 v209, v30, v209
    v_mul_f32 v210, v30, v210
    v_mul_f32 v211, v30, v211
    v_mul_f32 v212, v30, v212
    v_mul_f32 v213, v30, v213
    v_mul_f32 v214, v30, v214
    v_mul_f32 v215, v30, v215
    v_mul_f32 v216, v30, v216
    v_mul_f32 v217, v30, v217
    v_mul_f32 v218, v30, v218
    v_mul_f32 v219, v30, v219
    v_mul_f32 v220, v30, v220
    v_mul_f32 v221, v30, v221
    v_mul_f32 v222, v30, v222
    v_mul_f32 v223, v30, v223
    v_accvgpr_read_b32 v30, a195
    v_mul_f32 v224, v30, v224
    v_mul_f32 v225, v30, v225
    v_mul_f32 v226, v30, v226
    v_mul_f32 v227, v30, v227
    v_mul_f32 v228, v30, v228
    v_mul_f32 v229, v30, v229
    v_mul_f32 v230, v30, v230
    v_mul_f32 v231, v30, v231
    v_mul_f32 v232, v30, v232
    v_mul_f32 v233, v30, v233
    v_mul_f32 v234, v30, v234
    v_mul_f32 v235, v30, v235
    v_mul_f32 v236, v30, v236
    v_mul_f32 v237, v30, v237
    v_mul_f32 v238, v30, v238
    v_mul_f32 v239, v30, v239
    v_mul_f32 v240, v30, v240
    v_mul_f32 v241, v30, v241
    v_mul_f32 v242, v30, v242
    v_mul_f32 v243, v30, v243
    v_mul_f32 v244, v30, v244
    v_mul_f32 v245, v30, v245
    v_mul_f32 v246, v30, v246
    v_mul_f32 v247, v30, v247
    v_mul_f32 v248, v30, v248
    v_mul_f32 v249, v30, v249
    v_mul_f32 v250, v30, v250
    v_mul_f32 v251, v30, v251
    v_mul_f32 v252, v30, v252
    v_mul_f32 v253, v30, v253
    v_mul_f32 v254, v30, v254
    v_mul_f32 v255, v30, v255
    v_accvgpr_read_b32 v30, a196
    v_accvgpr_read_b32 v31, a160
    v_mul_f32 v31, v30, v31
    v_accvgpr_write_b32 a160, v31
    v_accvgpr_read_b32 v31, a161
    v_mul_f32 v31, v30, v31
    v_accvgpr_write_b32 a161, v31
    v_accvgpr_read_b32 v31, a162
    v_mul_f32 v31, v30, v31
    v_accvgpr_write_b32 a162, v31
    v_accvgpr_read_b32 v31, a163
    v_mul_f32 v31, v30, v31
    v_accvgpr_write_b32 a163, v31
    v_accvgpr_read_b32 v31, a164
    v_mul_f32 v31, v30, v31
    v_accvgpr_write_b32 a164, v31
    v_accvgpr_read_b32 v31, a165
    v_mul_f32 v31, v30, v31
    v_accvgpr_write_b32 a165, v31
    v_accvgpr_read_b32 v31, a166
    v_mul_f32 v31, v30, v31
    v_accvgpr_write_b32 a166, v31
    v_accvgpr_read_b32 v31, a167
    v_mul_f32 v31, v30, v31
    v_accvgpr_write_b32 a167, v31
    v_accvgpr_read_b32 v31, a168
    v_mul_f32 v31, v30, v31
    v_accvgpr_write_b32 a168, v31
    v_accvgpr_read_b32 v31, a169
    v_mul_f32 v31, v30, v31
    v_accvgpr_write_b32 a169, v31
    v_accvgpr_read_b32 v31, a170
    v_mul_f32 v31, v30, v31
    v_accvgpr_write_b32 a170, v31
    v_accvgpr_read_b32 v31, a171
    v_mul_f32 v31, v30, v31
    v_accvgpr_write_b32 a171, v31
    v_accvgpr_read_b32 v31, a172
    v_mul_f32 v31, v30, v31
    v_accvgpr_write_b32 a172, v31
    v_accvgpr_read_b32 v31, a173
    v_mul_f32 v31, v30, v31
    v_accvgpr_write_b32 a173, v31
    v_accvgpr_read_b32 v31, a174
    v_mul_f32 v31, v30, v31
    v_accvgpr_write_b32 a174, v31
    v_accvgpr_read_b32 v31, a175
    v_mul_f32 v31, v30, v31
    v_accvgpr_write_b32 a175, v31
    v_accvgpr_read_b32 v31, a176
    v_mul_f32 v31, v30, v31
    v_accvgpr_write_b32 a176, v31
    v_accvgpr_read_b32 v31, a177
    v_mul_f32 v31, v30, v31
    v_accvgpr_write_b32 a177, v31
    v_accvgpr_read_b32 v31, a178
    v_mul_f32 v31, v30, v31
    v_accvgpr_write_b32 a178, v31
    v_accvgpr_read_b32 v31, a179
    v_mul_f32 v31, v30, v31
    v_accvgpr_write_b32 a179, v31
    v_accvgpr_read_b32 v31, a180
    v_mul_f32 v31, v30, v31
    v_accvgpr_write_b32 a180, v31
    v_accvgpr_read_b32 v31, a181
    v_mul_f32 v31, v30, v31
    v_accvgpr_write_b32 a181, v31
    v_accvgpr_read_b32 v31, a182
    v_mul_f32 v31, v30, v31
    v_accvgpr_write_b32 a182, v31
    v_accvgpr_read_b32 v31, a183
    v_mul_f32 v31, v30, v31
    v_accvgpr_write_b32 a183, v31
    v_accvgpr_read_b32 v31, a184
    v_mul_f32 v31, v30, v31
    v_accvgpr_write_b32 a184, v31
    v_accvgpr_read_b32 v31, a185
    v_mul_f32 v31, v30, v31
    v_accvgpr_write_b32 a185, v31
    v_accvgpr_read_b32 v31, a186
    v_mul_f32 v31, v30, v31
    v_accvgpr_write_b32 a186, v31
    v_accvgpr_read_b32 v31, a187
    v_mul_f32 v31, v30, v31
    v_accvgpr_write_b32 a187, v31
    v_accvgpr_read_b32 v31, a188
    v_mul_f32 v31, v30, v31
    v_accvgpr_write_b32 a188, v31
    v_accvgpr_read_b32 v31, a189
    v_mul_f32 v31, v30, v31
    v_accvgpr_write_b32 a189, v31
    v_accvgpr_read_b32 v31, a190
    v_mul_f32 v31, v30, v31
    v_accvgpr_write_b32 a190, v31
    v_accvgpr_read_b32 v31, a191
    v_mul_f32 v31, v30, v31
    v_accvgpr_write_b32 a191, v31
    s_nop 3
    s_setpc_b64 s[40:41]
L_codeend:
.section .rodata,"a"
.p2align 6
.amdhsa_kernel concat_heads__gqa_block_cached__mha_block_cached__near_ridge_kernel
  .amdhsa_next_free_vgpr 512
  .amdhsa_next_free_sgpr 102
  .amdhsa_accum_offset 256
  .amdhsa_group_segment_fixed_size 0
  .amdhsa_kernarg_size 104
  .amdhsa_user_sgpr_count 2
  .amdhsa_user_sgpr_kernarg_segment_ptr 1
  .amdhsa_system_sgpr_workgroup_id_x 1
.end_amdhsa_kernel
```
